```python
import torch

def _softmax(x, axis=-1):
    return torch.softmax(x, dim=axis)
def _gelu(x):
    return torch.nn.functional.gelu(x, approximate="tanh")
def _silu(x):
    return torch.nn.functional.silu(x)
def _sigmoid(x):
    return torch.sigmoid(x)
def _layernorm(x, axis=-1, eps=1e-5):
    m = x.mean(dim=axis, keepdim=True)
    v = x.var(dim=axis, keepdim=True, unbiased=False)
    return (x - m) / torch.sqrt(v + eps)
def _scatter_add(tgt, idx, src, axis=0):
    return tgt.clone().index_add_(axis, idx, src)
def _segment_sum(src, seg, n):
    out = torch.zeros((n,) + src.shape[1:], dtype=src.dtype)
    return out.index_add_(0, seg, src)
def _pad(x, pw):
    flat = tuple(v for pair in reversed(pw) for v in pair)
    return torch.nn.functional.pad(x, flat)

kernel_name = 'interleave_layers__sliding_block__glu_gated_reglu__prompt'

def setup_inputs():

    _w = (lambda a: (lambda t: t.to(torch.bfloat16) if t.is_floating_point() else t)(torch.as_tensor(a)))
    def _A_setup():
        B, S, D = 1, 2048, 640
        return {
            "x": _w((lambda *s: torch.randn(*s, dtype=torch.bfloat16) * 0.05)(B, S, D)),
            "wqkv": _w((lambda *s: torch.randn(*s, dtype=torch.bfloat16) * 0.05)(D, 3 * D)),
            "wo": _w((lambda *s: torch.randn(*s, dtype=torch.bfloat16) * 0.05)(D, D)),
        }
    _A_in = _A_setup()

    def _B_setup():
        B, S, D, F = 1, 2048, 640, 1728
        return {
            "x": _w((lambda *s: torch.randn(*s, dtype=torch.bfloat16) * 0.05)(B, S, D)),
            "W_gate": _w((lambda *s: torch.randn(*s, dtype=torch.bfloat16) * 0.8)(D, F) * (2.0 / D) ** 0.5),
            "W_up": _w((lambda *s: torch.randn(*s, dtype=torch.bfloat16) * 0.8)(D, F) * (2.0 / D) ** 0.5),
            "W_down": _w((lambda *s: torch.randn(*s, dtype=torch.bfloat16) * 0.8)(F, D) * (1.0 / F) ** 0.5),
        }
    _B_in = _B_setup()

    return {
        "A_x": _A_in["x"],
        "A_wqkv": _A_in["wqkv"],
        "A_wo": _A_in["wo"],
        "B_x": _B_in["x"],
        "B_W_gate": _B_in["W_gate"],
        "B_W_up": _B_in["W_up"],
        "B_W_down": _B_in["W_down"],
    }

def reference(A_x, A_wqkv, A_wo, B_x, B_W_gate, B_W_up, B_W_down):
    def _A_ref(x, wqkv, wo):
        B, S, D = x.shape
        H = 32; Dh = D // H; W = 256
        qkv = (lambda x, *d: x.permute(*d))((x @ wqkv).reshape(B, S, 3, H, Dh), 2, 0, 3, 1, 4)
        q, k, v = qkv[0], qkv[1], qkv[2]
        scores = torch.einsum("bhqd,bhkd->bhqk", q, k) * (Dh ** -0.5)
        idx = torch.arange(S)
        mask = (idx[:, None] - idx[None, :] >= 0) & (idx[:, None] - idx[None, :] < W)
        scores = torch.where(mask[None, None], scores, -1e9)
        p = _softmax(scores, axis=-1)
        o = torch.einsum("bhqk,bhkd->bhqd", p, v)
        return (lambda x, *d: x.permute(*d))(o, 0, 2, 1, 3).reshape(B, S, D) @ wo

    def _B_ref(x, W_gate, W_up, W_down):
        gate = torch.einsum("bsd,df->bsf", x, W_gate)
        up = torch.einsum("bsd,df->bsf", x, W_up)
        gate = gate * (lambda x, dt: x.to(dt))(gate > 0, gate.dtype)
        h = gate * up
        return torch.einsum("bsf,fd->bsd", h, W_down)

    x = A_x
    x = x + _A_ref(_layernorm(x, axis=-1), A_wqkv, A_wo)
    x = x + _B_ref(_layernorm(x, axis=-1), B_W_gate, B_W_up, B_W_down)
    x = x + _A_ref(_layernorm(x, axis=-1), A_wqkv, A_wo)
    x = x + _B_ref(_layernorm(x, axis=-1), B_W_gate, B_W_up, B_W_down)
    return x
```

```asm
; @launch grid=(256,1,1) block=(256,1,1) lds=163840
.amdgcn_target "amdgcn-amd-amdhsa--gfx950"
.text
.globl interleave_layers__sliding_block__glu_gated_reglu__prompt_kernel
.p2align 8
.type interleave_layers__sliding_block__glu_gated_reglu__prompt_kernel,@function
interleave_layers__sliding_block__glu_gated_reglu__prompt_kernel:
    s_cmp_ge_u32 s2, 256
    s_nop 0
    s_cbranch_scc1 L_exit
    s_load_dwordx16 s[4:19], s[0:1], 0
    s_load_dwordx4 s[20:23], s[0:1], 64
    s_getpc_b64 s[56:57]
    v_lshrrev_b32 v3, 6, v0
    v_and_b32 v1, 63, v0
    v_readfirstlane_b32 s42, v3
    v_lshlrev_b32 v2, 4, v1
    s_lshr_b32 s49, s2, 3
    s_lshl_b32 s48, s49, 2
    s_add_u32 s48, s48, s42
    s_and_b32 s48, s48, 15
    s_lshl_b32 s48, s48, 13
    v_lshl_add_u32 v3, v1, 7, s48
    v_min_u32 v3, L_exit-interleave_layers__sliding_block__glu_gated_reglu__prompt_kernel-64, v3
    global_load_dword v63, v3, s[56:57]
    s_and_b32 s48, s2, 7
    s_lshr_b32 s50, s49, 4
    s_lshl_b32 s48, s48, 1
    s_add_u32 s40, s48, s50
    s_and_b32 s41, s49, 15
    s_lshl_b32 s45, s40, 4
    s_add_u32 s45, s45, s41
    s_lshl_b32 s96, s40, 2
    s_add_u32 s96, s96, s42
    s_lshl_b32 s66, s42, 10
    v_lshrrev_b32 v240, 4, v1
    v_and_b32 v241, 15, v1
    s_and_b32 s48, s42, 1
    s_lshl_b32 s48, s48, 2
    v_add_u32 v45, s48, v240
    v_lshlrev_b32 v45, 1, v45
    v_xor_b32 v45, v241, v45
    v_lshlrev_b32 v58, 4, v45
    v_mov_b32 v48, 1200
    v_cmp_lt_u32 vcc, 4, v45
    s_nop 1
    v_cndmask_b32 v47, 0, v48, vcc
    v_add_u32 v58, v58, v47
    v_cmp_lt_u32 vcc, 9, v45
    s_nop 1
    v_cndmask_b32 v47, 0, v48, vcc
    v_add_u32 v58, v58, v47
    v_mul_u32_u24 v47, 3840, v240
    v_add_u32 v58, v58, v47
    s_mul_i32 s88, s42, 30720
    s_mul_i32 s48, s41, 80
    s_add_u32 s88, s88, s48
    s_lshr_b32 s48, s2, 3
    s_lshl_b32 s48, s48, 2
    s_add_u32 s48, s48, s42
    s_mul_i32 s82, s48, 3840
    s_lshr_b32 s49, s40, 1
    s_lshl_b32 s49, s49, 7
    s_add_u32 s48, s48, s49
    s_mul_i32 s83, s48, 2560
    v_lshlrev_b32 v47, 7, v1
    v_mov_b32 v48, 0x40000000
    v_cmp_gt_u32 vcc, 30, v1
    s_nop 1
    v_cndmask_b32 v55, v48, v47, vcc
    v_cmp_gt_u32 vcc, 20, v1
    s_nop 1
    v_cndmask_b32 v56, v48, v47, vcc
    s_mul_i32 s71, s96, 40960
    s_lshl_b32 s69, s42, 14
    v_lshrrev_b32 v242, 2, v241
    v_lshlrev_b32 v242, 10, v242
    v_and_b32 v243, 3, v241
    v_lshl_add_u32 v242, v243, 8, v242
    v_add_u32 v242, s69, v242
    v_add_u32 v243, 0, v240
    v_xor_b32 v244, v243, v241
    v_lshlrev_b32 v244, 4, v244
    v_mul_u32_u24 v243, 1280, v243
    v_add_u32 v248, v244, v243
    v_add_u32 v244, v244, v242
    v_add_u32 v243, 4, v240
    v_xor_b32 v245, v243, v241
    v_lshlrev_b32 v245, 4, v245
    v_mul_u32_u24 v243, 1280, v243
    v_add_u32 v249, v245, v243
    v_add_u32 v245, v245, v242
    v_add_u32 v243, 8, v240
    v_xor_b32 v246, v243, v241
    v_lshlrev_b32 v246, 4, v246
    v_mul_u32_u24 v243, 1280, v243
    v_add_u32 v250, v246, v243
    v_add_u32 v246, v246, v242
    v_add_u32 v243, 12, v240
    v_xor_b32 v247, v243, v241
    v_lshlrev_b32 v247, 4, v247
    v_mul_u32_u24 v243, 1280, v243
    v_add_u32 v251, v247, v243
    v_add_u32 v247, v247, v242
    s_waitcnt lgkmcnt(0)
    s_mov_b32 s84, s6
    s_mov_b32 s85, s7
    s_mov_b32 s86, 2457600
    s_mov_b32 s87, 0x20000
    s_mov_b32 s28, s4
    s_mov_b32 s29, s5
    s_mov_b32 s30, 2621440
    s_mov_b32 s31, 0x20000
    s_add_u32 s63, s82, 0
    buffer_load_dword v63, v55, s[84:87], s63 offen
    buffer_load_dword v63, v56, s[28:31], s83 offen
    s_mov_b32 s24, s22
    s_mov_b32 s25, s23
    s_mov_b32 s26, 51736576
    s_mov_b32 s27, 0x20000
    v_mov_b32 v12, 0
    v_mov_b32 v13, 0
    v_mov_b32 v14, 0
    v_mov_b32 v15, 0
    s_lshl_b32 s48, s40, 12
    s_add_u32 s48, s48, 32768
    s_add_u32 s48, s48, s66
    s_lshl_b32 s49, s40, 11
    s_and_b32 s50, s42, 1
    s_lshl_b32 s50, s50, 10
    s_add_u32 s49, s49, s50
    s_add_u32 s51, s49, 131072
    s_cmp_lt_u32 s42, 2
    s_cselect_b32 s50, 0, 98304
    s_add_u32 s49, s49, s50
    s_cmp_eq_u32 s41, 0
    s_cselect_b32 s48, s48, 0x7f000000
    s_cselect_b32 s49, s49, 0x7f000000
    s_cselect_b32 s51, s51, 0x7f000000
    buffer_store_dwordx4 v[12:15], v2, s[24:27], s51 offen sc1
    buffer_store_dwordx4 v[12:15], v2, s[24:27], s48 offen sc1
    buffer_store_dwordx4 v[12:15], v2, s[24:27], s49 offen sc1
    s_add_u32 m0, s66, 114688
    s_add_u32 s63, s88, 0
    buffer_load_dwordx4 v58, s[84:87], s63 offen lds
    s_add_u32 m0, s66, 118784
    s_add_u32 s63, s88, 15360
    buffer_load_dwordx4 v58, s[84:87], s63 offen lds
    s_add_u32 m0, s66, 73728
    s_add_u32 s63, s88, 122880
    buffer_load_dwordx4 v58, s[84:87], s63 offen lds
    s_add_u32 m0, s66, 77824
    s_add_u32 s63, s88, 138240
    buffer_load_dwordx4 v58, s[84:87], s63 offen lds
    s_add_u32 s70, s45, 256
    s_mov_b32 s32, s18
    s_mov_b32 s33, s19
    s_mov_b32 s34, 2621440
    s_mov_b32 s35, 0x20000
    s_and_b32 s43, s41, 7
    s_lshr_b32 s44, s41, 3
    v_add_u32 v3, 65536, v2
    v_add_u32 v4, 131072, v2
    s_lshr_b32 s64, s42, 1
    s_and_b32 s65, s42, 1
    s_lshl_b32 s48, s64, 10
    v_add_u32 v5, s48, v2
    v_add_u32 v6, 65536, v5
    v_add_u32 v7, 131072, v5
    v_add_u32 v8, s66, v2
    s_lshl_b32 s68, s42, 11
    v_add_u32 v253, s68, v2
    v_add_u32 v254, 65536, v253
    v_add_u32 v255, 131072, v253
    s_mul_i32 s98, s41, 163840
    s_add_u32 s98, s98, 1048576
    s_mul_i32 s99, s43, 102400
    s_add_u32 s99, s99, 3670016
    s_mul_i32 s100, s41, 286720
    s_add_u32 s100, s100, 4489216
    s_mul_i32 s101, s43, 278528
    s_add_u32 s101, s101, 9076736
    s_mov_b32 s72, s22
    s_mov_b32 s73, s23
    s_mov_b32 s74, 0
    s_mov_b32 s75, 0x20000
    s_mov_b32 s76, s22
    s_mov_b32 s77, s23
    s_mov_b32 s78, 51736576
    s_mov_b32 s79, 0x20000
    s_and_b32 s48, s40, 1
    s_lshl_b32 s49, s42, 1
    s_add_u32 s49, s49, s48
    s_lshl_b32 s50, s49, 10
    s_lshl_b32 s49, s49, 1
    s_add_u32 s49, s49, s44
    s_lshl_b32 s51, s49, 10
    v_lshlrev_b32 v9, 7, v1
    v_mov_b32 v10, 0x40000000
    v_cmp_gt_u32 vcc, 8, v1
    s_nop 1
    v_cndmask_b32 v9, v10, v9, vcc
    v_add_u32 v252, s50, v9
    v_add_u32 v0, s51, v9
    s_lshl_b32 s67, s40, 12
    s_add_u32 s67, s67, 32768
    s_lshl_b32 s48, s42, 6
    s_add_u32 s90, s48, s67
    s_lshl_b32 s48, s41, 2
    s_add_u32 s95, s90, s48
    s_lshl_b32 s48, s44, 1
    s_add_u32 s48, s48, s65
    s_lshl_b32 s48, s48, 6
    s_add_u32 s94, s48, s67
    s_lshl_b32 s48, s43, 1
    s_add_u32 s48, s48, s64
    s_lshl_b32 s48, s48, 2
    s_add_u32 s91, s94, s48
    s_lshl_b32 s97, s40, 2
    s_lshl_b32 s48, s44, 1
    s_add_u32 s97, s97, s48
    s_add_u32 s97, s97, s65
    v_lshrrev_b32 v44, 2, v1
    v_and_b32 v45, 7, v44
    v_lshlrev_b32 v45, 1, v45
    v_and_b32 v46, 3, v1
    v_lshlrev_b32 v44, 8, v44
    v_add_u32 v44, 73728, v44
    v_mad_u32_u24 v47, v46, 1, 10
    v_lshrrev_b32 v48, 1, v47
    v_xor_b32 v48, v48, v45
    v_lshlrev_b32 v48, 4, v48
    v_and_b32 v47, 1, v47
    v_lshlrev_b32 v47, 3, v47
    v_add3_u32 v232, v44, v47, v48
    v_mad_u32_u24 v47, v46, 1, 15
    v_lshrrev_b32 v48, 1, v47
    v_xor_b32 v48, v48, v45
    v_lshlrev_b32 v48, 4, v48
    v_and_b32 v47, 1, v47
    v_lshlrev_b32 v47, 3, v47
    v_add3_u32 v233, v44, v47, v48
    v_mad_u32_u24 v47, v46, 5, 4
    v_lshrrev_b32 v48, 1, v47
    v_xor_b32 v48, v48, v45
    v_lshlrev_b32 v48, 4, v48
    v_and_b32 v47, 1, v47
    v_lshlrev_b32 v47, 3, v47
    v_add3_u32 v234, v44, v47, v48
    v_mad_u32_u24 v47, v46, 1, 20
    v_lshrrev_b32 v48, 1, v47
    v_xor_b32 v48, v48, v45
    v_lshlrev_b32 v48, 4, v48
    v_and_b32 v47, 1, v47
    v_lshlrev_b32 v47, 3, v47
    v_add3_u32 v235, v44, v47, v48
    v_mad_u32_u24 v47, v46, 1, 24
    v_lshrrev_b32 v48, 1, v47
    v_xor_b32 v48, v48, v45
    v_lshlrev_b32 v48, 4, v48
    v_and_b32 v47, 1, v47
    v_lshlrev_b32 v47, 3, v47
    v_add3_u32 v236, v44, v47, v48
    v_mad_u32_u24 v47, v46, 1, 28
    v_lshrrev_b32 v48, 1, v47
    v_xor_b32 v48, v48, v45
    v_lshlrev_b32 v48, 4, v48
    v_and_b32 v47, 1, v47
    v_lshlrev_b32 v47, 3, v47
    v_add3_u32 v237, v44, v47, v48
    v_mad_u32_u24 v47, v46, 1, 0
    v_lshrrev_b32 v48, 1, v47
    v_xor_b32 v48, v48, v45
    v_lshlrev_b32 v48, 4, v48
    v_and_b32 v47, 1, v47
    v_lshlrev_b32 v47, 3, v47
    v_add3_u32 v238, v44, v47, v48
    v_mad_u32_u24 v47, v46, 1, 5
    v_lshrrev_b32 v48, 1, v47
    v_xor_b32 v48, v48, v45
    v_lshlrev_b32 v48, 4, v48
    v_and_b32 v47, 1, v47
    v_lshlrev_b32 v47, 3, v47
    v_add3_u32 v239, v44, v47, v48
    v_mov_b32 v184, v232
    s_cmp_eq_u32 s42, 1
    s_cselect_b64 vcc, -1, 0
    v_cndmask_b32 v184, v184, v234, vcc
    s_cmp_eq_u32 s42, 2
    s_cselect_b64 vcc, -1, 0
    v_cndmask_b32 v184, v184, v236, vcc
    s_cmp_eq_u32 s42, 3
    s_cselect_b64 vcc, -1, 0
    v_cndmask_b32 v184, v184, v238, vcc
    v_mov_b32 v185, v233
    s_cmp_eq_u32 s42, 1
    s_cselect_b64 vcc, -1, 0
    v_cndmask_b32 v185, v185, v235, vcc
    s_cmp_eq_u32 s42, 2
    s_cselect_b64 vcc, -1, 0
    v_cndmask_b32 v185, v185, v237, vcc
    s_cmp_eq_u32 s42, 3
    s_cselect_b64 vcc, -1, 0
    v_cndmask_b32 v185, v185, v239, vcc
    v_mov_b32 v228, 0x3f803f80
    v_mov_b32 v229, 0x3f803f80
    v_mov_b32 v230, 0x3f803f80
    v_mov_b32 v231, 0x3f803f80
    s_cmp_eq_u32 s42, 3
    s_cselect_b32 s89, 122880, s68
    s_add_u32 s89, s89, s98
    v_lshlrev_b32 v54, 2, v1
    s_mul_i32 s80, s42, 5120
    s_cmp_ge_u32 s45, 40
    s_nop 0
    s_cbranch_scc1 L_prD_1
    s_mov_b32 s36, s8
    s_mov_b32 s37, s9
    s_mov_b32 s38, 819200
    s_mov_b32 s39, 0x20000
    s_lshr_b32 s48, s45, 1
    s_mul_i32 s50, s48, 40
    s_mul_i32 s49, s48, 160
    s_sub_u32 s49, s49, 2544
    s_cmp_lt_u32 s48, 16
    s_cselect_b32 s50, s50, s49
    s_cselect_b32 s51, 20, 80
    s_cselect_b32 s52, 4, 40
    s_cselect_b32 s53, 8, 20
    s_mov_b32 s56, 102400
    s_mov_b32 s57, 3670016
    s_and_b32 s54, s45, 1
    s_mul_i32 s54, s54, 640
    s_lshr_b32 s55, s42, 1
    s_mul_i32 s55, s55, s53
    s_add_u32 s50, s50, s55
    s_and_b32 s55, s42, 1
    s_mul_i32 s55, s55, s51
    s_add_u32 s50, s50, s55
    s_mul_i32 s50, s50, 1280
    s_add_u32 s50, s50, s54
    s_mul_i32 s52, s52, 1280
    v_add_u32 v44, 0, v1
    v_mul_u32_u24 v45, 1639, v44
    v_lshrrev_b32 v45, 16, v45
    v_mul_u32_u24 v46, 40, v45
    v_sub_u32 v46, v44, v46
    v_lshl_add_u32 v46, v46, 4, s50
    v_and_b32 v47, 3, v45
    v_mul_u32_u24 v47, 1280, v47
    v_lshrrev_b32 v45, 2, v45
    v_mul_u32_u24 v45, s52, v45
    v_add3_u32 v42, v45, v46, v47
    v_add_u32 v44, 64, v1
    v_mul_u32_u24 v45, 1639, v44
    v_lshrrev_b32 v45, 16, v45
    v_mul_u32_u24 v46, 40, v45
    v_sub_u32 v46, v44, v46
    v_lshl_add_u32 v46, v46, 4, s50
    v_and_b32 v47, 3, v45
    v_mul_u32_u24 v47, 1280, v47
    v_lshrrev_b32 v45, 2, v45
    v_mul_u32_u24 v45, s52, v45
    v_add3_u32 v43, v45, v46, v47
    v_add_u32 v44, 128, v1
    v_mul_u32_u24 v45, 1639, v44
    v_lshrrev_b32 v45, 16, v45
    v_mul_u32_u24 v46, 40, v45
    v_sub_u32 v46, v44, v46
    v_lshl_add_u32 v46, v46, 4, s50
    v_and_b32 v47, 3, v45
    v_mul_u32_u24 v47, 1280, v47
    v_lshrrev_b32 v45, 2, v45
    v_mul_u32_u24 v45, s52, v45
    v_add3_u32 v57, v45, v46, v47
    v_add_u32 v44, 192, v1
    v_mul_u32_u24 v45, 1639, v44
    v_lshrrev_b32 v45, 16, v45
    v_mul_u32_u24 v46, 40, v45
    v_sub_u32 v46, v44, v46
    v_lshl_add_u32 v46, v46, 4, s50
    v_and_b32 v47, 3, v45
    v_mul_u32_u24 v47, 1280, v47
    v_lshrrev_b32 v45, 2, v45
    v_mul_u32_u24 v45, s52, v45
    v_add3_u32 v60, v45, v46, v47
    v_add_u32 v44, 256, v1
    v_mul_u32_u24 v45, 1639, v44
    v_lshrrev_b32 v45, 16, v45
    v_mul_u32_u24 v46, 40, v45
    v_sub_u32 v46, v44, v46
    v_lshl_add_u32 v46, v46, 4, s50
    v_and_b32 v47, 3, v45
    v_mul_u32_u24 v47, 1280, v47
    v_lshrrev_b32 v45, 2, v45
    v_mul_u32_u24 v45, s52, v45
    v_add3_u32 v61, v45, v46, v47
    v_lshrrev_b32 v44, 2, v1
    v_mul_u32_u24 v44, 640, v44
    v_and_b32 v45, 3, v1
    v_lshl_add_u32 v44, v45, 3, v44
    s_mul_i32 s49, s42, 160
    s_add_u32 s49, s49, 139264
    v_add_u32 v26, s49, v44
    s_and_b32 s49, s45, 1
    s_lshl_b32 s49, s49, 2
    s_add_u32 s49, s49, s42
    s_mul_i32 s49, s49, s56
    s_add_u32 s49, s49, s57
    s_lshr_b32 s50, s45, 2
    s_mul_i32 s50, s50, 10240
    s_add_u32 s49, s49, s50
    s_bfe_u32 s50, s45, 0x10001
    s_lshl_b32 s50, s50, 10
    s_add_u32 s49, s49, s50
    v_add_u32 v36, s49, v2
    v_add_u32 v27, 10240, v26
    v_add_u32 v28, 32, v26
    v_add_u32 v29, 10272, v26
    v_add_u32 v30, 64, v26
    v_add_u32 v31, 10304, v26
    v_add_u32 v32, 96, v26
    v_add_u32 v33, 10336, v26
    v_add_u32 v34, 128, v26
    v_add_u32 v35, 10368, v26
    v_add_u32 v37, 2048, v36
    v_add_u32 v38, 4096, v36
    v_add_u32 v39, 6144, v36
    v_add_u32 v40, 8192, v36
    v_mov_b32 v41, 0x7f000000
    s_mov_b32 s81, 0
    s_nop 0
    s_branch L_prend_2
    s_nop 0
L_prD_1:
    s_cmp_lt_u32 s42, 2
    s_cselect_b32 s36, s12, s14
    s_cselect_b32 s37, s13, s15
    s_mov_b32 s38, 2211840
    s_mov_b32 s39, 0x20000
    s_sub_u32 s48, s45, 40
    s_lshr_b32 s49, s48, 3
    s_and_b32 s48, s48, 7
    s_mul_i32 s50, s48, 80
    s_and_b32 s51, s42, 1
    s_mul_i32 s51, s51, 40
    s_add_u32 s50, s50, s51
    s_mul_i32 s50, s50, 3456
    s_lshl_b32 s51, s49, 7
    s_add_u32 s50, s50, s51
    v_lshrrev_b32 v44, 3, v1
    v_mul_u32_u24 v44, 3456, v44
    v_and_b32 v45, 7, v1
    v_lshl_add_u32 v44, v45, 4, v44
    v_add_u32 v42, s50, v44
    v_add_u32 v43, 27648, v42
    v_add_u32 v57, 55296, v42
    v_add_u32 v60, 82944, v42
    v_add_u32 v61, 110592, v42
    v_bfe_u32 v44, v1, 4, 1
    v_lshlrev_b32 v44, 2, v44
    v_bfe_u32 v45, v1, 2, 2
    v_add_u32 v44, v44, v45
    v_lshlrev_b32 v44, 7, v44
    v_lshrrev_b32 v46, 5, v1
    v_mul_u32_u24 v45, 10240, v46
    v_add_u32 v44, v44, v45
    v_and_b32 v45, 3, v1
    v_lshl_add_u32 v44, v45, 3, v44
    s_lshl_b32 s50, s42, 5
    s_add_u32 s50, s50, 139264
    v_add_u32 v26, s50, v44
    v_add_u32 v27, 2048, v26
    v_add_u32 v28, 1024, v26
    v_add_u32 v29, 3072, v26
    v_add_u32 v30, 4096, v26
    v_add_u32 v31, 6144, v26
    v_add_u32 v32, 5120, v26
    v_add_u32 v33, 7168, v26
    v_add_u32 v34, 8192, v26
    v_add_u32 v35, 9216, v26
    v_and_b32 v45, 31, v1
    v_lshlrev_b32 v45, 4, v45
    v_lshl_add_u32 v45, v46, 10, v45
    s_lshl_b32 s49, s49, 2
    s_add_u32 s49, s49, s42
    s_mul_i32 s50, s49, 19
    s_lshr_b32 s50, s50, 9
    s_mul_i32 s51, s50, 27
    s_sub_u32 s51, s49, s51
    s_lshl_b32 s50, s50, 2
    s_mul_i32 s81, s50, 286720
    s_add_u32 s81, s81, 4696064
    s_cmp_eq_u32 s51, 6
    s_cselect_b32 s81, s81, 0
    s_cmp_ge_u32 s51, 6
    s_cselect_b32 s52, 1, 0
    s_cselect_b32 s53, 6, 0
    s_add_u32 s50, s50, s52
    s_sub_u32 s51, s51, s53
    s_cmp_ge_u32 s51, 7
    s_cselect_b32 s52, 1, 0
    s_cselect_b32 s53, 7, 0
    s_add_u32 s50, s50, s52
    s_sub_u32 s51, s51, s53
    s_cmp_ge_u32 s51, 7
    s_cselect_b32 s52, 1, 0
    s_cselect_b32 s53, 7, 0
    s_add_u32 s50, s50, s52
    s_sub_u32 s51, s51, s53
    s_lshl_b32 s55, s51, 1
    s_add_u32 s52, s55, 190
    s_mov_b32 s53, 4
    s_add_u32 s54, s55, 114
    s_cmp_lt_u32 s51, 5
    s_cselect_b32 s52, s54, s52
    s_cmp_lt_u32 s51, 3
    s_cselect_b32 s52, s55, s52
    s_cselect_b32 s53, 6, s53
    s_lshl_b32 s52, s52, 10
    s_lshl_b32 s53, s53, 10
    s_mul_i32 s50, s50, 286720
    s_add_u32 s52, s52, s50
    s_add_u32 s52, s52, 4489216
    s_mul_i32 s50, s48, 5
    s_add_u32 s51, s50, 0
    s_lshr_b32 s54, s51, 1
    s_mul_i32 s54, s54, s53
    s_and_b32 s51, s51, 1
    s_lshl_b32 s51, s51, 9
    s_add_u32 s54, s54, s51
    s_add_u32 s54, s54, s52
    v_add_u32 v36, s54, v45
    s_add_u32 s51, s50, 1
    s_lshr_b32 s54, s51, 1
    s_mul_i32 s54, s54, s53
    s_and_b32 s51, s51, 1
    s_lshl_b32 s51, s51, 9
    s_add_u32 s54, s54, s51
    s_add_u32 s54, s54, s52
    v_add_u32 v37, s54, v45
    s_add_u32 s51, s50, 2
    s_lshr_b32 s54, s51, 1
    s_mul_i32 s54, s54, s53
    s_and_b32 s51, s51, 1
    s_lshl_b32 s51, s51, 9
    s_add_u32 s54, s54, s51
    s_add_u32 s54, s54, s52
    v_add_u32 v38, s54, v45
    s_add_u32 s51, s50, 3
    s_lshr_b32 s54, s51, 1
    s_mul_i32 s54, s54, s53
    s_and_b32 s51, s51, 1
    s_lshl_b32 s51, s51, 9
    s_add_u32 s54, s54, s51
    s_add_u32 s54, s54, s52
    v_add_u32 v39, s54, v45
    s_add_u32 s51, s50, 4
    s_lshr_b32 s54, s51, 1
    s_mul_i32 s54, s54, s53
    s_and_b32 s51, s51, 1
    s_lshl_b32 s51, s51, 9
    s_add_u32 s54, s54, s51
    s_add_u32 s54, s54, s52
    v_add_u32 v40, s54, v45
    s_mul_i32 s48, s48, 108
    s_add_u32 s48, s48, s49
    s_lshl_b32 s48, s48, 7
    s_add_u32 s48, s48, 11386880
    v_lshl_add_u32 v44, v1, 2, s48
    v_mov_b32 v45, 0x7f000000
    v_cmp_gt_u32 vcc, 32, v1
    s_nop 1
    v_cndmask_b32 v41, v45, v44, vcc
    s_nop 1
L_prend_2:
    v_bfe_u32 v44, v1, 2, 2
    v_lshrrev_b32 v45, 5, v1
    v_cmp_eq_u32 vcc, v44, v45
    v_mov_b32 v44, 0x3f803f80
    s_nop 0
    v_cndmask_b32 v44, 0, v44, vcc
    v_accvgpr_write_b32 a200, v44
    v_accvgpr_write_b32 a201, v44
    v_accvgpr_write_b32 a202, v44
    v_accvgpr_write_b32 a203, v44
    s_cmp_lt_u32 s70, 364
    s_nop 0
    s_cbranch_scc0 L_notask_3
    s_sub_u32 s48, s70, 256
    s_and_b32 s48, s48, -2
    s_mul_i32 s58, s48, 205
    s_lshr_b32 s58, s58, 10
    s_mul_i32 s59, s58, 5
    s_sub_u32 s59, s48, s59
    s_lshr_b32 s60, s58, 2
    s_mul_i32 s60, s60, 27
    s_add_u32 s59, s59, s60
    s_and_b32 s58, s58, 3
    s_mul_i32 s60, s58, 7
    s_add_u32 s59, s59, s60
    s_min_u32 s58, s58, 1
    s_sub_u32 s59, s59, s58
    s_sub_u32 s58, s48, 80
    s_mul_i32 s60, s58, 37
    s_lshr_b32 s60, s60, 8
    s_mul_i32 s61, s60, 7
    s_sub_u32 s58, s58, s61
    s_mul_i32 s60, s60, 27
    s_add_u32 s60, s60, 5
    s_add_u32 s61, s58, 1
    s_lshr_b32 s61, s61, 1
    s_mul_i32 s61, s61, 7
    s_add_u32 s60, s60, s61
    s_and_b32 s58, s58, 1
    s_sub_u32 s60, s60, s58
    s_cmp_lt_u32 s48, 80
    s_cselect_b32 s50, s59, s60
    s_add_u32 s48, s48, 1
    s_mul_i32 s58, s48, 205
    s_lshr_b32 s58, s58, 10
    s_mul_i32 s59, s58, 5
    s_sub_u32 s59, s48, s59
    s_lshr_b32 s60, s58, 2
    s_mul_i32 s60, s60, 27
    s_add_u32 s59, s59, s60
    s_and_b32 s58, s58, 3
    s_mul_i32 s60, s58, 7
    s_add_u32 s59, s59, s60
    s_min_u32 s58, s58, 1
    s_sub_u32 s59, s59, s58
    s_sub_u32 s58, s48, 80
    s_mul_i32 s60, s58, 37
    s_lshr_b32 s60, s60, 8
    s_mul_i32 s61, s60, 7
    s_sub_u32 s58, s58, s61
    s_mul_i32 s60, s60, 27
    s_add_u32 s60, s60, 5
    s_add_u32 s61, s58, 1
    s_lshr_b32 s61, s61, 1
    s_mul_i32 s61, s61, 7
    s_add_u32 s60, s60, s61
    s_and_b32 s58, s58, 1
    s_sub_u32 s60, s60, s58
    s_cmp_lt_u32 s48, 80
    s_cselect_b32 s51, s59, s60
    s_sub_u32 s51, s51, s50
    s_lshl_b32 s51, s51, 4
    s_lshl_b32 s50, s50, 4
    s_mov_b32 s52, 4
    s_mov_b32 s53, 8
    s_mov_b32 s56, 278528
    s_mov_b32 s57, 8421376
    s_and_b32 s54, s70, 1
    s_mul_i32 s54, s54, 640
    s_lshr_b32 s55, s42, 1
    s_mul_i32 s55, s55, s53
    s_add_u32 s50, s50, s55
    s_and_b32 s55, s42, 1
    s_mul_i32 s55, s55, s51
    s_add_u32 s50, s50, s55
    s_mul_i32 s50, s50, 1280
    s_add_u32 s50, s50, s54
    s_mul_i32 s52, s52, 1280
    v_add_u32 v44, 0, v1
    v_mul_u32_u24 v45, 1639, v44
    v_lshrrev_b32 v45, 16, v45
    v_mul_u32_u24 v46, 40, v45
    v_sub_u32 v46, v44, v46
    v_lshl_add_u32 v46, v46, 4, s50
    v_and_b32 v47, 3, v45
    v_mul_u32_u24 v47, 1280, v47
    v_lshrrev_b32 v45, 2, v45
    v_mul_u32_u24 v45, s52, v45
    v_add3_u32 v208, v45, v46, v47
    v_add_u32 v44, 64, v1
    v_mul_u32_u24 v45, 1639, v44
    v_lshrrev_b32 v45, 16, v45
    v_mul_u32_u24 v46, 40, v45
    v_sub_u32 v46, v44, v46
    v_lshl_add_u32 v46, v46, 4, s50
    v_and_b32 v47, 3, v45
    v_mul_u32_u24 v47, 1280, v47
    v_lshrrev_b32 v45, 2, v45
    v_mul_u32_u24 v45, s52, v45
    v_add3_u32 v209, v45, v46, v47
    v_add_u32 v44, 128, v1
    v_mul_u32_u24 v45, 1639, v44
    v_lshrrev_b32 v45, 16, v45
    v_mul_u32_u24 v46, 40, v45
    v_sub_u32 v46, v44, v46
    v_lshl_add_u32 v46, v46, 4, s50
    v_and_b32 v47, 3, v45
    v_mul_u32_u24 v47, 1280, v47
    v_lshrrev_b32 v45, 2, v45
    v_mul_u32_u24 v45, s52, v45
    v_add3_u32 v210, v45, v46, v47
    v_add_u32 v44, 192, v1
    v_mul_u32_u24 v45, 1639, v44
    v_lshrrev_b32 v45, 16, v45
    v_mul_u32_u24 v46, 40, v45
    v_sub_u32 v46, v44, v46
    v_lshl_add_u32 v46, v46, 4, s50
    v_and_b32 v47, 3, v45
    v_mul_u32_u24 v47, 1280, v47
    v_lshrrev_b32 v45, 2, v45
    v_mul_u32_u24 v45, s52, v45
    v_add3_u32 v211, v45, v46, v47
    v_add_u32 v44, 256, v1
    v_mul_u32_u24 v45, 1639, v44
    v_lshrrev_b32 v45, 16, v45
    v_mul_u32_u24 v46, 40, v45
    v_sub_u32 v46, v44, v46
    v_lshl_add_u32 v46, v46, 4, s50
    v_and_b32 v47, 3, v45
    v_mul_u32_u24 v47, 1280, v47
    v_lshrrev_b32 v45, 2, v45
    v_mul_u32_u24 v45, s52, v45
    v_add3_u32 v212, v45, v46, v47
    v_lshrrev_b32 v44, 2, v1
    v_mul_u32_u24 v44, 640, v44
    v_and_b32 v45, 3, v1
    v_lshl_add_u32 v44, v45, 3, v44
    s_mul_i32 s49, s42, 160
    s_add_u32 s49, s49, 114688
    v_add_u32 v213, s49, v44
    s_and_b32 s49, s70, 1
    s_lshl_b32 s49, s49, 2
    s_add_u32 s49, s49, s42
    s_mul_i32 s49, s49, s56
    s_add_u32 s49, s49, s57
    s_lshr_b32 s50, s70, 2
    s_mul_i32 s50, s50, 10240
    s_add_u32 s49, s49, s50
    s_bfe_u32 s50, s70, 0x10001
    s_lshl_b32 s50, s50, 10
    s_add_u32 s49, s49, s50
    v_add_u32 v214, s49, v2
    v_accvgpr_write_b32 a192, v208
    v_accvgpr_write_b32 a193, v209
    v_accvgpr_write_b32 a194, v210
    v_accvgpr_write_b32 a195, v211
    v_accvgpr_write_b32 a196, v212
    v_accvgpr_write_b32 a197, v213
    v_accvgpr_write_b32 a198, v214
    s_nop 1
L_notask_3:
    s_cmp_eq_u32 s41, 0
    s_cbranch_scc0 L_nopub_4
    s_waitcnt vmcnt(4)
    s_lshl_b32 s48, s96, 2
    v_mov_b32 v9, s48
    v_mov_b32 v10, 1
    s_mov_b64 exec, 1
    global_store_dword v9, v10, s[20:21] sc1
    s_mov_b64 exec, -1
    s_nop 0
L_nopub_4:
    s_add_u32 s63, s82, 491520
    buffer_load_dword v63, v55, s[84:87], s63 offen
    s_add_u32 m0, s69, 0
    s_add_u32 s63, s71, 0
    buffer_load_dwordx4 v248, s[28:31], s63 offen  lds
    s_add_u32 m0, s69, 1024
    s_add_u32 s63, s71, 0
    buffer_load_dwordx4 v249, s[28:31], s63 offen  lds
    s_add_u32 m0, s69, 2048
    s_add_u32 s63, s71, 0
    buffer_load_dwordx4 v250, s[28:31], s63 offen  lds
    s_add_u32 m0, s69, 3072
    s_add_u32 s63, s71, 0
    buffer_load_dwordx4 v251, s[28:31], s63 offen  lds
    s_add_u32 m0, s69, 4096
    s_add_u32 s63, s71, 20480
    buffer_load_dwordx4 v248, s[28:31], s63 offen  lds
    s_add_u32 m0, s69, 5120
    s_add_u32 s63, s71, 20480
    buffer_load_dwordx4 v249, s[28:31], s63 offen  lds
    s_add_u32 m0, s69, 6144
    s_add_u32 s63, s71, 20480
    buffer_load_dwordx4 v250, s[28:31], s63 offen  lds
    s_add_u32 m0, s69, 7168
    s_add_u32 s63, s71, 20480
    buffer_load_dwordx4 v251, s[28:31], s63 offen  lds
    s_add_u32 m0, s66, 81920
    s_add_u32 s63, s88, 245760
    buffer_load_dwordx4 v58, s[84:87], s63 offen lds
    s_add_u32 m0, s66, 86016
    s_add_u32 s63, s88, 261120
    buffer_load_dwordx4 v58, s[84:87], s63 offen lds
    s_add_u32 m0, s66, 90112
    s_add_u32 s63, s88, 368640
    buffer_load_dwordx4 v58, s[84:87], s63 offen lds
    s_add_u32 m0, s66, 94208
    s_add_u32 s63, s88, 384000
    buffer_load_dwordx4 v58, s[84:87], s63 offen lds
    s_add_u32 m0, s69, 8192
    s_add_u32 s63, s71, 256
    buffer_load_dwordx4 v248, s[28:31], s63 offen  lds
    s_add_u32 m0, s69, 9216
    s_add_u32 s63, s71, 256
    buffer_load_dwordx4 v249, s[28:31], s63 offen  lds
    s_add_u32 m0, s69, 10240
    s_add_u32 s63, s71, 256
    buffer_load_dwordx4 v250, s[28:31], s63 offen  lds
    s_add_u32 m0, s69, 11264
    s_add_u32 s63, s71, 256
    buffer_load_dwordx4 v251, s[28:31], s63 offen  lds
    s_add_u32 m0, s69, 12288
    s_add_u32 s63, s71, 20736
    buffer_load_dwordx4 v248, s[28:31], s63 offen  lds
    s_add_u32 m0, s69, 13312
    s_add_u32 s63, s71, 20736
    buffer_load_dwordx4 v249, s[28:31], s63 offen  lds
    s_add_u32 m0, s69, 14336
    s_add_u32 s63, s71, 20736
    buffer_load_dwordx4 v250, s[28:31], s63 offen  lds
    s_add_u32 m0, s69, 15360
    s_add_u32 s63, s71, 20736
    buffer_load_dwordx4 v251, s[28:31], s63 offen  lds
    s_waitcnt vmcnt(21)
    s_barrier
    ds_read_b64_tr_b16 v[96:97], v184 offset:40960
    ds_read_b64_tr_b16 v[98:99], v184 offset:45056
    ds_read_b64_tr_b16 v[100:101], v185 offset:40960
    ds_read_b64_tr_b16 v[102:103], v185 offset:45056
    ds_read_b64_tr_b16 v[64:65], v232 offset:40960
    ds_read_b64_tr_b16 v[66:67], v232 offset:45056
    ds_read_b64_tr_b16 v[68:69], v233 offset:40960
    ds_read_b64_tr_b16 v[70:71], v233 offset:45056
    ds_read_b64_tr_b16 v[72:73], v234 offset:40960
    ds_read_b64_tr_b16 v[74:75], v234 offset:45056
    ds_read_b64_tr_b16 v[76:77], v235 offset:40960
    ds_read_b64_tr_b16 v[78:79], v235 offset:45056
    ds_read_b64_tr_b16 v[80:81], v236 offset:40960
    ds_read_b64_tr_b16 v[82:83], v236 offset:45056
    ds_read_b64_tr_b16 v[84:85], v237 offset:40960
    s_waitcnt lgkmcnt(8)
    ds_read_b64_tr_b16 v[86:87], v237 offset:45056
    ds_read_b64_tr_b16 v[88:89], v238 offset:40960
    ds_read_b64_tr_b16 v[90:91], v238 offset:45056
    ds_read_b64_tr_b16 v[92:93], v239 offset:40960
    ds_read_b64_tr_b16 v[94:95], v239 offset:45056
    s_waitcnt vmcnt(16)
    ds_read_b128 a[0:3], v244 offset:0
    ds_read_b128 a[8:11], v245 offset:0
    s_waitcnt lgkmcnt(8)
    ds_read_b128 a[16:19], v246 offset:0
    ds_read_b128 a[24:27], v247 offset:0
    s_waitcnt vmcnt(12)
    ds_read_b128 a[4:7], v244 offset:4096
    ds_read_b128 a[12:15], v245 offset:4096
    ds_read_b128 a[20:23], v246 offset:4096
    ds_read_b128 a[28:31], v247 offset:4096
    s_waitcnt lgkmcnt(3)
    v_mfma_f32_16x16x32_bf16 v[176:179], v[228:231], v[96:99], 0
    ds_read_b64_tr_b16 v[104:105], v184 offset:0
    ds_read_b64_tr_b16 v[106:107], v184 offset:4096
    v_mfma_f32_16x16x32_bf16 v[180:183], v[228:231], v[100:103], 0
    ds_read_b64_tr_b16 v[108:109], v185 offset:0
    ds_read_b64_tr_b16 v[110:111], v185 offset:4096
    s_cmp_eq_u32 s40, 0
    s_cbranch_scc1 L_pack_5
L_packed_6:
    v_mfma_f32_16x16x32_bf16 v[112:115], v[64:67], a[0:3], 0
    s_add_u32 m0, s66, 98304
    s_add_u32 s63, s88, 491520
    buffer_load_dwordx4 v58, s[84:87], s63 offen lds
    ds_read_b64_tr_b16 a[160:161], v232 offset:0
    v_mfma_f32_16x16x32_bf16 v[116:119], v[64:67], a[4:7], 0
    ds_read_b64_tr_b16 a[162:163], v232 offset:4096
    ds_read_b64_tr_b16 a[164:165], v233 offset:0
    v_mfma_f32_16x16x32_bf16 v[120:123], v[68:71], a[0:3], 0
    ds_read_b64_tr_b16 a[166:167], v233 offset:4096
    ds_read_b64_tr_b16 a[168:169], v234 offset:0
    v_mfma_f32_16x16x32_bf16 v[124:127], v[68:71], a[4:7], 0
    ds_read_b64_tr_b16 a[170:171], v234 offset:4096
    ds_read_b64_tr_b16 a[172:173], v235 offset:0
    v_mfma_f32_16x16x32_bf16 v[128:131], v[72:75], a[0:3], 0
    ds_read_b64_tr_b16 a[174:175], v235 offset:4096
    s_waitcnt lgkmcnt(8)
    ds_read_b64_tr_b16 a[176:177], v236 offset:0
    v_mfma_f32_16x16x32_bf16 v[132:135], v[72:75], a[4:7], 0
    ds_read_b64_tr_b16 a[178:179], v236 offset:4096
    ds_read_b64_tr_b16 a[180:181], v237 offset:0
    v_mfma_f32_16x16x32_bf16 v[136:139], a[0:3], v[76:79], 0
    s_add_u32 m0, s69, 0
    s_add_u32 s63, s71, 512
    buffer_load_dwordx4 v248, s[28:31], s63 offen  lds
    ds_read_b64_tr_b16 a[182:183], v237 offset:4096
    v_mfma_f32_16x16x32_bf16 v[140:143], a[4:7], v[76:79], 0
    ds_read_b64_tr_b16 a[184:185], v238 offset:0
    ds_read_b64_tr_b16 a[186:187], v238 offset:4096
    v_mfma_f32_16x16x32_bf16 v[144:147], a[0:3], v[80:83], 0
    ds_read_b64_tr_b16 a[188:189], v239 offset:0
    s_waitcnt lgkmcnt(8)
    ds_read_b64_tr_b16 a[190:191], v239 offset:4096
    v_mfma_f32_16x16x32_bf16 v[148:151], a[4:7], v[80:83], 0
    v_mfma_f32_16x16x32_bf16 v[152:155], a[0:3], v[84:87], 0
    v_mfma_f32_16x16x32_bf16 v[156:159], a[4:7], v[84:87], 0
    s_add_u32 m0, s66, 102400
    s_add_u32 s63, s88, 506880
    buffer_load_dwordx4 v58, s[84:87], s63 offen lds
    v_mfma_f32_16x16x32_bf16 v[160:163], v[88:91], a[0:3], 0
    v_mfma_f32_16x16x32_bf16 v[164:167], v[88:91], a[4:7], 0
    v_mfma_f32_16x16x32_bf16 v[168:171], v[92:95], a[0:3], 0
    v_mfma_f32_16x16x32_bf16 v[172:175], v[92:95], a[4:7], 0
    v_mfma_f32_16x16x32_bf16 v[192:195], v[228:231], a[0:3], 0
    v_mfma_f32_16x16x32_bf16 v[196:199], a[0:3], a[0:3], 0
    s_add_u32 m0, s69, 1024
    s_add_u32 s63, s71, 512
    buffer_load_dwordx4 v249, s[28:31], s63 offen  lds
    v_mfma_f32_16x16x32_bf16 v[200:203], v[228:231], a[4:7], 0
    v_mfma_f32_16x16x32_bf16 v[204:207], a[4:7], a[4:7], 0
    s_waitcnt vmcnt(12)
    s_barrier
    v_mfma_f32_16x16x32_bf16 v[176:179], v[228:231], v[104:107], v[176:179]
    ds_read_b64_tr_b16 v[96:97], v184 offset:8192
    ds_read_b64_tr_b16 v[98:99], v184 offset:12288
    v_mfma_f32_16x16x32_bf16 v[180:183], v[228:231], v[108:111], v[180:183]
    ds_read_b64_tr_b16 v[100:101], v185 offset:8192
    ds_read_b64_tr_b16 v[102:103], v185 offset:12288
    s_cmp_eq_u32 s40, 1
    s_cbranch_scc1 L_pack_7
L_packed_8:
    v_mfma_f32_16x16x32_bf16 v[112:115], a[160:163], a[8:11], v[112:115]
    s_add_u32 m0, s66, 114688
    s_add_u32 s63, s88, 614400
    buffer_load_dwordx4 v58, s[84:87], s63 offen lds
    ds_read_b64_tr_b16 v[64:65], v232 offset:8192
    v_mfma_f32_16x16x32_bf16 v[116:119], a[160:163], a[12:15], v[116:119]
    ds_read_b64_tr_b16 v[66:67], v232 offset:12288
    s_waitcnt lgkmcnt(8)
    ds_read_b64_tr_b16 v[68:69], v233 offset:8192
    v_mfma_f32_16x16x32_bf16 v[120:123], a[164:167], a[8:11], v[120:123]
    ds_read_b64_tr_b16 v[70:71], v233 offset:12288
    ds_read_b64_tr_b16 v[72:73], v234 offset:8192
    v_mfma_f32_16x16x32_bf16 v[124:127], a[164:167], a[12:15], v[124:127]
    ds_read_b64_tr_b16 v[74:75], v234 offset:12288
    ds_read_b64_tr_b16 v[76:77], v235 offset:8192
    v_mfma_f32_16x16x32_bf16 v[128:131], a[168:171], a[8:11], v[128:131]
    s_add_u32 m0, s69, 2048
    s_add_u32 s63, s71, 512
    buffer_load_dwordx4 v250, s[28:31], s63 offen  lds
    ds_read_b64_tr_b16 v[78:79], v235 offset:12288
    v_mfma_f32_16x16x32_bf16 v[132:135], a[168:171], a[12:15], v[132:135]
    ds_read_b64_tr_b16 v[80:81], v236 offset:8192
    s_waitcnt lgkmcnt(8)
    ds_read_b64_tr_b16 v[82:83], v236 offset:12288
    v_mfma_f32_16x16x32_bf16 v[136:139], a[8:11], a[172:175], v[136:139]
    ds_read_b64_tr_b16 v[84:85], v237 offset:8192
    ds_read_b64_tr_b16 v[86:87], v237 offset:12288
    v_mfma_f32_16x16x32_bf16 v[140:143], a[12:15], a[172:175], v[140:143]
    ds_read_b64_tr_b16 v[88:89], v238 offset:8192
    ds_read_b64_tr_b16 v[90:91], v238 offset:12288
    v_mfma_f32_16x16x32_bf16 v[144:147], a[8:11], a[176:179], v[144:147]
    ds_read_b64_tr_b16 v[92:93], v239 offset:8192
    ds_read_b64_tr_b16 v[94:95], v239 offset:12288
    v_mfma_f32_16x16x32_bf16 v[148:151], a[12:15], a[176:179], v[148:151]
    s_add_u32 m0, s66, 118784
    s_add_u32 s63, s88, 629760
    buffer_load_dwordx4 v58, s[84:87], s63 offen lds
    v_mfma_f32_16x16x32_bf16 v[152:155], a[8:11], a[180:183], v[152:155]
    v_mfma_f32_16x16x32_bf16 v[156:159], a[12:15], a[180:183], v[156:159]
    v_mfma_f32_16x16x32_bf16 v[160:163], a[184:187], a[8:11], v[160:163]
    v_mfma_f32_16x16x32_bf16 v[164:167], a[184:187], a[12:15], v[164:167]
    s_add_u32 m0, s69, 3072
    s_add_u32 s63, s71, 512
    buffer_load_dwordx4 v251, s[28:31], s63 offen  lds
    v_mfma_f32_16x16x32_bf16 v[168:171], a[188:191], a[8:11], v[168:171]
    v_mfma_f32_16x16x32_bf16 v[172:175], a[188:191], a[12:15], v[172:175]
    v_mfma_f32_16x16x32_bf16 v[192:195], v[228:231], a[8:11], v[192:195]
    v_mfma_f32_16x16x32_bf16 v[196:199], a[8:11], a[8:11], v[196:199]
    s_add_u32 s63, s82, 983040
    buffer_load_dword v63, v55, s[84:87], s63 offen
    v_mfma_f32_16x16x32_bf16 v[200:203], v[228:231], a[12:15], v[200:203]
    v_mfma_f32_16x16x32_bf16 v[204:207], a[12:15], a[12:15], v[204:207]
    s_waitcnt lgkmcnt(10)
    v_mfma_f32_16x16x32_bf16 v[176:179], v[228:231], v[96:99], v[176:179]
    ds_read_b64_tr_b16 v[104:105], v184 offset:16384
    ds_read_b64_tr_b16 v[106:107], v184 offset:20480
    v_mfma_f32_16x16x32_bf16 v[180:183], v[228:231], v[100:103], v[180:183]
    s_add_u32 m0, s66, 106496
    s_add_u32 s63, s88, 737280
    buffer_load_dwordx4 v58, s[84:87], s63 offen lds
    ds_read_b64_tr_b16 v[108:109], v185 offset:16384
    s_cmp_eq_u32 s40, 2
    s_cbranch_scc1 L_pack_9
L_packed_10:
    v_mfma_f32_16x16x32_bf16 v[112:115], v[64:67], a[16:19], v[112:115]
    ds_read_b64_tr_b16 v[110:111], v185 offset:20480
    ds_read_b64_tr_b16 a[160:161], v232 offset:16384
    v_mfma_f32_16x16x32_bf16 v[116:119], v[64:67], a[20:23], v[116:119]
    s_waitcnt lgkmcnt(8)
    ds_read_b64_tr_b16 a[162:163], v232 offset:20480
    ds_read_b64_tr_b16 a[164:165], v233 offset:16384
    v_mfma_f32_16x16x32_bf16 v[120:123], v[68:71], a[16:19], v[120:123]
    ds_read_b64_tr_b16 a[166:167], v233 offset:20480
    ds_read_b64_tr_b16 a[168:169], v234 offset:16384
    v_mfma_f32_16x16x32_bf16 v[124:127], v[68:71], a[20:23], v[124:127]
    s_add_u32 m0, s69, 4096
    s_add_u32 s63, s71, 20992
    buffer_load_dwordx4 v248, s[28:31], s63 offen  lds
    ds_read_b64_tr_b16 a[170:171], v234 offset:20480
    v_mfma_f32_16x16x32_bf16 v[128:131], v[72:75], a[16:19], v[128:131]
    ds_read_b64_tr_b16 a[172:173], v235 offset:16384
    ds_read_b64_tr_b16 a[174:175], v235 offset:20480
    v_mfma_f32_16x16x32_bf16 v[132:135], v[72:75], a[20:23], v[132:135]
    s_waitcnt lgkmcnt(8)
    ds_read_b64_tr_b16 a[176:177], v236 offset:16384
    ds_read_b64_tr_b16 a[178:179], v236 offset:20480
    v_mfma_f32_16x16x32_bf16 v[136:139], a[16:19], v[76:79], v[136:139]
    ds_read_b64_tr_b16 a[180:181], v237 offset:16384
    ds_read_b64_tr_b16 a[182:183], v237 offset:20480
    v_mfma_f32_16x16x32_bf16 v[140:143], a[20:23], v[76:79], v[140:143]
    s_add_u32 m0, s66, 110592
    s_add_u32 s63, s88, 752640
    buffer_load_dwordx4 v58, s[84:87], s63 offen lds
    ds_read_b64_tr_b16 a[184:185], v238 offset:16384
    v_mfma_f32_16x16x32_bf16 v[144:147], a[16:19], v[80:83], v[144:147]
    ds_read_b64_tr_b16 a[186:187], v238 offset:20480
    ds_read_b64_tr_b16 a[188:189], v239 offset:16384
    v_mfma_f32_16x16x32_bf16 v[148:151], a[20:23], v[80:83], v[148:151]
    s_waitcnt lgkmcnt(8)
    ds_read_b64_tr_b16 a[190:191], v239 offset:20480
    s_waitcnt vmcnt(16)
    ds_read_b128 a[32:35], v244 offset:8192
    ds_read_b128 a[40:43], v245 offset:8192
    ds_read_b128 a[48:51], v246 offset:8192
    ds_read_b128 a[56:59], v247 offset:8192
    v_mfma_f32_16x16x32_bf16 v[152:155], a[16:19], v[84:87], v[152:155]
    s_add_u32 m0, s69, 5120
    s_add_u32 s63, s71, 20992
    buffer_load_dwordx4 v249, s[28:31], s63 offen  lds
    v_mfma_f32_16x16x32_bf16 v[156:159], a[20:23], v[84:87], v[156:159]
    v_mfma_f32_16x16x32_bf16 v[160:163], v[88:91], a[16:19], v[160:163]
    v_mfma_f32_16x16x32_bf16 v[164:167], v[88:91], a[20:23], v[164:167]
    v_mfma_f32_16x16x32_bf16 v[168:171], v[92:95], a[16:19], v[168:171]
    s_add_u32 m0, s80, 139264
    s_nop 0
    buffer_load_dwordx4 v42, s[36:39], 0 offen nt lds
    v_mfma_f32_16x16x32_bf16 v[172:175], v[92:95], a[20:23], v[172:175]
    v_mfma_f32_16x16x32_bf16 v[192:195], v[228:231], a[16:19], v[192:195]
    v_mfma_f32_16x16x32_bf16 v[196:199], a[16:19], a[16:19], v[196:199]
    v_mfma_f32_16x16x32_bf16 v[200:203], v[228:231], a[20:23], v[200:203]
    s_add_u32 m0, s80, 140288
    s_nop 0
    buffer_load_dwordx4 v43, s[36:39], 0 offen nt lds
    v_mfma_f32_16x16x32_bf16 v[204:207], a[20:23], a[20:23], v[204:207]
    s_waitcnt vmcnt(8)
    s_barrier
    v_mfma_f32_16x16x32_bf16 v[176:179], v[228:231], v[104:107], v[176:179]
    ds_read_b64_tr_b16 v[96:97], v184 offset:24576
    ds_read_b64_tr_b16 v[98:99], v184 offset:28672
    v_mfma_f32_16x16x32_bf16 v[180:183], v[228:231], v[108:111], v[180:183]
    s_add_u32 m0, s66, 73728
    s_add_u32 s63, s88, 860160
    buffer_load_dwordx4 v58, s[84:87], s63 offen lds
    s_waitcnt lgkmcnt(8)
    ds_read_b64_tr_b16 v[100:101], v185 offset:24576
    s_cmp_eq_u32 s40, 3
    s_cbranch_scc1 L_pack_11
L_packed_12:
    v_mfma_f32_16x16x32_bf16 v[112:115], a[160:163], a[24:27], v[112:115]
    ds_read_b64_tr_b16 v[102:103], v185 offset:28672
    ds_read_b64_tr_b16 v[64:65], v232 offset:24576
    v_mfma_f32_16x16x32_bf16 v[116:119], a[160:163], a[28:31], v[116:119]
    ds_read_b64_tr_b16 v[66:67], v232 offset:28672
    ds_read_b64_tr_b16 v[68:69], v233 offset:24576
    v_mfma_f32_16x16x32_bf16 v[120:123], a[164:167], a[24:27], v[120:123]
    ds_read_b64_tr_b16 v[70:71], v233 offset:28672
    ds_read_b64_tr_b16 v[72:73], v234 offset:24576
    v_mfma_f32_16x16x32_bf16 v[124:127], a[164:167], a[28:31], v[124:127]
    s_add_u32 m0, s69, 6144
    s_add_u32 s63, s71, 20992
    buffer_load_dwordx4 v250, s[28:31], s63 offen  lds
    s_waitcnt lgkmcnt(8)
    ds_read_b64_tr_b16 v[74:75], v234 offset:28672
    v_mfma_f32_16x16x32_bf16 v[128:131], a[168:171], a[24:27], v[128:131]
    ds_read_b64_tr_b16 v[76:77], v235 offset:24576
    ds_read_b64_tr_b16 v[78:79], v235 offset:28672
    v_mfma_f32_16x16x32_bf16 v[132:135], a[168:171], a[28:31], v[132:135]
    ds_read_b64_tr_b16 v[80:81], v236 offset:24576
    ds_read_b64_tr_b16 v[82:83], v236 offset:28672
    v_mfma_f32_16x16x32_bf16 v[136:139], a[24:27], a[172:175], v[136:139]
    ds_read_b64_tr_b16 v[84:85], v237 offset:24576
    ds_read_b64_tr_b16 v[86:87], v237 offset:28672
    v_mfma_f32_16x16x32_bf16 v[140:143], a[28:31], a[172:175], v[140:143]
    s_add_u32 m0, s66, 77824
    s_add_u32 s63, s88, 875520
    buffer_load_dwordx4 v58, s[84:87], s63 offen lds
    s_waitcnt lgkmcnt(8)
    ds_read_b64_tr_b16 v[88:89], v238 offset:24576
    v_mfma_f32_16x16x32_bf16 v[144:147], a[24:27], a[176:179], v[144:147]
    ds_read_b64_tr_b16 v[90:91], v238 offset:28672
    ds_read_b64_tr_b16 v[92:93], v239 offset:24576
    v_mfma_f32_16x16x32_bf16 v[148:151], a[28:31], a[176:179], v[148:151]
    ds_read_b64_tr_b16 v[94:95], v239 offset:28672
    ds_read_b128 a[36:39], v244 offset:12288
    ds_read_b128 a[44:47], v245 offset:12288
    ds_read_b128 a[52:55], v246 offset:12288
    s_waitcnt lgkmcnt(8)
    ds_read_b128 a[60:63], v247 offset:12288
    v_mfma_f32_16x16x32_bf16 v[152:155], a[24:27], a[180:183], v[152:155]
    s_add_u32 m0, s69, 7168
    s_add_u32 s63, s71, 20992
    buffer_load_dwordx4 v251, s[28:31], s63 offen  lds
    v_mfma_f32_16x16x32_bf16 v[156:159], a[28:31], a[180:183], v[156:159]
    v_mfma_f32_16x16x32_bf16 v[160:163], a[184:187], a[24:27], v[160:163]
    v_mfma_f32_16x16x32_bf16 v[164:167], a[184:187], a[28:31], v[164:167]
    v_mfma_f32_16x16x32_bf16 v[168:171], a[188:191], a[24:27], v[168:171]
    s_add_u32 m0, s80, 141312
    s_nop 0
    buffer_load_dwordx4 v57, s[36:39], 0 offen nt lds
    v_mfma_f32_16x16x32_bf16 v[172:175], a[188:191], a[28:31], v[172:175]
    v_mfma_f32_16x16x32_bf16 v[192:195], v[228:231], a[24:27], v[192:195]
    v_mfma_f32_16x16x32_bf16 v[196:199], a[24:27], a[24:27], v[196:199]
    v_mfma_f32_16x16x32_bf16 v[200:203], v[228:231], a[28:31], v[200:203]
    s_add_u32 m0, s80, 142336
    s_nop 0
    buffer_load_dwordx4 v60, s[36:39], 0 offen nt lds
    v_mfma_f32_16x16x32_bf16 v[204:207], a[28:31], a[28:31], v[204:207]
    s_waitcnt lgkmcnt(3)
    v_mfma_f32_16x16x32_bf16 v[176:179], v[228:231], v[96:99], v[176:179]
    ds_read_b64_tr_b16 v[104:105], v184 offset:40960
    ds_read_b64_tr_b16 v[106:107], v184 offset:45056
    v_mfma_f32_16x16x32_bf16 v[180:183], v[228:231], v[100:103], v[180:183]
    s_add_u32 m0, s66, 81920
    s_add_u32 s63, s88, 983040
    buffer_load_dwordx4 v58, s[84:87], s63 offen lds
    ds_read_b64_tr_b16 v[108:109], v185 offset:40960
    s_cmp_eq_u32 s40, 4
    s_cbranch_scc1 L_pack_13
L_packed_14:
    v_mfma_f32_16x16x32_bf16 v[112:115], v[64:67], a[32:35], v[112:115]
    ds_read_b64_tr_b16 v[110:111], v185 offset:45056
    ds_read_b64_tr_b16 a[160:161], v232 offset:40960
    v_mfma_f32_16x16x32_bf16 v[116:119], v[64:67], a[36:39], v[116:119]
    ds_read_b64_tr_b16 a[162:163], v232 offset:45056
    ds_read_b64_tr_b16 a[164:165], v233 offset:40960
    v_mfma_f32_16x16x32_bf16 v[120:123], v[68:71], a[32:35], v[120:123]
    ds_read_b64_tr_b16 a[166:167], v233 offset:45056
    ds_read_b64_tr_b16 a[168:169], v234 offset:40960
    v_mfma_f32_16x16x32_bf16 v[124:127], v[68:71], a[36:39], v[124:127]
    s_add_u32 m0, s69, 8192
    s_add_u32 s63, s71, 768
    buffer_load_dwordx4 v248, s[28:31], s63 offen  lds
    ds_read_b64_tr_b16 a[170:171], v234 offset:45056
    v_mfma_f32_16x16x32_bf16 v[128:131], v[72:75], a[32:35], v[128:131]
    ds_read_b64_tr_b16 a[172:173], v235 offset:40960
    ds_read_b64_tr_b16 a[174:175], v235 offset:45056
    v_mfma_f32_16x16x32_bf16 v[132:135], v[72:75], a[36:39], v[132:135]
    s_waitcnt lgkmcnt(8)
    ds_read_b64_tr_b16 a[176:177], v236 offset:40960
    ds_read_b64_tr_b16 a[178:179], v236 offset:45056
    v_mfma_f32_16x16x32_bf16 v[136:139], a[32:35], v[76:79], v[136:139]
    ds_read_b64_tr_b16 a[180:181], v237 offset:40960
    ds_read_b64_tr_b16 a[182:183], v237 offset:45056
    v_mfma_f32_16x16x32_bf16 v[140:143], a[36:39], v[76:79], v[140:143]
    s_add_u32 m0, s66, 86016
    s_add_u32 s63, s88, 998400
    buffer_load_dwordx4 v58, s[84:87], s63 offen lds
    ds_read_b64_tr_b16 a[184:185], v238 offset:40960
    v_mfma_f32_16x16x32_bf16 v[144:147], a[32:35], v[80:83], v[144:147]
    ds_read_b64_tr_b16 a[186:187], v238 offset:45056
    ds_read_b64_tr_b16 a[188:189], v239 offset:40960
    v_mfma_f32_16x16x32_bf16 v[148:151], a[36:39], v[80:83], v[148:151]
    s_waitcnt lgkmcnt(8)
    ds_read_b64_tr_b16 a[190:191], v239 offset:45056
    v_mfma_f32_16x16x32_bf16 v[152:155], a[32:35], v[84:87], v[152:155]
    s_add_u32 m0, s69, 9216
    s_add_u32 s63, s71, 768
    buffer_load_dwordx4 v249, s[28:31], s63 offen  lds
    v_mfma_f32_16x16x32_bf16 v[156:159], a[36:39], v[84:87], v[156:159]
    v_mfma_f32_16x16x32_bf16 v[160:163], v[88:91], a[32:35], v[160:163]
    v_mfma_f32_16x16x32_bf16 v[164:167], v[88:91], a[36:39], v[164:167]
    v_mfma_f32_16x16x32_bf16 v[168:171], v[92:95], a[32:35], v[168:171]
    s_add_u32 m0, s80, 143360
    s_nop 0
    buffer_load_dwordx4 v61, s[36:39], 0 offen nt lds
    v_mfma_f32_16x16x32_bf16 v[172:175], v[92:95], a[36:39], v[172:175]
    v_mfma_f32_16x16x32_bf16 v[192:195], v[228:231], a[32:35], v[192:195]
    v_mfma_f32_16x16x32_bf16 v[196:199], a[32:35], a[32:35], v[196:199]
    v_mfma_f32_16x16x32_bf16 v[200:203], v[228:231], a[36:39], v[200:203]
    s_add_u32 s63, s82, 1474560
    buffer_load_dword v63, v55, s[84:87], s63 offen
    v_mfma_f32_16x16x32_bf16 v[204:207], a[36:39], a[36:39], v[204:207]
    s_waitcnt vmcnt(9)
    s_barrier
    v_mfma_f32_16x16x32_bf16 v[176:179], v[228:231], v[104:107], v[176:179]
    ds_read_b64_tr_b16 v[96:97], v184 offset:32768
    ds_read_b64_tr_b16 v[98:99], v184 offset:36864
    v_mfma_f32_16x16x32_bf16 v[180:183], v[228:231], v[108:111], v[180:183]
    ds_read_b64_tr_b16 v[100:101], v185 offset:32768
    ds_read_b64_tr_b16 v[102:103], v185 offset:36864
    s_cmp_eq_u32 s40, 5
    s_cbranch_scc1 L_pack_15
L_packed_16:
    v_mfma_f32_16x16x32_bf16 v[112:115], a[160:163], a[40:43], v[112:115]
    s_add_u32 m0, s66, 90112
    s_add_u32 s63, s88, 1105920
    buffer_load_dwordx4 v58, s[84:87], s63 offen lds
    ds_read_b64_tr_b16 v[64:65], v232 offset:32768
    v_mfma_f32_16x16x32_bf16 v[116:119], a[160:163], a[44:47], v[116:119]
    ds_read_b64_tr_b16 v[66:67], v232 offset:36864
    s_waitcnt lgkmcnt(8)
    ds_read_b64_tr_b16 v[68:69], v233 offset:32768
    v_mfma_f32_16x16x32_bf16 v[120:123], a[164:167], a[40:43], v[120:123]
    ds_read_b64_tr_b16 v[70:71], v233 offset:36864
    ds_read_b64_tr_b16 v[72:73], v234 offset:32768
    v_mfma_f32_16x16x32_bf16 v[124:127], a[164:167], a[44:47], v[124:127]
    ds_read_b64_tr_b16 v[74:75], v234 offset:36864
    ds_read_b64_tr_b16 v[76:77], v235 offset:32768
    v_mfma_f32_16x16x32_bf16 v[128:131], a[168:171], a[40:43], v[128:131]
    ds_read_b64_tr_b16 v[78:79], v235 offset:36864
    ds_read_b64_tr_b16 v[80:81], v236 offset:32768
    v_mfma_f32_16x16x32_bf16 v[132:135], a[168:171], a[44:47], v[132:135]
    s_waitcnt lgkmcnt(8)
    ds_read_b64_tr_b16 v[82:83], v236 offset:36864
    ds_read_b64_tr_b16 v[84:85], v237 offset:32768
    v_mfma_f32_16x16x32_bf16 v[136:139], a[40:43], a[172:175], v[136:139]
    s_add_u32 m0, s69, 10240
    s_add_u32 s63, s71, 768
    buffer_load_dwordx4 v250, s[28:31], s63 offen  lds
    ds_read_b64_tr_b16 v[86:87], v237 offset:36864
    v_mfma_f32_16x16x32_bf16 v[140:143], a[44:47], a[172:175], v[140:143]
    ds_read_b64_tr_b16 v[88:89], v238 offset:32768
    ds_read_b64_tr_b16 v[90:91], v238 offset:36864
    v_mfma_f32_16x16x32_bf16 v[144:147], a[40:43], a[176:179], v[144:147]
    ds_read_b64_tr_b16 v[92:93], v239 offset:32768
    ds_read_b64_tr_b16 v[94:95], v239 offset:36864
    v_mfma_f32_16x16x32_bf16 v[148:151], a[44:47], a[176:179], v[148:151]
    s_waitcnt lgkmcnt(8)
    ds_read_b128 a[64:67], v244 offset:0
    ds_read_b128 a[72:75], v245 offset:0
    ds_read_b128 a[80:83], v246 offset:0
    ds_read_b128 a[88:91], v247 offset:0
    v_mfma_f32_16x16x32_bf16 v[152:155], a[40:43], a[180:183], v[152:155]
    v_mfma_f32_16x16x32_bf16 v[156:159], a[44:47], a[180:183], v[156:159]
    s_add_u32 m0, s66, 94208
    s_add_u32 s63, s88, 1121280
    buffer_load_dwordx4 v58, s[84:87], s63 offen lds
    v_mfma_f32_16x16x32_bf16 v[160:163], a[184:187], a[40:43], v[160:163]
    v_mfma_f32_16x16x32_bf16 v[164:167], a[184:187], a[44:47], v[164:167]
    v_mfma_f32_16x16x32_bf16 v[168:171], a[188:191], a[40:43], v[168:171]
    v_mfma_f32_16x16x32_bf16 v[172:175], a[188:191], a[44:47], v[172:175]
    v_mfma_f32_16x16x32_bf16 v[192:195], v[228:231], a[40:43], v[192:195]
    v_mfma_f32_16x16x32_bf16 v[196:199], a[40:43], a[40:43], v[196:199]
    s_add_u32 m0, s69, 11264
    s_add_u32 s63, s71, 768
    buffer_load_dwordx4 v251, s[28:31], s63 offen  lds
    v_mfma_f32_16x16x32_bf16 v[200:203], v[228:231], a[44:47], v[200:203]
    v_mfma_f32_16x16x32_bf16 v[204:207], a[44:47], a[44:47], v[204:207]
    v_mfma_f32_16x16x32_bf16 v[176:179], v[228:231], v[96:99], v[176:179]
    ds_read_b64_tr_b16 v[104:105], v184 offset:0
    ds_read_b64_tr_b16 v[106:107], v184 offset:4096
    v_mfma_f32_16x16x32_bf16 v[180:183], v[228:231], v[100:103], v[180:183]
    ds_read_b64_tr_b16 v[108:109], v185 offset:0
    s_waitcnt lgkmcnt(8)
    ds_read_b64_tr_b16 v[110:111], v185 offset:4096
    s_cmp_eq_u32 s40, 6
    s_cbranch_scc1 L_pack_17
L_packed_18:
    v_mfma_f32_16x16x32_bf16 v[112:115], v[64:67], a[48:51], v[112:115]
    s_add_u32 m0, s66, 98304
    s_add_u32 s63, s88, 1228800
    buffer_load_dwordx4 v58, s[84:87], s63 offen lds
    ds_read_b64_tr_b16 a[160:161], v232 offset:0
    v_mfma_f32_16x16x32_bf16 v[116:119], v[64:67], a[52:55], v[116:119]
    ds_read_b64_tr_b16 a[162:163], v232 offset:4096
    ds_read_b64_tr_b16 a[164:165], v233 offset:0
    v_mfma_f32_16x16x32_bf16 v[120:123], v[68:71], a[48:51], v[120:123]
    ds_read_b64_tr_b16 a[166:167], v233 offset:4096
    ds_read_b64_tr_b16 a[168:169], v234 offset:0
    v_mfma_f32_16x16x32_bf16 v[124:127], v[68:71], a[52:55], v[124:127]
    ds_read_b64_tr_b16 a[170:171], v234 offset:4096
    s_waitcnt lgkmcnt(8)
    ds_read_b64_tr_b16 a[172:173], v235 offset:0
    v_mfma_f32_16x16x32_bf16 v[128:131], v[72:75], a[48:51], v[128:131]
    ds_read_b64_tr_b16 a[174:175], v235 offset:4096
    ds_read_b64_tr_b16 a[176:177], v236 offset:0
    v_mfma_f32_16x16x32_bf16 v[132:135], v[72:75], a[52:55], v[132:135]
    ds_read_b64_tr_b16 a[178:179], v236 offset:4096
    ds_read_b64_tr_b16 a[180:181], v237 offset:0
    v_mfma_f32_16x16x32_bf16 v[136:139], a[48:51], v[76:79], v[136:139]
    s_add_u32 m0, s69, 12288
    s_add_u32 s63, s71, 21248
    buffer_load_dwordx4 v248, s[28:31], s63 offen  lds
    ds_read_b64_tr_b16 a[182:183], v237 offset:4096
    v_mfma_f32_16x16x32_bf16 v[140:143], a[52:55], v[76:79], v[140:143]
    ds_read_b64_tr_b16 a[184:185], v238 offset:0
    s_waitcnt lgkmcnt(8)
    ds_read_b64_tr_b16 a[186:187], v238 offset:4096
    v_mfma_f32_16x16x32_bf16 v[144:147], a[48:51], v[80:83], v[144:147]
    ds_read_b64_tr_b16 a[188:189], v239 offset:0
    ds_read_b64_tr_b16 a[190:191], v239 offset:4096
    v_mfma_f32_16x16x32_bf16 v[148:151], a[52:55], v[80:83], v[148:151]
    s_waitcnt vmcnt(14)
    ds_read_b128 a[68:71], v244 offset:4096
    ds_read_b128 a[76:79], v245 offset:4096
    ds_read_b128 a[84:87], v246 offset:4096
    ds_read_b128 a[92:95], v247 offset:4096
    v_mfma_f32_16x16x32_bf16 v[152:155], a[48:51], v[84:87], v[152:155]
    v_mfma_f32_16x16x32_bf16 v[156:159], a[52:55], v[84:87], v[156:159]
    s_add_u32 m0, s66, 102400
    s_add_u32 s63, s88, 1244160
    buffer_load_dwordx4 v58, s[84:87], s63 offen lds
    v_mfma_f32_16x16x32_bf16 v[160:163], v[88:91], a[48:51], v[160:163]
    v_mfma_f32_16x16x32_bf16 v[164:167], v[88:91], a[52:55], v[164:167]
    v_mfma_f32_16x16x32_bf16 v[168:171], v[92:95], a[48:51], v[168:171]
    v_mfma_f32_16x16x32_bf16 v[172:175], v[92:95], a[52:55], v[172:175]
    v_mfma_f32_16x16x32_bf16 v[192:195], v[228:231], a[48:51], v[192:195]
    v_mfma_f32_16x16x32_bf16 v[196:199], a[48:51], a[48:51], v[196:199]
    s_add_u32 m0, s69, 13312
    s_add_u32 s63, s71, 21248
    buffer_load_dwordx4 v249, s[28:31], s63 offen  lds
    v_mfma_f32_16x16x32_bf16 v[200:203], v[228:231], a[52:55], v[200:203]
    v_mfma_f32_16x16x32_bf16 v[204:207], a[52:55], a[52:55], v[204:207]
    s_waitcnt vmcnt(5)
    s_barrier
    s_waitcnt lgkmcnt(14)
    v_mfma_f32_16x16x32_bf16 v[176:179], v[228:231], v[104:107], v[176:179]
    ds_read_b64_tr_b16 v[96:97], v184 offset:8192
    s_waitcnt lgkmcnt(8)
    ds_read_b64_tr_b16 v[98:99], v184 offset:12288
    v_mfma_f32_16x16x32_bf16 v[180:183], v[228:231], v[108:111], v[180:183]
    ds_read_b64_tr_b16 v[100:101], v185 offset:8192
    ds_read_b64_tr_b16 v[102:103], v185 offset:12288
    s_cmp_eq_u32 s40, 7
    s_cbranch_scc1 L_pack_19
L_packed_20:
    v_mfma_f32_16x16x32_bf16 v[112:115], a[160:163], a[56:59], v[112:115]
    s_add_u32 m0, s66, 114688
    s_add_u32 s63, s88, 1351680
    buffer_load_dwordx4 v58, s[84:87], s63 offen lds
    ds_read_b64_tr_b16 v[64:65], v232 offset:8192
    v_mfma_f32_16x16x32_bf16 v[116:119], a[160:163], a[60:63], v[116:119]
    ds_read_b64_tr_b16 v[66:67], v232 offset:12288
    ds_read_b64_tr_b16 v[68:69], v233 offset:8192
    v_mfma_f32_16x16x32_bf16 v[120:123], a[164:167], a[56:59], v[120:123]
    ds_read_b64_tr_b16 v[70:71], v233 offset:12288
    s_waitcnt lgkmcnt(8)
    ds_read_b64_tr_b16 v[72:73], v234 offset:8192
    v_mfma_f32_16x16x32_bf16 v[124:127], a[164:167], a[60:63], v[124:127]
    ds_read_b64_tr_b16 v[74:75], v234 offset:12288
    ds_read_b64_tr_b16 v[76:77], v235 offset:8192
    v_mfma_f32_16x16x32_bf16 v[128:131], a[168:171], a[56:59], v[128:131]
    ds_read_b64_tr_b16 v[78:79], v235 offset:12288
    ds_read_b64_tr_b16 v[80:81], v236 offset:8192
    v_mfma_f32_16x16x32_bf16 v[132:135], a[168:171], a[60:63], v[132:135]
    ds_read_b64_tr_b16 v[82:83], v236 offset:12288
    ds_read_b64_tr_b16 v[84:85], v237 offset:8192
    v_mfma_f32_16x16x32_bf16 v[136:139], a[56:59], a[172:175], v[136:139]
    s_add_u32 m0, s69, 14336
    s_add_u32 s63, s71, 21248
    buffer_load_dwordx4 v250, s[28:31], s63 offen  lds
    s_waitcnt lgkmcnt(8)
    ds_read_b64_tr_b16 v[86:87], v237 offset:12288
    v_mfma_f32_16x16x32_bf16 v[140:143], a[60:63], a[172:175], v[140:143]
    ds_read_b64_tr_b16 v[88:89], v238 offset:8192
    ds_read_b64_tr_b16 v[90:91], v238 offset:12288
    v_mfma_f32_16x16x32_bf16 v[144:147], a[56:59], a[176:179], v[144:147]
    ds_read_b64_tr_b16 v[92:93], v239 offset:8192
    ds_read_b64_tr_b16 v[94:95], v239 offset:12288
    v_mfma_f32_16x16x32_bf16 v[148:151], a[60:63], a[176:179], v[148:151]
    v_mfma_f32_16x16x32_bf16 v[152:155], a[56:59], a[180:183], v[152:155]
    v_mfma_f32_16x16x32_bf16 v[156:159], a[60:63], a[180:183], v[156:159]
    s_add_u32 m0, s66, 118784
    s_add_u32 s63, s88, 1367040
    buffer_load_dwordx4 v58, s[84:87], s63 offen lds
    v_mfma_f32_16x16x32_bf16 v[160:163], a[184:187], a[56:59], v[160:163]
    v_mfma_f32_16x16x32_bf16 v[164:167], a[184:187], a[60:63], v[164:167]
    v_mfma_f32_16x16x32_bf16 v[168:171], a[188:191], a[56:59], v[168:171]
    v_mfma_f32_16x16x32_bf16 v[172:175], a[188:191], a[60:63], v[172:175]
    v_mfma_f32_16x16x32_bf16 v[192:195], v[228:231], a[56:59], v[192:195]
    v_mfma_f32_16x16x32_bf16 v[196:199], a[56:59], a[56:59], v[196:199]
    s_add_u32 m0, s69, 15360
    s_add_u32 s63, s71, 21248
    buffer_load_dwordx4 v251, s[28:31], s63 offen  lds
    v_mfma_f32_16x16x32_bf16 v[200:203], v[228:231], a[60:63], v[200:203]
    v_mfma_f32_16x16x32_bf16 v[204:207], a[60:63], a[60:63], v[204:207]
    s_cmp_lg_u32 s42, 0
    s_nop 6
    s_cbranch_scc1 L_w0_21
    global_load_dword v59, v54, s[20:21] sc1
    s_nop 0
L_w0_21:
    s_waitcnt lgkmcnt(10)
    v_mfma_f32_16x16x32_bf16 v[176:179], v[228:231], v[96:99], v[176:179]
    ds_read_b64_tr_b16 v[104:105], v184 offset:16384
    ds_read_b64_tr_b16 v[106:107], v184 offset:20480
    v_mfma_f32_16x16x32_bf16 v[180:183], v[228:231], v[100:103], v[180:183]
    ds_read_b64_tr_b16 v[108:109], v185 offset:16384
    ds_read_b64_tr_b16 v[110:111], v185 offset:20480
    s_cmp_eq_u32 s40, 8
    s_cbranch_scc1 L_pack_22
L_packed_23:
    v_mfma_f32_16x16x32_bf16 v[112:115], v[64:67], a[64:67], v[112:115]
    s_add_u32 m0, s66, 106496
    s_add_u32 s63, s88, 1474560
    buffer_load_dwordx4 v58, s[84:87], s63 offen lds
    ds_read_b64_tr_b16 a[160:161], v232 offset:16384
    v_mfma_f32_16x16x32_bf16 v[116:119], v[64:67], a[68:71], v[116:119]
    s_waitcnt lgkmcnt(8)
    ds_read_b64_tr_b16 a[162:163], v232 offset:20480
    ds_read_b64_tr_b16 a[164:165], v233 offset:16384
    v_mfma_f32_16x16x32_bf16 v[120:123], v[68:71], a[64:67], v[120:123]
    ds_read_b64_tr_b16 a[166:167], v233 offset:20480
    ds_read_b64_tr_b16 a[168:169], v234 offset:16384
    v_mfma_f32_16x16x32_bf16 v[124:127], v[68:71], a[68:71], v[124:127]
    ds_read_b64_tr_b16 a[170:171], v234 offset:20480
    ds_read_b64_tr_b16 a[172:173], v235 offset:16384
    v_mfma_f32_16x16x32_bf16 v[128:131], v[72:75], a[64:67], v[128:131]
    ds_read_b64_tr_b16 a[174:175], v235 offset:20480
    s_waitcnt lgkmcnt(8)
    ds_read_b64_tr_b16 a[176:177], v236 offset:16384
    v_mfma_f32_16x16x32_bf16 v[132:135], v[72:75], a[68:71], v[132:135]
    s_add_u32 m0, s69, 0
    s_add_u32 s63, s71, 1024
    buffer_load_dwordx4 v248, s[28:31], s63 offen  lds
    ds_read_b64_tr_b16 a[178:179], v236 offset:20480
    v_mfma_f32_16x16x32_bf16 v[136:139], a[64:67], v[76:79], v[136:139]
    ds_read_b64_tr_b16 a[180:181], v237 offset:16384
    ds_read_b64_tr_b16 a[182:183], v237 offset:20480
    v_mfma_f32_16x16x32_bf16 v[140:143], a[68:71], v[76:79], v[140:143]
    ds_read_b64_tr_b16 a[184:185], v238 offset:16384
    ds_read_b64_tr_b16 a[186:187], v238 offset:20480
    v_mfma_f32_16x16x32_bf16 v[144:147], a[64:67], v[80:83], v[144:147]
    ds_read_b64_tr_b16 a[188:189], v239 offset:16384
    s_waitcnt lgkmcnt(8)
    ds_read_b64_tr_b16 a[190:191], v239 offset:20480
    v_mfma_f32_16x16x32_bf16 v[148:151], a[68:71], v[80:83], v[148:151]
    v_mfma_f32_16x16x32_bf16 v[152:155], a[64:67], v[84:87], v[152:155]
    v_mfma_f32_16x16x32_bf16 v[156:159], a[68:71], v[84:87], v[156:159]
    s_add_u32 m0, s66, 110592
    s_add_u32 s63, s88, 1489920
    buffer_load_dwordx4 v58, s[84:87], s63 offen lds
    v_mfma_f32_16x16x32_bf16 v[160:163], v[88:91], a[64:67], v[160:163]
    v_mfma_f32_16x16x32_bf16 v[164:167], v[88:91], a[68:71], v[164:167]
    v_mfma_f32_16x16x32_bf16 v[168:171], v[92:95], a[64:67], v[168:171]
    v_mfma_f32_16x16x32_bf16 v[172:175], v[92:95], a[68:71], v[172:175]
    v_mfma_f32_16x16x32_bf16 v[192:195], v[228:231], a[64:67], v[192:195]
    s_add_u32 m0, s69, 1024
    s_add_u32 s63, s71, 1024
    buffer_load_dwordx4 v249, s[28:31], s63 offen  lds
    v_mfma_f32_16x16x32_bf16 v[196:199], a[64:67], a[64:67], v[196:199]
    v_mfma_f32_16x16x32_bf16 v[200:203], v[228:231], a[68:71], v[200:203]
    v_mfma_f32_16x16x32_bf16 v[204:207], a[68:71], a[68:71], v[204:207]
    v_mfma_f32_16x16x32_bf16 v[192:195], v[228:231], a[72:75], v[192:195]
    v_mfma_f32_16x16x32_bf16 v[196:199], a[72:75], a[72:75], v[196:199]
    s_add_u32 s63, s82, 1966080
    buffer_load_dword v63, v55, s[84:87], s63 offen
    v_mfma_f32_16x16x32_bf16 v[200:203], v[228:231], a[76:79], v[200:203]
    v_mfma_f32_16x16x32_bf16 v[204:207], a[76:79], a[76:79], v[204:207]
    s_waitcnt vmcnt(6)
    s_barrier
    v_mfma_f32_16x16x32_bf16 v[176:179], v[228:231], v[104:107], v[176:179]
    ds_read_b64_tr_b16 v[96:97], v184 offset:24576
    ds_read_b64_tr_b16 v[98:99], v184 offset:28672
    v_mfma_f32_16x16x32_bf16 v[180:183], v[228:231], v[108:111], v[180:183]
    ds_read_b64_tr_b16 v[100:101], v185 offset:24576
    ds_read_b64_tr_b16 v[102:103], v185 offset:28672
    s_cmp_eq_u32 s40, 9
    s_cbranch_scc1 L_pack_24
L_packed_25:
    v_mfma_f32_16x16x32_bf16 v[112:115], a[160:163], a[72:75], v[112:115]
    ds_read_b64_tr_b16 v[64:65], v232 offset:24576
    ds_read_b64_tr_b16 v[66:67], v232 offset:28672
    v_mfma_f32_16x16x32_bf16 v[116:119], a[160:163], a[76:79], v[116:119]
    s_add_u32 m0, s66, 73728
    s_add_u32 s63, s88, 1597440
    buffer_load_dwordx4 v58, s[84:87], s63 offen lds
    s_waitcnt lgkmcnt(8)
    ds_read_b64_tr_b16 v[68:69], v233 offset:24576
    v_mfma_f32_16x16x32_bf16 v[120:123], a[164:167], a[72:75], v[120:123]
    ds_read_b64_tr_b16 v[70:71], v233 offset:28672
    ds_read_b64_tr_b16 v[72:73], v234 offset:24576
    v_mfma_f32_16x16x32_bf16 v[124:127], a[164:167], a[76:79], v[124:127]
    ds_read_b64_tr_b16 v[74:75], v234 offset:28672
    ds_read_b64_tr_b16 v[76:77], v235 offset:24576
    v_mfma_f32_16x16x32_bf16 v[128:131], a[168:171], a[72:75], v[128:131]
    ds_read_b64_tr_b16 v[78:79], v235 offset:28672
    ds_read_b64_tr_b16 v[80:81], v236 offset:24576
    v_mfma_f32_16x16x32_bf16 v[132:135], a[168:171], a[76:79], v[132:135]
    s_waitcnt lgkmcnt(8)
    ds_read_b64_tr_b16 v[82:83], v236 offset:28672
    ds_read_b64_tr_b16 v[84:85], v237 offset:24576
    v_mfma_f32_16x16x32_bf16 v[136:139], a[72:75], a[172:175], v[136:139]
    ds_read_b64_tr_b16 v[86:87], v237 offset:28672
    ds_read_b64_tr_b16 v[88:89], v238 offset:24576
    v_mfma_f32_16x16x32_bf16 v[140:143], a[76:79], a[172:175], v[140:143]
    s_add_u32 m0, s69, 2048
    s_add_u32 s63, s71, 1024
    buffer_load_dwordx4 v250, s[28:31], s63 offen  lds
    ds_read_b64_tr_b16 v[90:91], v238 offset:28672
    v_mfma_f32_16x16x32_bf16 v[144:147], a[72:75], a[176:179], v[144:147]
    ds_read_b64_tr_b16 v[92:93], v239 offset:24576
    ds_read_b64_tr_b16 v[94:95], v239 offset:28672
    v_mfma_f32_16x16x32_bf16 v[148:151], a[76:79], a[176:179], v[148:151]
    s_waitcnt lgkmcnt(8)
    ds_read_b128 a[96:99], v244 offset:8192
    ds_read_b128 a[104:107], v245 offset:8192
    ds_read_b128 a[112:115], v246 offset:8192
    ds_read_b128 a[120:123], v247 offset:8192
    v_mfma_f32_16x16x32_bf16 v[152:155], a[72:75], a[180:183], v[152:155]
    v_mfma_f32_16x16x32_bf16 v[156:159], a[76:79], a[180:183], v[156:159]
    v_mfma_f32_16x16x32_bf16 v[160:163], a[184:187], a[72:75], v[160:163]
    v_mfma_f32_16x16x32_bf16 v[164:167], a[184:187], a[76:79], v[164:167]
    v_mfma_f32_16x16x32_bf16 v[168:171], a[188:191], a[72:75], v[168:171]
    s_add_u32 m0, s66, 77824
    s_add_u32 s63, s88, 1612800
    buffer_load_dwordx4 v58, s[84:87], s63 offen lds
    v_mfma_f32_16x16x32_bf16 v[172:175], a[188:191], a[76:79], v[172:175]
    v_mfma_f32_16x16x32_bf16 v[192:195], v[228:231], a[80:83], v[192:195]
    v_mfma_f32_16x16x32_bf16 v[196:199], a[80:83], a[80:83], v[196:199]
    v_mfma_f32_16x16x32_bf16 v[200:203], v[228:231], a[84:87], v[200:203]
    v_mfma_f32_16x16x32_bf16 v[204:207], a[84:87], a[84:87], v[204:207]
    v_mfma_f32_16x16x32_bf16 v[192:195], v[228:231], a[88:91], v[192:195]
    s_add_u32 m0, s69, 3072
    s_add_u32 s63, s71, 1024
    buffer_load_dwordx4 v251, s[28:31], s63 offen  lds
    v_mfma_f32_16x16x32_bf16 v[196:199], a[88:91], a[88:91], v[196:199]
    v_mfma_f32_16x16x32_bf16 v[200:203], v[228:231], a[92:95], v[200:203]
    v_mfma_f32_16x16x32_bf16 v[204:207], a[92:95], a[92:95], v[204:207]
    v_mfma_f32_16x16x32_bf16 v[176:179], v[228:231], v[96:99], v[176:179]
    ds_read_b64_tr_b16 v[104:105], v184 offset:40960
    ds_read_b64_tr_b16 v[106:107], v184 offset:45056
    v_mfma_f32_16x16x32_bf16 v[180:183], v[228:231], v[100:103], v[180:183]
    ds_read_b64_tr_b16 v[108:109], v185 offset:40960
    s_waitcnt lgkmcnt(8)
    ds_read_b64_tr_b16 v[110:111], v185 offset:45056
    s_cmp_eq_u32 s40, 10
    s_cbranch_scc1 L_pack_26
L_packed_27:
    v_mfma_f32_16x16x32_bf16 v[112:115], v[64:67], a[80:83], v[112:115]
    s_add_u32 m0, s66, 81920
    s_add_u32 s63, s88, 1720320
    buffer_load_dwordx4 v58, s[84:87], s63 offen lds
    ds_read_b64_tr_b16 a[160:161], v232 offset:40960
    v_mfma_f32_16x16x32_bf16 v[116:119], v[64:67], a[84:87], v[116:119]
    ds_read_b64_tr_b16 a[162:163], v232 offset:45056
    ds_read_b64_tr_b16 a[164:165], v233 offset:40960
    v_mfma_f32_16x16x32_bf16 v[120:123], v[68:71], a[80:83], v[120:123]
    ds_read_b64_tr_b16 a[166:167], v233 offset:45056
    ds_read_b64_tr_b16 a[168:169], v234 offset:40960
    v_mfma_f32_16x16x32_bf16 v[124:127], v[68:71], a[84:87], v[124:127]
    ds_read_b64_tr_b16 a[170:171], v234 offset:45056
    s_waitcnt lgkmcnt(8)
    ds_read_b64_tr_b16 a[172:173], v235 offset:40960
    v_mfma_f32_16x16x32_bf16 v[128:131], v[72:75], a[80:83], v[128:131]
    s_add_u32 m0, s69, 4096
    s_add_u32 s63, s71, 21504
    buffer_load_dwordx4 v248, s[28:31], s63 offen  lds
    ds_read_b64_tr_b16 a[174:175], v235 offset:45056
    v_mfma_f32_16x16x32_bf16 v[132:135], v[72:75], a[84:87], v[132:135]
    ds_read_b64_tr_b16 a[176:177], v236 offset:40960
    ds_read_b64_tr_b16 a[178:179], v236 offset:45056
    v_mfma_f32_16x16x32_bf16 v[136:139], a[80:83], v[76:79], v[136:139]
    ds_read_b64_tr_b16 a[180:181], v237 offset:40960
    ds_read_b64_tr_b16 a[182:183], v237 offset:45056
    v_mfma_f32_16x16x32_bf16 v[140:143], a[84:87], v[76:79], v[140:143]
    ds_read_b64_tr_b16 a[184:185], v238 offset:40960
    s_waitcnt lgkmcnt(8)
    ds_read_b64_tr_b16 a[186:187], v238 offset:45056
    v_mfma_f32_16x16x32_bf16 v[144:147], a[80:83], v[80:83], v[144:147]
    ds_read_b64_tr_b16 a[188:189], v239 offset:40960
    ds_read_b64_tr_b16 a[190:191], v239 offset:45056
    v_mfma_f32_16x16x32_bf16 v[148:151], a[84:87], v[80:83], v[148:151]
    s_add_u32 m0, s66, 86016
    s_add_u32 s63, s88, 1735680
    buffer_load_dwordx4 v58, s[84:87], s63 offen lds
    s_waitcnt vmcnt(12)
    ds_read_b128 a[100:103], v244 offset:12288
    ds_read_b128 a[108:111], v245 offset:12288
    ds_read_b128 a[116:119], v246 offset:12288
    ds_read_b128 a[124:127], v247 offset:12288
    v_mfma_f32_16x16x32_bf16 v[152:155], a[80:83], v[84:87], v[152:155]
    s_waitcnt lgkmcnt(8)
    ds_read_b64_tr_b16 v[208:209], v26
    ds_read_b64_tr_b16 v[210:211], v27
    v_mfma_f32_16x16x32_bf16 v[156:159], a[84:87], v[84:87], v[156:159]
    ds_read_b64_tr_b16 v[212:213], v28
    ds_read_b64_tr_b16 v[214:215], v29
    v_mfma_f32_16x16x32_bf16 v[160:163], v[88:91], a[80:83], v[160:163]
    ds_read_b64_tr_b16 v[216:217], v30
    ds_read_b64_tr_b16 v[218:219], v31
    v_mfma_f32_16x16x32_bf16 v[164:167], v[88:91], a[84:87], v[164:167]
    s_add_u32 m0, s69, 5120
    s_add_u32 s63, s71, 21504
    buffer_load_dwordx4 v249, s[28:31], s63 offen  lds
    ds_read_b64_tr_b16 v[220:221], v32
    v_mfma_f32_16x16x32_bf16 v[168:171], v[92:95], a[80:83], v[168:171]
    s_waitcnt lgkmcnt(8)
    ds_read_b64_tr_b16 v[222:223], v33
    ds_read_b64_tr_b16 v[224:225], v34
    v_mfma_f32_16x16x32_bf16 v[172:175], v[92:95], a[84:87], v[172:175]
    ds_read_b64_tr_b16 v[226:227], v35
    s_waitcnt vmcnt(5)
    s_barrier
    v_mfma_f32_16x16x32_bf16 v[176:179], v[228:231], v[104:107], v[176:179]
    ds_read_b64_tr_b16 v[96:97], v184 offset:32768
    ds_read_b64_tr_b16 v[98:99], v184 offset:36864
    v_mfma_f32_16x16x32_bf16 v[180:183], v[228:231], v[108:111], v[180:183]
    s_add_u32 m0, s66, 114688
    s_add_u32 s63, s88, 1843200
    buffer_load_dwordx4 v58, s[84:87], s63 offen lds
    ds_read_b64_tr_b16 v[100:101], v185 offset:32768
    s_cmp_eq_u32 s40, 11
    s_cbranch_scc1 L_pack_28
L_packed_29:
    v_mfma_f32_16x16x32_bf16 v[112:115], a[160:163], a[88:91], v[112:115]
    ds_read_b64_tr_b16 v[102:103], v185 offset:36864
    s_waitcnt lgkmcnt(8)
    ds_read_b64_tr_b16 v[64:65], v232 offset:32768
    v_mfma_f32_16x16x32_bf16 v[116:119], a[160:163], a[92:95], v[116:119]
    ds_read_b64_tr_b16 v[66:67], v232 offset:36864
    ds_read_b64_tr_b16 v[68:69], v233 offset:32768
    v_mfma_f32_16x16x32_bf16 v[120:123], a[164:167], a[88:91], v[120:123]
    ds_read_b64_tr_b16 v[70:71], v233 offset:36864
    ds_read_b64_tr_b16 v[72:73], v234 offset:32768
    v_mfma_f32_16x16x32_bf16 v[124:127], a[164:167], a[92:95], v[124:127]
    s_add_u32 m0, s69, 6144
    s_add_u32 s63, s71, 21504
    buffer_load_dwordx4 v250, s[28:31], s63 offen  lds
    ds_read_b64_tr_b16 v[74:75], v234 offset:36864
    v_mfma_f32_16x16x32_bf16 v[128:131], a[168:171], a[88:91], v[128:131]
    ds_read_b64_tr_b16 v[76:77], v235 offset:32768
    s_waitcnt lgkmcnt(8)
    ds_read_b64_tr_b16 v[78:79], v235 offset:36864
    v_mfma_f32_16x16x32_bf16 v[132:135], a[168:171], a[92:95], v[132:135]
    ds_read_b64_tr_b16 v[80:81], v236 offset:32768
    ds_read_b64_tr_b16 v[82:83], v236 offset:36864
    v_mfma_f32_16x16x32_bf16 v[136:139], a[88:91], a[172:175], v[136:139]
    ds_read_b64_tr_b16 v[84:85], v237 offset:32768
    ds_read_b64_tr_b16 v[86:87], v237 offset:36864
    v_mfma_f32_16x16x32_bf16 v[140:143], a[92:95], a[172:175], v[140:143]
    s_add_u32 m0, s66, 118784
    s_add_u32 s63, s88, 1858560
    buffer_load_dwordx4 v58, s[84:87], s63 offen lds
    ds_read_b64_tr_b16 v[88:89], v238 offset:32768
    v_mfma_f32_16x16x32_bf16 v[144:147], a[88:91], a[176:179], v[144:147]
    ds_read_b64_tr_b16 v[90:91], v238 offset:36864
    s_waitcnt lgkmcnt(8)
    ds_read_b64_tr_b16 v[92:93], v239 offset:32768
    v_mfma_f32_16x16x32_bf16 v[148:151], a[92:95], a[176:179], v[148:151]
    ds_read_b64_tr_b16 v[94:95], v239 offset:36864
    v_mfma_f32_16x16x32_bf16 v[152:155], a[88:91], a[180:183], v[152:155]
    v_mfma_f32_16x16x32_bf16 v[156:159], a[92:95], a[180:183], v[156:159]
    s_add_u32 m0, s69, 7168
    s_add_u32 s63, s71, 21504
    buffer_load_dwordx4 v251, s[28:31], s63 offen  lds
    v_mfma_f32_16x16x32_bf16 v[160:163], a[184:187], a[88:91], v[160:163]
    v_mfma_f32_16x16x32_bf16 v[164:167], a[184:187], a[92:95], v[164:167]
    v_mfma_f32_16x16x32_bf16 v[168:171], a[188:191], a[88:91], v[168:171]
    v_mfma_f32_16x16x32_bf16 v[48:51], a[200:203], v[208:211], 0
    buffer_store_dwordx4 v[208:211], v36, s[24:27], 0 offen sc1
    v_mfma_f32_16x16x32_bf16 v[172:175], a[188:191], a[92:95], v[172:175]
    v_mfma_f32_16x16x32_bf16 v[192:195], v[228:231], a[96:99], v[192:195]
    v_mfma_f32_16x16x32_bf16 v[196:199], a[96:99], a[96:99], v[196:199]
    v_mfma_f32_16x16x32_bf16 v[200:203], v[228:231], a[100:103], v[200:203]
    v_mfma_f32_16x16x32_bf16 v[48:51], a[200:203], v[212:215], v[48:51]
    buffer_store_dwordx4 v[212:215], v37, s[24:27], 0 offen sc1
    v_mfma_f32_16x16x32_bf16 v[204:207], a[100:103], a[100:103], v[204:207]
    v_mfma_f32_16x16x32_bf16 v[192:195], v[228:231], a[104:107], v[192:195]
    v_mfma_f32_16x16x32_bf16 v[196:199], a[104:107], a[104:107], v[196:199]
    v_mfma_f32_16x16x32_bf16 v[200:203], v[228:231], a[108:111], v[200:203]
    v_mfma_f32_16x16x32_bf16 v[48:51], a[200:203], v[216:219], v[48:51]
    buffer_store_dwordx4 v[216:219], v38, s[24:27], 0 offen sc1
    v_mfma_f32_16x16x32_bf16 v[204:207], a[108:111], a[108:111], v[204:207]
    v_mfma_f32_16x16x32_bf16 v[176:179], v[228:231], v[96:99], v[176:179]
    ds_read_b64_tr_b16 v[104:105], v184 offset:0
    ds_read_b64_tr_b16 v[106:107], v184 offset:4096
    v_mfma_f32_16x16x32_bf16 v[180:183], v[228:231], v[100:103], v[180:183]
    ds_read_b64_tr_b16 v[108:109], v185 offset:0
    ds_read_b64_tr_b16 v[110:111], v185 offset:4096
    s_cmp_eq_u32 s40, 12
    s_cbranch_scc1 L_pack_30
L_packed_31:
    v_mfma_f32_16x16x32_bf16 v[112:115], v[64:67], a[96:99], v[112:115]
    s_add_u32 m0, s66, 90112
    s_add_u32 s63, s88, 1966080
    buffer_load_dwordx4 v58, s[84:87], s63 offen lds
    ds_read_b64_tr_b16 a[160:161], v232 offset:0
    v_mfma_f32_16x16x32_bf16 v[116:119], v[64:67], a[100:103], v[116:119]
    s_waitcnt lgkmcnt(8)
    ds_read_b64_tr_b16 a[162:163], v232 offset:4096
    ds_read_b64_tr_b16 a[164:165], v233 offset:0
    v_mfma_f32_16x16x32_bf16 v[120:123], v[68:71], a[96:99], v[120:123]
    ds_read_b64_tr_b16 a[166:167], v233 offset:4096
    ds_read_b64_tr_b16 a[168:169], v234 offset:0
    v_mfma_f32_16x16x32_bf16 v[124:127], v[68:71], a[100:103], v[124:127]
    ds_read_b64_tr_b16 a[170:171], v234 offset:4096
    ds_read_b64_tr_b16 a[172:173], v235 offset:0
    v_mfma_f32_16x16x32_bf16 v[128:131], v[72:75], a[96:99], v[128:131]
    s_add_u32 m0, s66, 94208
    s_add_u32 s63, s88, 1981440
    buffer_load_dwordx4 v58, s[84:87], s63 offen lds
    ds_read_b64_tr_b16 a[174:175], v235 offset:4096
    v_mfma_f32_16x16x32_bf16 v[132:135], v[72:75], a[100:103], v[132:135]
    s_waitcnt lgkmcnt(8)
    ds_read_b64_tr_b16 a[176:177], v236 offset:0
    ds_read_b64_tr_b16 a[178:179], v236 offset:4096
    v_mfma_f32_16x16x32_bf16 v[136:139], a[96:99], v[76:79], v[136:139]
    ds_read_b64_tr_b16 a[180:181], v237 offset:0
    ds_read_b64_tr_b16 a[182:183], v237 offset:4096
    v_mfma_f32_16x16x32_bf16 v[140:143], a[100:103], v[76:79], v[140:143]
    ds_read_b64_tr_b16 a[184:185], v238 offset:0
    ds_read_b64_tr_b16 a[186:187], v238 offset:4096
    v_mfma_f32_16x16x32_bf16 v[144:147], a[96:99], v[80:83], v[144:147]
    v_mfma_f32_16x16x32_bf16 v[48:51], a[200:203], v[220:223], v[48:51]
    buffer_store_dwordx4 v[220:223], v39, s[24:27], 0 offen sc1
    ds_read_b64_tr_b16 a[188:189], v239 offset:0
    v_mfma_f32_16x16x32_bf16 v[148:151], a[100:103], v[80:83], v[148:151]
    s_waitcnt lgkmcnt(8)
    ds_read_b64_tr_b16 a[190:191], v239 offset:4096
    v_mfma_f32_16x16x32_bf16 v[152:155], a[96:99], v[84:87], v[152:155]
    v_mfma_f32_16x16x32_bf16 v[156:159], a[100:103], v[84:87], v[156:159]
    v_mfma_f32_16x16x32_bf16 v[160:163], v[88:91], a[96:99], v[160:163]
    v_mfma_f32_16x16x32_bf16 v[164:167], v[88:91], a[100:103], v[164:167]
    v_mfma_f32_16x16x32_bf16 v[48:51], a[200:203], v[224:227], v[48:51]
    buffer_store_dwordx4 v[224:227], v40, s[24:27], 0 offen sc1
    v_mfma_f32_16x16x32_bf16 v[168:171], v[92:95], a[96:99], v[168:171]
    v_mfma_f32_16x16x32_bf16 v[172:175], v[92:95], a[100:103], v[172:175]
    v_mfma_f32_16x16x32_bf16 v[192:195], v[228:231], a[112:115], v[192:195]
    v_mfma_f32_16x16x32_bf16 v[196:199], a[112:115], a[112:115], v[196:199]
    s_nop 2
    buffer_store_dword v48, v41, s[24:27], 0 offen sc1
    v_mfma_f32_16x16x32_bf16 v[200:203], v[228:231], a[116:119], v[200:203]
    v_mfma_f32_16x16x32_bf16 v[204:207], a[116:119], a[116:119], v[204:207]
    v_mfma_f32_16x16x32_bf16 v[192:195], v[228:231], a[120:123], v[192:195]
    v_mfma_f32_16x16x32_bf16 v[196:199], a[120:123], a[120:123], v[196:199]
    s_cmp_lg_u32 s81, 0
    s_cbranch_scc1 L_dup_32
L_dupd_33:
    v_mfma_f32_16x16x32_bf16 v[200:203], v[228:231], a[124:127], v[200:203]
    v_mfma_f32_16x16x32_bf16 v[204:207], a[124:127], a[124:127], v[204:207]
    s_waitcnt vmcnt(9)
    s_barrier
    v_mfma_f32_16x16x32_bf16 v[176:179], v[228:231], v[104:107], v[176:179]
    ds_read_b64_tr_b16 v[96:97], v184 offset:8192
    ds_read_b64_tr_b16 v[98:99], v184 offset:12288
    v_mfma_f32_16x16x32_bf16 v[180:183], v[228:231], v[108:111], v[180:183]
    ds_read_b64_tr_b16 v[100:101], v185 offset:8192
    ds_read_b64_tr_b16 v[102:103], v185 offset:12288
    s_cmp_eq_u32 s40, 13
    s_cbranch_scc1 L_pack_34
L_packed_35:
    v_mfma_f32_16x16x32_bf16 v[112:115], a[160:163], a[104:107], v[112:115]
    ds_read_b64_tr_b16 v[64:65], v232 offset:8192
    ds_read_b64_tr_b16 v[66:67], v232 offset:12288
    v_mfma_f32_16x16x32_bf16 v[116:119], a[160:163], a[108:111], v[116:119]
    s_waitcnt lgkmcnt(8)
    ds_read_b64_tr_b16 v[68:69], v233 offset:8192
    ds_read_b64_tr_b16 v[70:71], v233 offset:12288
    v_mfma_f32_16x16x32_bf16 v[120:123], a[164:167], a[104:107], v[120:123]
    s_add_u32 m0, s66, 98304
    s_add_u32 s63, s88, 2088960
    buffer_load_dwordx4 v58, s[84:87], s63 offen lds
    ds_read_b64_tr_b16 v[72:73], v234 offset:8192
    v_mfma_f32_16x16x32_bf16 v[124:127], a[164:167], a[108:111], v[124:127]
    ds_read_b64_tr_b16 v[74:75], v234 offset:12288
    ds_read_b64_tr_b16 v[76:77], v235 offset:8192
    v_mfma_f32_16x16x32_bf16 v[128:131], a[168:171], a[104:107], v[128:131]
    ds_read_b64_tr_b16 v[78:79], v235 offset:12288
    ds_read_b64_tr_b16 v[80:81], v236 offset:8192
    v_mfma_f32_16x16x32_bf16 v[132:135], a[168:171], a[108:111], v[132:135]
    s_waitcnt lgkmcnt(8)
    ds_read_b64_tr_b16 v[82:83], v236 offset:12288
    ds_read_b64_tr_b16 v[84:85], v237 offset:8192
    v_mfma_f32_16x16x32_bf16 v[136:139], a[104:107], a[172:175], v[136:139]
    ds_read_b64_tr_b16 v[86:87], v237 offset:12288
    ds_read_b64_tr_b16 v[88:89], v238 offset:8192
    v_mfma_f32_16x16x32_bf16 v[140:143], a[108:111], a[172:175], v[140:143]
    ds_read_b64_tr_b16 v[90:91], v238 offset:12288
    ds_read_b64_tr_b16 v[92:93], v239 offset:8192
    v_mfma_f32_16x16x32_bf16 v[144:147], a[104:107], a[176:179], v[144:147]
    ds_read_b64_tr_b16 v[94:95], v239 offset:12288
    s_waitcnt lgkmcnt(8)
    ds_read_b128 a[128:131], v244 offset:0
    ds_read_b128 a[136:139], v245 offset:0
    ds_read_b128 a[144:147], v246 offset:0
    ds_read_b128 a[152:155], v247 offset:0
    v_mfma_f32_16x16x32_bf16 v[148:151], a[108:111], a[176:179], v[148:151]
    v_mfma_f32_16x16x32_bf16 v[152:155], a[104:107], a[180:183], v[152:155]
    v_mfma_f32_16x16x32_bf16 v[156:159], a[108:111], a[180:183], v[156:159]
    s_add_u32 m0, s66, 102400
    s_add_u32 s63, s88, 2104320
    buffer_load_dwordx4 v58, s[84:87], s63 offen lds
    v_mfma_f32_16x16x32_bf16 v[160:163], a[184:187], a[104:107], v[160:163]
    v_mfma_f32_16x16x32_bf16 v[164:167], a[184:187], a[108:111], v[164:167]
    v_mfma_f32_16x16x32_bf16 v[168:171], a[188:191], a[104:107], v[168:171]
    v_mfma_f32_16x16x32_bf16 v[172:175], a[188:191], a[108:111], v[172:175]
    s_cmp_lg_u32 s42, 0
    s_nop 6
    s_cbranch_scc1 L_w0_36
    v_cmp_le_u32 vcc, 1, v59
    s_nop 1
    s_cmp_eq_u64 vcc, -1
    s_nop 1
    s_cbranch_scc1 L_fd_38
    s_mov_b32 s46, 0x200000
    s_nop 0
L_fl_37:
    global_load_dword v10, v54, s[20:21] sc1
    s_waitcnt vmcnt(0)
    v_cmp_le_u32 vcc, 1, v10
    s_nop 1
    s_cmp_eq_u64 vcc, -1
    s_nop 1
    s_cbranch_scc1 L_fd_38
    s_sub_u32 s46, s46, 1
    s_cmp_lg_u32 s46, 0
    s_nop 0
    s_cbranch_scc1 L_fl_37
    s_nop 0
L_fd_38:
L_w0_36:
    v_mfma_f32_16x16x32_bf16 v[176:179], v[228:231], v[96:99], v[176:179]
    ds_read_b64_tr_b16 v[104:105], v184 offset:40960
    ds_read_b64_tr_b16 v[106:107], v184 offset:45056
    v_mfma_f32_16x16x32_bf16 v[180:183], v[228:231], v[100:103], v[180:183]
    ds_read_b64_tr_b16 v[108:109], v185 offset:40960
    s_waitcnt lgkmcnt(8)
    ds_read_b64_tr_b16 v[110:111], v185 offset:45056
    s_cmp_eq_u32 s40, 14
    s_cbranch_scc1 L_pack_39
L_packed_40:
    v_mfma_f32_16x16x32_bf16 v[112:115], v[64:67], a[112:115], v[112:115]
    ds_read_b64_tr_b16 a[160:161], v232 offset:40960
    ds_read_b64_tr_b16 a[162:163], v232 offset:45056
    v_mfma_f32_16x16x32_bf16 v[116:119], v[64:67], a[116:119], v[116:119]
    ds_read_b64_tr_b16 a[164:165], v233 offset:40960
    ds_read_b64_tr_b16 a[166:167], v233 offset:45056
    v_mfma_f32_16x16x32_bf16 v[120:123], v[68:71], a[112:115], v[120:123]
    s_add_u32 m0, s66, 106496
    s_add_u32 s63, s88, 2211840
    buffer_load_dwordx4 v58, s[84:87], s63 offen lds
    ds_read_b64_tr_b16 a[168:169], v234 offset:40960
    v_mfma_f32_16x16x32_bf16 v[124:127], v[68:71], a[116:119], v[124:127]
    ds_read_b64_tr_b16 a[170:171], v234 offset:45056
    s_waitcnt lgkmcnt(8)
    ds_read_b64_tr_b16 a[172:173], v235 offset:40960
    v_mfma_f32_16x16x32_bf16 v[128:131], v[72:75], a[112:115], v[128:131]
    ds_read_b64_tr_b16 a[174:175], v235 offset:45056
    ds_read_b64_tr_b16 a[176:177], v236 offset:40960
    v_mfma_f32_16x16x32_bf16 v[132:135], v[72:75], a[116:119], v[132:135]
    ds_read_b64_tr_b16 a[178:179], v236 offset:45056
    ds_read_b64_tr_b16 a[180:181], v237 offset:40960
    v_mfma_f32_16x16x32_bf16 v[136:139], a[112:115], v[76:79], v[136:139]
    ds_read_b64_tr_b16 a[182:183], v237 offset:45056
    ds_read_b64_tr_b16 a[184:185], v238 offset:40960
    v_mfma_f32_16x16x32_bf16 v[140:143], a[116:119], v[76:79], v[140:143]
    s_waitcnt lgkmcnt(8)
    ds_read_b64_tr_b16 a[186:187], v238 offset:45056
    ds_read_b64_tr_b16 a[188:189], v239 offset:40960
    v_mfma_f32_16x16x32_bf16 v[144:147], a[112:115], v[80:83], v[144:147]
    ds_read_b64_tr_b16 a[190:191], v239 offset:45056
    s_waitcnt vmcnt(11)
    ds_read_b128 a[132:135], v244 offset:4096
    ds_read_b128 a[140:143], v245 offset:4096
    ds_read_b128 a[148:151], v246 offset:4096
    ds_read_b128 a[156:159], v247 offset:4096
    v_mfma_f32_16x16x32_bf16 v[148:151], a[116:119], v[80:83], v[148:151]
    v_mfma_f32_16x16x32_bf16 v[152:155], a[112:115], v[84:87], v[152:155]
    v_mfma_f32_16x16x32_bf16 v[156:159], a[116:119], v[84:87], v[156:159]
    s_add_u32 m0, s66, 110592
    s_add_u32 s63, s88, 2227200
    buffer_load_dwordx4 v58, s[84:87], s63 offen lds
    v_mfma_f32_16x16x32_bf16 v[160:163], v[88:91], a[112:115], v[160:163]
    v_mfma_f32_16x16x32_bf16 v[164:167], v[88:91], a[116:119], v[164:167]
    v_mfma_f32_16x16x32_bf16 v[168:171], v[92:95], a[112:115], v[168:171]
    v_mfma_f32_16x16x32_bf16 v[172:175], v[92:95], a[116:119], v[172:175]
    s_waitcnt vmcnt(4)
    s_waitcnt vmcnt(2)
    s_barrier
    s_cmp_lg_u32 s42, 0
    s_nop 3
    s_cbranch_scc1 L_w0_41
    s_and_b32 s48, s45, 1
    s_add_u32 s49, s48, 2
    s_mov_b32 s69, 53
    s_cmp_lt_u32 s45, 40
    s_cselect_b32 s48, s48, s49
    s_cselect_b32 s69, 19, s69
    s_sub_u32 s49, s45, 40
    s_lshr_b32 s50, s49, 3
    s_add_u32 s50, s50, 4
    s_cmp_lt_u32 s49, 216
    s_cselect_b32 s48, s50, s48
    s_cselect_b32 s69, 7, s69
    s_lshl_b32 s3, s48, 7
    s_add_u32 s3, s3, 98304
    s_lshr_b32 s49, s48, 1
    s_lshl_b32 s49, s49, 12
    s_and_b32 s48, s48, 1
    s_lshl_b32 s48, s48, 8
    s_add_u32 s48, s48, s49
    s_add_u32 s48, s48, 36352
    v_mov_b32 v9, s48
    v_mov_b32 v11, 1
    s_mov_b64 exec, 1
    global_atomic_add v61, v9, v11, s[22:23] sc0 sc1
    s_mov_b64 exec, -1
    s_getreg_b32 s48, hwreg(HW_REG_XCC_ID, 0, 3)
    s_lshl_b32 s48, s48, 3
    s_lshl_b64 s[48:49], 1, s48
    s_add_u32 s50, s67, 3328
    v_mov_b32 v10, s48
    v_mov_b32 v11, s49
    v_mov_b32 v9, s50
    s_mov_b64 exec, 1
    global_atomic_add_x2 v9, v[10:11], s[22:23] sc1
    s_mov_b64 exec, -1
    s_nop 0
L_w0_41:
    s_waitcnt lgkmcnt(14)
    v_mfma_f32_16x16x32_bf16 v[176:179], v[228:231], v[104:107], v[176:179]
    ds_read_b64_tr_b16 v[96:97], v184 offset:16384
    s_waitcnt lgkmcnt(8)
    ds_read_b64_tr_b16 v[98:99], v184 offset:20480
    v_mfma_f32_16x16x32_bf16 v[180:183], v[228:231], v[108:111], v[180:183]
    ds_read_b64_tr_b16 v[100:101], v185 offset:16384
    ds_read_b64_tr_b16 v[102:103], v185 offset:20480
    s_cmp_eq_u32 s40, 15
    s_cbranch_scc1 L_pack_42
L_packed_43:
    v_mfma_f32_16x16x32_bf16 v[112:115], a[160:163], a[120:123], v[112:115]
    ds_read_b64_tr_b16 v[64:65], v232 offset:16384
    ds_read_b64_tr_b16 v[66:67], v232 offset:20480
    v_mfma_f32_16x16x32_bf16 v[116:119], a[160:163], a[124:127], v[116:119]
    ds_read_b64_tr_b16 v[68:69], v233 offset:16384
    ds_read_b64_tr_b16 v[70:71], v233 offset:20480
    v_mfma_f32_16x16x32_bf16 v[120:123], a[164:167], a[120:123], v[120:123]
    s_waitcnt lgkmcnt(8)
    ds_read_b64_tr_b16 v[72:73], v234 offset:16384
    ds_read_b64_tr_b16 v[74:75], v234 offset:20480
    v_mfma_f32_16x16x32_bf16 v[124:127], a[164:167], a[124:127], v[124:127]
    ds_read_b64_tr_b16 v[76:77], v235 offset:16384
    ds_read_b64_tr_b16 v[78:79], v235 offset:20480
    v_mfma_f32_16x16x32_bf16 v[128:131], a[168:171], a[120:123], v[128:131]
    s_add_u32 m0, s66, 73728
    s_add_u32 s63, s88, 2334720
    buffer_load_dwordx4 v58, s[84:87], s63 offen lds
    ds_read_b64_tr_b16 v[80:81], v236 offset:16384
    v_mfma_f32_16x16x32_bf16 v[132:135], a[168:171], a[124:127], v[132:135]
    ds_read_b64_tr_b16 v[82:83], v236 offset:20480
    ds_read_b64_tr_b16 v[84:85], v237 offset:16384
    v_mfma_f32_16x16x32_bf16 v[136:139], a[120:123], a[172:175], v[136:139]
    s_waitcnt lgkmcnt(8)
    ds_read_b64_tr_b16 v[86:87], v237 offset:20480
    ds_read_b64_tr_b16 v[88:89], v238 offset:16384
    v_mfma_f32_16x16x32_bf16 v[140:143], a[124:127], a[172:175], v[140:143]
    ds_read_b64_tr_b16 v[90:91], v238 offset:20480
    ds_read_b64_tr_b16 v[92:93], v239 offset:16384
    v_mfma_f32_16x16x32_bf16 v[144:147], a[120:123], a[176:179], v[144:147]
    ds_read_b64_tr_b16 v[94:95], v239 offset:20480
    s_mul_i32 s71, s45, 22528
    s_add_u32 s71, s71, 11497472
    s_mov_b32 s62, 1
    s_mul_i32 s83, s42, 5632
    s_add_u32 s82, s71, s83
    v_mfma_f32_16x16x32_bf16 v[148:151], a[124:127], a[176:179], v[148:151]
    s_add_u32 s83, s83, 45056
    v_add_u32 v12, s83, v2
    v_lshrrev_b32 v13, 4, v1
    v_mul_u32_u24 v13, 768, v13
    v_mfma_f32_16x16x32_bf16 v[152:155], a[120:123], a[180:183], v[152:155]
    v_and_b32 v15, 15, v1
    v_lshl_add_u32 v13, v15, 4, v13
    v_add_u32 v14, s83, v13
    v_mov_b32 v60, 0x3f803f80
    v_mfma_f32_16x16x32_bf16 v[156:159], a[124:127], a[180:183], v[156:159]
    v_mfma_f32_16x16x32_bf16 v[160:163], a[184:187], a[120:123], v[160:163]
    v_mfma_f32_16x16x32_bf16 v[164:167], a[184:187], a[124:127], v[164:167]
    v_mfma_f32_16x16x32_bf16 v[168:171], a[188:191], a[120:123], v[168:171]
    v_mfma_f32_16x16x32_bf16 v[172:175], a[188:191], a[124:127], v[172:175]
    v_mfma_f32_16x16x32_bf16 v[192:195], v[228:231], a[128:131], v[192:195]
    v_mfma_f32_16x16x32_bf16 v[196:199], a[128:131], a[128:131], v[196:199]
    s_add_u32 m0, s66, 77824
    s_add_u32 s63, s88, 2350080
    buffer_load_dwordx4 v58, s[84:87], s63 offen lds
    v_mfma_f32_16x16x32_bf16 v[200:203], v[228:231], a[132:135], v[200:203]
    v_mfma_f32_16x16x32_bf16 v[204:207], a[132:135], a[132:135], v[204:207]
    v_mfma_f32_16x16x32_bf16 v[192:195], v[228:231], a[136:139], v[192:195]
    v_mfma_f32_16x16x32_bf16 v[196:199], a[136:139], a[136:139], v[196:199]
    v_mfma_f32_16x16x32_bf16 v[200:203], v[228:231], a[140:143], v[200:203]
    v_mfma_f32_16x16x32_bf16 v[204:207], a[140:143], a[140:143], v[204:207]
    s_waitcnt lgkmcnt(10)
    v_mfma_f32_16x16x32_bf16 v[176:179], v[228:231], v[96:99], v[176:179]
    ds_read_b64_tr_b16 v[104:105], v184 offset:24576
    ds_read_b64_tr_b16 v[106:107], v184 offset:28672
    v_mfma_f32_16x16x32_bf16 v[180:183], v[228:231], v[100:103], v[180:183]
    ds_read_b64_tr_b16 v[108:109], v185 offset:24576
    ds_read_b64_tr_b16 v[110:111], v185 offset:28672
    s_cmp_eq_u32 s40, 0
    s_cbranch_scc1 L_pack_44
L_packed_45:
    v_mfma_f32_16x16x32_bf16 v[112:115], v[64:67], a[128:131], v[112:115]
    ds_read_b64_tr_b16 a[160:161], v232 offset:24576
    s_waitcnt lgkmcnt(8)
    ds_read_b64_tr_b16 a[162:163], v232 offset:28672
    v_mfma_f32_16x16x32_bf16 v[116:119], v[64:67], a[132:135], v[116:119]
    ds_read_b64_tr_b16 a[164:165], v233 offset:24576
    ds_read_b64_tr_b16 a[166:167], v233 offset:28672
    v_mfma_f32_16x16x32_bf16 v[120:123], v[68:71], a[128:131], v[120:123]
    ds_read_b64_tr_b16 a[168:169], v234 offset:24576
    ds_read_b64_tr_b16 a[170:171], v234 offset:28672
    v_mfma_f32_16x16x32_bf16 v[124:127], v[68:71], a[132:135], v[124:127]
    ds_read_b64_tr_b16 a[172:173], v235 offset:24576
    ds_read_b64_tr_b16 a[174:175], v235 offset:28672
    v_mfma_f32_16x16x32_bf16 v[128:131], v[72:75], a[128:131], v[128:131]
    s_waitcnt lgkmcnt(8)
    ds_read_b64_tr_b16 a[176:177], v236 offset:24576
    v_mfma_f32_16x16x32_bf16 v[132:135], v[72:75], a[132:135], v[132:135]
    ds_read_b64_tr_b16 a[178:179], v236 offset:28672
    ds_read_b64_tr_b16 a[180:181], v237 offset:24576
    v_mfma_f32_16x16x32_bf16 v[136:139], a[128:131], v[76:79], v[136:139]
    ds_read_b64_tr_b16 a[182:183], v237 offset:28672
    ds_read_b64_tr_b16 a[184:185], v238 offset:24576
    v_mfma_f32_16x16x32_bf16 v[140:143], a[132:135], v[76:79], v[140:143]
    ds_read_b64_tr_b16 a[186:187], v238 offset:28672
    ds_read_b64_tr_b16 a[188:189], v239 offset:24576
    v_mfma_f32_16x16x32_bf16 v[144:147], a[128:131], v[80:83], v[144:147]
    s_waitcnt lgkmcnt(8)
    ds_read_b64_tr_b16 a[190:191], v239 offset:28672
    v_mfma_f32_16x16x32_bf16 v[148:151], a[132:135], v[80:83], v[148:151]
    v_mfma_f32_16x16x32_bf16 v[152:155], a[128:131], v[84:87], v[152:155]
    v_mfma_f32_16x16x32_bf16 v[156:159], a[132:135], v[84:87], v[156:159]
    v_mfma_f32_16x16x32_bf16 v[160:163], v[88:91], a[128:131], v[160:163]
    v_mfma_f32_16x16x32_bf16 v[164:167], v[88:91], a[132:135], v[164:167]
    v_mfma_f32_16x16x32_bf16 v[168:171], v[92:95], a[128:131], v[168:171]
    v_mfma_f32_16x16x32_bf16 v[172:175], v[92:95], a[132:135], v[172:175]
    v_mfma_f32_16x16x32_bf16 v[192:195], v[228:231], a[144:147], v[192:195]
    v_mfma_f32_16x16x32_bf16 v[196:199], a[144:147], a[144:147], v[196:199]
    v_mfma_f32_16x16x32_bf16 v[200:203], v[228:231], a[148:151], v[200:203]
    v_mfma_f32_16x16x32_bf16 v[204:207], a[148:151], a[148:151], v[204:207]
    v_mfma_f32_16x16x32_bf16 v[192:195], v[228:231], a[152:155], v[192:195]
    v_mfma_f32_16x16x32_bf16 v[196:199], a[152:155], a[152:155], v[196:199]
    v_mfma_f32_16x16x32_bf16 v[200:203], v[228:231], a[156:159], v[200:203]
    v_mfma_f32_16x16x32_bf16 v[204:207], a[156:159], a[156:159], v[204:207]
    s_waitcnt vmcnt(0)
    s_barrier
    s_cmp_lg_u32 s42, 0
    s_nop 4
    s_cbranch_scc1 L_w0_46
    s_waitcnt vmcnt(3)
    v_readfirstlane_b32 s48, v61
    s_nop 1
    s_cmp_eq_u32 s48, s69
    s_cbranch_scc0 L_notlast_47
    v_lshlrev_b32 v9, 12, v1
    v_add_u32 v9, s3, v9
    v_mov_b32 v11, 1
    s_mov_b64 exec, 0xff
    global_store_dword v9, v11, s[22:23] sc1
    s_mov_b64 exec, -1
    s_nop 0
L_notlast_47:
    s_nop 0
L_w0_46:
    v_mfma_f32_16x16x32_bf16 v[176:179], v[228:231], v[104:107], v[176:179]
    v_and_b32 v52, 3, v1
    v_and_b32 v53, 15, v1
    v_bfe_u32 v54, v1, 2, 2
    v_lshl_add_u32 v53, v54, 4, v53
    v_mfma_f32_16x16x32_bf16 v[180:183], v[228:231], v[108:111], v[180:183]
    v_lshlrev_b32 v53, 2, v53
    v_cmp_eq_u32 vcc, 1, v52
    s_cmp_eq_u32 s40, 1
    s_cbranch_scc1 L_pack_48
L_packed_49:
    v_mfma_f32_16x16x32_bf16 v[112:115], a[160:163], a[136:139], v[112:115]
    v_cndmask_b32 v196, v196, v197, vcc
    v_cndmask_b32 v204, v204, v205, vcc
    v_cmp_eq_u32 vcc, 2, v52
    v_mfma_f32_16x16x32_bf16 v[116:119], a[160:163], a[140:143], v[116:119]
    s_nop 0
    v_cndmask_b32 v196, v196, v198, vcc
    v_cndmask_b32 v204, v204, v206, vcc
    v_cmp_eq_u32 vcc, 3, v52
    v_mfma_f32_16x16x32_bf16 v[120:123], a[164:167], a[136:139], v[120:123]
    s_nop 0
    v_cndmask_b32 v196, v196, v199, vcc
    v_cndmask_b32 v204, v204, v207, vcc
    v_mfma_f32_16x16x32_bf16 v[124:127], a[164:167], a[140:143], v[124:127]
    ds_bpermute_b32 v197, v53, v196
    ds_bpermute_b32 v205, v53, v204
    v_mfma_f32_16x16x32_bf16 v[128:131], a[168:171], a[136:139], v[128:131]
    v_mul_f32 v50, 0.0015625, v192
    s_waitcnt lgkmcnt(1)
    v_mul_f32 v55, 0.0015625, v197
    v_fma_f32 v55, -v50, v50, v55
    v_max_f32 v55, 0, v55
    v_add_f32 v55, 1e-05, v55
    v_rsq_f32 v52, v55
    v_mul_f32 v51, 0.0015625, v200
    s_waitcnt lgkmcnt(0)
    v_mul_f32 v55, 0.0015625, v205
    v_fma_f32 v55, -v51, v51, v55
    v_max_f32 v55, 0, v55
    v_add_f32 v55, 1e-05, v55
    v_rsq_f32 v53, v55
    v_mfma_f32_16x16x32_bf16 v[132:135], a[168:171], a[140:143], v[132:135]
    v_lshrrev_b32 v44, 4, v1
    v_lshlrev_b32 v44, 4, v44
    ds_read_b64_tr_b16 v[96:97], v184 offset:32768
    v_mfma_f32_16x16x32_bf16 v[136:139], a[136:139], a[172:175], v[136:139]
    ds_read_b64_tr_b16 v[98:99], v184 offset:36864
    ds_read_b64_tr_b16 v[100:101], v185 offset:32768
    v_mfma_f32_16x16x32_bf16 v[140:143], a[140:143], a[172:175], v[140:143]
    ds_read_b64_tr_b16 v[102:103], v185 offset:36864
    ds_read_b64_tr_b16 v[64:65], v232 offset:32768
    v_mfma_f32_16x16x32_bf16 v[144:147], a[136:139], a[176:179], v[144:147]
    ds_read_b64_tr_b16 v[66:67], v232 offset:36864
    ds_read_b64_tr_b16 v[68:69], v233 offset:32768
    v_mfma_f32_16x16x32_bf16 v[148:151], a[140:143], a[176:179], v[148:151]
    ds_read_b64_tr_b16 v[70:71], v233 offset:36864
    ds_read_b64_tr_b16 v[72:73], v234 offset:32768
    v_mfma_f32_16x16x32_bf16 v[152:155], a[136:139], a[180:183], v[152:155]
    ds_read_b64_tr_b16 v[74:75], v234 offset:36864
    ds_read_b64_tr_b16 v[76:77], v235 offset:32768
    v_mfma_f32_16x16x32_bf16 v[156:159], a[140:143], a[180:183], v[156:159]
    ds_read_b64_tr_b16 v[78:79], v235 offset:36864
    v_mfma_f32_16x16x32_bf16 v[160:163], a[184:187], a[136:139], v[160:163]
    ds_read_b64_tr_b16 v[80:81], v236 offset:32768
    ds_read_b64_tr_b16 v[82:83], v236 offset:36864
    v_mfma_f32_16x16x32_bf16 v[164:167], a[184:187], a[140:143], v[164:167]
    ds_read_b64_tr_b16 v[84:85], v237 offset:32768
    s_waitcnt lgkmcnt(8)
    ds_read_b64_tr_b16 v[86:87], v237 offset:36864
    v_mfma_f32_16x16x32_bf16 v[168:171], a[188:191], a[136:139], v[168:171]
    ds_read_b64_tr_b16 v[88:89], v238 offset:32768
    ds_read_b64_tr_b16 v[90:91], v238 offset:36864
    v_mfma_f32_16x16x32_bf16 v[172:175], a[188:191], a[140:143], v[172:175]
    ds_read_b64_tr_b16 v[92:93], v239 offset:32768
    ds_read_b64_tr_b16 v[94:95], v239 offset:36864
    s_waitcnt lgkmcnt(10)
    v_mfma_f32_16x16x32_bf16 v[176:179], v[228:231], v[96:99], v[176:179]
    v_cmp_gt_u32 vcc, 32, v1
    v_mov_b32 v26, v52
    v_mul_f32 v40, 0.3225964182229561, v52
    v_mfma_f32_16x16x32_bf16 v[180:183], v[228:231], v[100:103], v[180:183]
    v_cndmask_b32 v42, v26, v40, vcc
    ds_bpermute_b32 v32, v44, v26 offset:0
    s_cmp_eq_u32 s40, 2
    s_cbranch_scc1 L_pack_50
L_packed_51:
    v_mfma_f32_16x16x32_bf16 v[112:115], v[64:67], a[144:147], v[112:115]
    ds_bpermute_b32 v33, v44, v26 offset:4
    ds_bpermute_b32 v34, v44, v26 offset:8
    v_mfma_f32_16x16x32_bf16 v[116:119], v[64:67], a[148:151], v[116:119]
    ds_bpermute_b32 v35, v44, v26 offset:12
    v_cvt_pk_bf16_f32 v45, v50, v50
    v_lshlrev_b32 v45, 16, v45
    v_sub_f32 v46, v50, v45
    v_cvt_pk_bf16_f32 v28, -v45, -v46
    v_cvt_pk_bf16_f32 v29, -v45, 0
    v_mfma_f32_16x16x32_bf16 v[120:123], v[68:71], a[144:147], v[120:123]
    v_mov_b32 v27, v53
    v_mul_f32 v41, 0.3225964182229561, v53
    v_mfma_f32_16x16x32_bf16 v[124:127], v[68:71], a[148:151], v[124:127]
    v_cndmask_b32 v43, v27, v41, vcc
    ds_bpermute_b32 v36, v44, v27 offset:0
    v_mfma_f32_16x16x32_bf16 v[128:131], v[72:75], a[144:147], v[128:131]
    s_waitcnt lgkmcnt(8)
    ds_bpermute_b32 v37, v44, v27 offset:4
    ds_bpermute_b32 v38, v44, v27 offset:8
    v_mfma_f32_16x16x32_bf16 v[132:135], v[72:75], a[148:151], v[132:135]
    ds_bpermute_b32 v39, v44, v27 offset:12
    v_cvt_pk_bf16_f32 v45, v51, v51
    v_lshlrev_b32 v45, 16, v45
    v_sub_f32 v46, v51, v45
    v_cvt_pk_bf16_f32 v30, -v45, -v46
    v_cvt_pk_bf16_f32 v31, -v45, 0
    s_waitcnt lgkmcnt(8)
    v_mfma_f32_16x16x32_bf16 v[136:139], a[144:147], v[76:79], v[136:139]
    v_cmp_gt_u32 vcc, 16, v1
    s_nop 1
    v_cndmask_b32 v28, 0, v28, vcc
    v_mfma_f32_16x16x32_bf16 v[140:143], a[148:151], v[76:79], v[140:143]
    v_cndmask_b32 v29, 0, v29, vcc
    v_cndmask_b32 v30, 0, v30, vcc
    v_mfma_f32_16x16x32_bf16 v[144:147], a[144:147], v[80:83], v[144:147]
    v_cndmask_b32 v31, 0, v31, vcc
    ds_read_b64_tr_b16 v[104:105], v184 offset:0
    v_mfma_f32_16x16x32_bf16 v[148:151], a[148:151], v[80:83], v[148:151]
    ds_read_b64_tr_b16 v[106:107], v184 offset:4096
    ds_read_b64_tr_b16 v[108:109], v185 offset:0
    v_mfma_f32_16x16x32_bf16 v[152:155], a[144:147], v[84:87], v[152:155]
    ds_read_b64_tr_b16 v[110:111], v185 offset:4096
    ds_read_b64_tr_b16 a[160:161], v232 offset:0
    v_mfma_f32_16x16x32_bf16 v[156:159], a[148:151], v[84:87], v[156:159]
    ds_read_b64_tr_b16 a[162:163], v232 offset:4096
    v_mfma_f32_16x16x32_bf16 v[160:163], v[88:91], a[144:147], v[160:163]
    ds_read_b64_tr_b16 a[164:165], v233 offset:0
    s_waitcnt lgkmcnt(8)
    ds_read_b64_tr_b16 a[166:167], v233 offset:4096
    v_mfma_f32_16x16x32_bf16 v[164:167], v[88:91], a[148:151], v[164:167]
    ds_read_b64_tr_b16 a[168:169], v234 offset:0
    ds_read_b64_tr_b16 a[170:171], v234 offset:4096
    v_mfma_f32_16x16x32_bf16 v[168:171], v[92:95], a[144:147], v[168:171]
    ds_read_b64_tr_b16 a[172:173], v235 offset:0
    ds_read_b64_tr_b16 a[174:175], v235 offset:4096
    v_mfma_f32_16x16x32_bf16 v[172:175], v[92:95], a[148:151], v[172:175]
    ds_read_b64_tr_b16 a[176:177], v236 offset:0
    ds_read_b64_tr_b16 a[178:179], v236 offset:4096
    s_waitcnt lgkmcnt(8)
    ds_read_b64_tr_b16 a[180:181], v237 offset:0
    ds_read_b64_tr_b16 a[182:183], v237 offset:4096
    ds_read_b64_tr_b16 a[184:185], v238 offset:0
    ds_read_b64_tr_b16 a[186:187], v238 offset:4096
    ds_read_b64_tr_b16 a[188:189], v239 offset:0
    ds_read_b64_tr_b16 a[190:191], v239 offset:4096
    s_barrier
    s_waitcnt lgkmcnt(10)
    v_mfma_f32_16x16x32_bf16 v[176:179], v[228:231], v[104:107], v[176:179]
    v_mfma_f32_16x16x32_bf16 v[180:183], v[228:231], v[108:111], v[180:183]
    s_cmp_eq_u32 s40, 3
    s_cbranch_scc1 L_pack_52
L_packed_53:
    v_mfma_f32_16x16x32_bf16 v[112:115], a[160:163], a[152:155], v[112:115]
    v_mfma_f32_16x16x32_bf16 v[116:119], a[160:163], a[156:159], v[116:119]
    s_lshl_b32 s48, s42, 10
    v_lshlrev_b32 v49, 3, v1
    v_add_u32 v189, s48, v49
    v_cvt_pk_bf16_f32 v45, v176, v176
    v_lshlrev_b32 v45, 16, v45
    v_sub_f32 v46, v176, v45
    v_cvt_pk_bf16_f32 v186, v45, v45
    v_cvt_pk_bf16_f32 v187, v46, 0
    v_mfma_f32_16x16x32_bf16 v[120:123], a[164:167], a[152:155], v[120:123]
    ds_write_b64 v189, v[186:187] offset:0
    v_mfma_f32_16x16x32_bf16 v[124:127], a[164:167], a[156:159], v[124:127]
    v_cvt_pk_bf16_f32 v45, v180, v180
    v_lshlrev_b32 v45, 16, v45
    v_sub_f32 v46, v180, v45
    v_cvt_pk_bf16_f32 v186, v45, v45
    v_cvt_pk_bf16_f32 v187, v46, 0
    ds_write_b64 v189, v[186:187] offset:512
    v_mfma_f32_16x16x32_bf16 v[128:131], a[168:171], a[152:155], v[128:131]
    v_mfma_f32_16x16x32_bf16 v[132:135], a[168:171], a[156:159], v[132:135]
    s_waitcnt lgkmcnt(2)
    v_mfma_f32_16x16x32_bf16 v[136:139], a[152:155], a[172:175], v[136:139]
    v_mfma_f32_16x16x32_bf16 v[140:143], a[156:159], a[172:175], v[140:143]
    v_mfma_f32_16x16x32_bf16 v[144:147], a[152:155], a[176:179], v[144:147]
    v_mfma_f32_16x16x32_bf16 v[148:151], a[156:159], a[176:179], v[148:151]
    v_mfma_f32_16x16x32_bf16 v[152:155], a[152:155], a[180:183], v[152:155]
    v_mfma_f32_16x16x32_bf16 v[156:159], a[156:159], a[180:183], v[156:159]
    v_mfma_f32_16x16x32_bf16 v[160:163], a[184:187], a[152:155], v[160:163]
    v_mfma_f32_16x16x32_bf16 v[164:167], a[184:187], a[156:159], v[164:167]
    v_mfma_f32_16x16x32_bf16 v[168:171], a[188:191], a[152:155], v[168:171]
    v_mfma_f32_16x16x32_bf16 v[172:175], a[188:191], a[156:159], v[172:175]
    s_waitcnt lgkmcnt(0)
    s_barrier
    ds_read_b64 a[216:217], v49 offset:0
    ds_read_b64 a[218:219], v49 offset:512
    ds_read_b64 a[220:221], v49 offset:1024
    ds_read_b64 a[222:223], v49 offset:1536
    ds_read_b64 a[224:225], v49 offset:2048
    ds_read_b64 a[226:227], v49 offset:2560
    ds_read_b64 a[228:229], v49 offset:3072
    ds_read_b64 a[230:231], v49 offset:3584
    s_waitcnt lgkmcnt(7)
    v_mfma_f32_16x16x16bf16_1k v[112:115], a[216:217], v[28:29], v[112:115]
    v_mfma_f32_16x16x16bf16_1k v[116:119], a[216:217], v[30:31], v[116:119]
    s_waitcnt lgkmcnt(6)
    v_mfma_f32_16x16x16bf16_1k v[120:123], a[218:219], v[28:29], v[120:123]
    v_mfma_f32_16x16x16bf16_1k v[124:127], a[218:219], v[30:31], v[124:127]
    s_waitcnt lgkmcnt(5)
    v_mfma_f32_16x16x16bf16_1k v[128:131], a[220:221], v[28:29], v[128:131]
    v_mfma_f32_16x16x16bf16_1k v[132:135], a[220:221], v[30:31], v[132:135]
    s_waitcnt lgkmcnt(4)
    v_mfma_f32_16x16x16bf16_1k v[136:139], v[28:29], a[222:223], v[136:139]
    v_mfma_f32_16x16x16bf16_1k v[140:143], v[30:31], a[222:223], v[140:143]
    s_waitcnt lgkmcnt(3)
    v_mfma_f32_16x16x16bf16_1k v[144:147], v[28:29], a[224:225], v[144:147]
    v_mfma_f32_16x16x16bf16_1k v[148:151], v[30:31], a[224:225], v[148:151]
    s_waitcnt lgkmcnt(2)
    v_mfma_f32_16x16x16bf16_1k v[152:155], v[28:29], a[226:227], v[152:155]
    v_mfma_f32_16x16x16bf16_1k v[156:159], v[30:31], a[226:227], v[156:159]
    s_waitcnt lgkmcnt(1)
    v_mfma_f32_16x16x16bf16_1k v[160:163], a[228:229], v[28:29], v[160:163]
    v_mfma_f32_16x16x16bf16_1k v[164:167], a[228:229], v[30:31], v[164:167]
    s_waitcnt lgkmcnt(0)
    v_mfma_f32_16x16x16bf16_1k v[168:171], a[230:231], v[28:29], v[168:171]
    v_mfma_f32_16x16x16bf16_1k v[172:175], a[230:231], v[30:31], v[172:175]
    v_mul_f32 v112, v112, v26
    v_mul_f32 v113, v113, v26
    v_mul_f32 v114, v114, v26
    v_mul_f32 v115, v115, v26
    v_cvt_pk_bf16_f32 v208, v112, v113
    v_cvt_pk_bf16_f32 v209, v114, v115
    v_mul_f32 v116, v116, v27
    v_mul_f32 v117, v117, v27
    v_mul_f32 v118, v118, v27
    v_mul_f32 v119, v119, v27
    v_cvt_pk_bf16_f32 v210, v116, v117
    v_cvt_pk_bf16_f32 v211, v118, v119
    s_nop 0
    v_permlane16_swap_b32 v208, v210
    v_permlane16_swap_b32 v209, v211
    buffer_store_dwordx4 v[208:211], v2, s[24:27], s82 offen offset:0 sc1
    ds_write_b128 v12, v[208:211] offset:0
    v_mul_f32 v120, v120, v26
    v_mul_f32 v121, v121, v26
    v_mul_f32 v122, v122, v26
    v_mul_f32 v123, v123, v26
    v_cvt_pk_bf16_f32 v212, v120, v121
    v_cvt_pk_bf16_f32 v213, v122, v123
    v_mul_f32 v124, v124, v27
    v_mul_f32 v125, v125, v27
    v_mul_f32 v126, v126, v27
    v_mul_f32 v127, v127, v27
    v_cvt_pk_bf16_f32 v214, v124, v125
    v_cvt_pk_bf16_f32 v215, v126, v127
    s_nop 0
    v_permlane16_swap_b32 v212, v214
    v_permlane16_swap_b32 v213, v215
    buffer_store_dwordx4 v[212:215], v2, s[24:27], s82 offen offset:1024 sc1
    ds_write_b128 v12, v[212:215] offset:1024
    v_mul_f32 v128, v128, v42
    v_mul_f32 v129, v129, v42
    v_mul_f32 v130, v130, v42
    v_mul_f32 v131, v131, v42
    v_cvt_pk_bf16_f32 v216, v128, v129
    v_cvt_pk_bf16_f32 v217, v130, v131
    v_mul_f32 v132, v132, v43
    v_mul_f32 v133, v133, v43
    v_mul_f32 v134, v134, v43
    v_mul_f32 v135, v135, v43
    v_cvt_pk_bf16_f32 v218, v132, v133
    v_cvt_pk_bf16_f32 v219, v134, v135
    s_nop 0
    v_permlane16_swap_b32 v216, v218
    v_permlane16_swap_b32 v217, v219
    s_mov_b32 exec_lo, 0
    buffer_store_dwordx4 v[216:219], v2, s[24:27], s82 offen offset:1536 sc1
    ds_write_b128 v12, v[216:219] offset:1536
    s_mov_b32 exec_lo, -1
    v_cmp_gt_u32 vcc, 32, v1
    s_nop 1
    v_cndmask_b32 v248, 0, v216, vcc
    v_cndmask_b32 v249, 0, v217, vcc
    v_cndmask_b32 v250, 0, v218, vcc
    v_cndmask_b32 v251, 0, v219, vcc
    v_mul_f32 v136, v136, v32
    v_mul_f32 v137, v137, v33
    v_mul_f32 v138, v138, v34
    v_mul_f32 v139, v139, v35
    v_cvt_pk_bf16_f32 v220, v136, v137
    v_cvt_pk_bf16_f32 v221, v138, v139
    v_mul_f32 v140, v140, v36
    v_mul_f32 v141, v141, v37
    v_mul_f32 v142, v142, v38
    v_mul_f32 v143, v143, v39
    v_cvt_pk_bf16_f32 v222, v140, v141
    v_cvt_pk_bf16_f32 v223, v142, v143
    s_nop 0
    v_permlane32_swap_b32 v220, v222
    v_permlane32_swap_b32 v221, v223
    buffer_store_dwordx4 v[220:223], v13, s[24:27], s82 offen offset:2560 sc1
    ds_write_b128 v14, v[220:223] offset:2560
    v_mul_f32 v144, v144, v32
    v_mul_f32 v145, v145, v33
    v_mul_f32 v146, v146, v34
    v_mul_f32 v147, v147, v35
    v_cvt_pk_bf16_f32 v224, v144, v145
    v_cvt_pk_bf16_f32 v225, v146, v147
    v_mul_f32 v148, v148, v36
    v_mul_f32 v149, v149, v37
    v_mul_f32 v150, v150, v38
    v_mul_f32 v151, v151, v39
    v_cvt_pk_bf16_f32 v226, v148, v149
    v_cvt_pk_bf16_f32 v227, v150, v151
    s_nop 0
    v_permlane32_swap_b32 v224, v226
    v_permlane32_swap_b32 v225, v227
    buffer_store_dwordx4 v[224:227], v13, s[24:27], s82 offen offset:2816 sc1
    ds_write_b128 v14, v[224:227] offset:2816
    v_mul_f32 v152, v152, v32
    v_mul_f32 v153, v153, v33
    v_mul_f32 v154, v154, v34
    v_mul_f32 v155, v155, v35
    v_cvt_pk_bf16_f32 v228, v152, v153
    v_cvt_pk_bf16_f32 v229, v154, v155
    v_mul_f32 v156, v156, v36
    v_mul_f32 v157, v157, v37
    v_mul_f32 v158, v158, v38
    v_mul_f32 v159, v159, v39
    v_cvt_pk_bf16_f32 v230, v156, v157
    v_cvt_pk_bf16_f32 v231, v158, v159
    s_nop 0
    v_permlane32_swap_b32 v228, v230
    v_permlane32_swap_b32 v229, v231
    v_cmp_eq_u32 vcc, 8, v15
    s_nop 1
    v_cndmask_b32 v228, v228, v60, vcc
    v_cndmask_b32 v229, v229, v60, vcc
    v_cndmask_b32 v230, v230, v60, vcc
    v_cndmask_b32 v231, v231, v60, vcc
    buffer_store_dwordx4 v[228:231], v13, s[24:27], s82 offen offset:3072 sc1
    ds_write_b128 v14, v[228:231] offset:3072
    s_lshl_b32 s48, s97, 5
    s_lshl_b32 s49, s64, 4
    s_add_u32 s48, s48, s49
    v_and_b32 v44, 15, v1
    v_add_u32 v44, s48, v44
    v_mul_u32_u24 v44, 1280, v44
    v_lshrrev_b32 v45, 4, v1
    v_lshl_add_u32 v44, v45, 3, v44
    s_mul_i32 s48, s43, 160
    buffer_load_dwordx2 v[16:17], v44, s[28:31], s48 offen offset:0
    buffer_load_dwordx2 v[18:19], v44, s[28:31], s48 offen offset:32
    buffer_load_dwordx2 v[20:21], v44, s[28:31], s48 offen offset:64
    buffer_load_dwordx2 v[22:23], v44, s[28:31], s48 offen offset:96
    buffer_load_dwordx2 v[24:25], v44, s[28:31], s48 offen offset:128
    v_pk_mul_f32 v[160:161], v[160:161], v[40:41] op_sel:[0,0] op_sel_hi:[1,0]
    v_pk_mul_f32 v[162:163], v[162:163], v[40:41] op_sel:[0,0] op_sel_hi:[1,0]
    v_cvt_pk_bf16_f32 v240, v160, v161
    v_cvt_pk_bf16_f32 v241, v162, v163
    v_pk_mul_f32 v[164:165], v[164:165], v[40:41] op_sel:[0,1] op_sel_hi:[1,1]
    v_pk_mul_f32 v[166:167], v[166:167], v[40:41] op_sel:[0,1] op_sel_hi:[1,1]
    v_cvt_pk_bf16_f32 v242, v164, v165
    v_cvt_pk_bf16_f32 v243, v166, v167
    s_nop 0
    v_permlane16_swap_b32 v240, v242
    v_permlane16_swap_b32 v241, v243
    v_pk_mul_f32 v[168:169], v[168:169], v[40:41] op_sel:[0,0] op_sel_hi:[1,0]
    v_pk_mul_f32 v[170:171], v[170:171], v[40:41] op_sel:[0,0] op_sel_hi:[1,0]
    v_cvt_pk_bf16_f32 v244, v168, v169
    v_cvt_pk_bf16_f32 v245, v170, v171
    v_pk_mul_f32 v[172:173], v[172:173], v[40:41] op_sel:[0,1] op_sel_hi:[1,1]
    v_pk_mul_f32 v[174:175], v[174:175], v[40:41] op_sel:[0,1] op_sel_hi:[1,1]
    v_cvt_pk_bf16_f32 v246, v172, v173
    v_cvt_pk_bf16_f32 v247, v174, v175
    s_nop 0
    v_permlane16_swap_b32 v244, v246
    v_permlane16_swap_b32 v245, v247
    v_and_b32 v44, 31, v1
    v_lshrrev_b32 v45, 5, v1
    v_lshlrev_b32 v46, 2, v45
    v_sub_u32 v46, v44, v46
    v_mov_b32 v47, 0xf149f2ca
    s_mul_i32 s48, s42, 5632
    v_add_u32 v32, s48, v2
    v_lshl_add_u32 v33, v44, 4, s48
    v_cmp_gt_u32 vcc, 20, v44
    v_mul_u32_u24 v48, 48, v45
    v_add_u32 v49, 0, v44
    v_cndmask_b32 v49, 40, v49, vcc
    v_add_u32 v49, v49, v48
    s_mul_i32 s48, s42, 5632
    v_lshl_add_u32 v34, v49, 4, s48
    v_add_u32 v49, 20, v44
    v_cndmask_b32 v49, 40, v49, vcc
    v_add_u32 v49, v49, v48
    s_mul_i32 s48, s42, 5632
    v_lshl_add_u32 v35, v49, 4, s48
    v_cmp_le_i32 vcc, 0, v46
    s_nop 1
    v_cndmask_b32 v208, v47, 0, vcc
    v_cndmask_b32 v224, 0, v47, vcc
    v_cmp_le_i32 vcc, 1, v46
    s_nop 1
    v_cndmask_b32 v209, v47, 0, vcc
    v_cndmask_b32 v225, 0, v47, vcc
    v_cmp_le_i32 vcc, 2, v46
    s_nop 1
    v_cndmask_b32 v210, v47, 0, vcc
    v_cndmask_b32 v226, 0, v47, vcc
    v_cmp_le_i32 vcc, 3, v46
    s_nop 1
    v_cndmask_b32 v211, v47, 0, vcc
    v_cndmask_b32 v227, 0, v47, vcc
    v_cmp_le_i32 vcc, 8, v46
    s_nop 1
    v_cndmask_b32 v212, v47, 0, vcc
    v_cndmask_b32 v228, 0, v47, vcc
    v_cmp_le_i32 vcc, 9, v46
    s_nop 1
    v_cndmask_b32 v213, v47, 0, vcc
    v_cndmask_b32 v229, 0, v47, vcc
    v_cmp_le_i32 vcc, 10, v46
    s_nop 1
    v_cndmask_b32 v214, v47, 0, vcc
    v_cndmask_b32 v230, 0, v47, vcc
    v_cmp_le_i32 vcc, 11, v46
    s_nop 1
    v_cndmask_b32 v215, v47, 0, vcc
    v_cndmask_b32 v231, 0, v47, vcc
    v_cmp_le_i32 vcc, 16, v46
    s_nop 1
    v_cndmask_b32 v216, v47, 0, vcc
    v_cndmask_b32 v232, 0, v47, vcc
    v_cmp_le_i32 vcc, 17, v46
    s_nop 1
    v_cndmask_b32 v217, v47, 0, vcc
    v_cndmask_b32 v233, 0, v47, vcc
    v_cmp_le_i32 vcc, 18, v46
    s_nop 1
    v_cndmask_b32 v218, v47, 0, vcc
    v_cndmask_b32 v234, 0, v47, vcc
    v_cmp_le_i32 vcc, 19, v46
    s_nop 1
    v_cndmask_b32 v219, v47, 0, vcc
    v_cndmask_b32 v235, 0, v47, vcc
    v_cmp_le_i32 vcc, 24, v46
    s_nop 1
    v_cndmask_b32 v220, v47, 0, vcc
    v_cndmask_b32 v236, 0, v47, vcc
    v_cmp_le_i32 vcc, 25, v46
    s_nop 1
    v_cndmask_b32 v221, v47, 0, vcc
    v_cndmask_b32 v237, 0, v47, vcc
    v_cmp_le_i32 vcc, 26, v46
    s_nop 1
    v_cndmask_b32 v222, v47, 0, vcc
    v_cndmask_b32 v238, 0, v47, vcc
    v_cmp_le_i32 vcc, 27, v46
    s_nop 1
    v_cndmask_b32 v223, v47, 0, vcc
    v_cndmask_b32 v239, 0, v47, vcc
    s_waitcnt lgkmcnt(0)
    s_waitcnt vmcnt(5)
    s_barrier
    s_cmp_lg_u32 s42, 0
    s_nop 0
    s_cbranch_scc1 L_w0_54
    s_add_u32 s48, s45, 16
    s_lshl_b32 s48, s48, 7
    s_add_u32 s48, s48, 4
    v_mul_u32_u24 v9, 133120, v1
    v_add_u32 v9, s48, v9
    v_mov_b32 v11, s62
    s_sub_u32 s48, 15, s40
    s_min_u32 s48, s48, 2
    s_bfm_b64 exec, s48, 0
    s_nop 0
    s_cbranch_execz L_nosig_55
    global_store_dword v9, v11, s[22:23] sc1
    s_nop 0
L_nosig_55:
    s_mov_b64 exec, -1
    s_nop 0
L_w0_54:
    s_cmp_lg_u32 s42, 0
    s_nop 0
    s_cbranch_scc1 L_w0_56
    v_lshlrev_b32 v9, 11, v1
    s_lshl_b32 s48, s41, 7
    s_add_u32 s48, s48, 131072
    v_add_u32 v9, s48, v9
    s_mov_b64 exec, 0xffff
    v_mov_b32 v11, 1
    global_atomic_add v9, v11, s[22:23] sc1
    s_mov_b64 exec, -1
    s_nop 0
L_w0_56:
L_layer:
    ds_read_b128 v[64:67], v32 offset:45056
    ds_read_b128 v[72:75], v33 offset:47104
    ds_read_b128 v[68:71], v32 offset:46080
    ds_read_b128 v[80:83], v34 offset:47616
    ds_read_b128 v[84:87], v34 offset:49152
    s_waitcnt lgkmcnt(4)
    v_mfma_f32_32x32x16_bf16 v[112:127], v[64:67], v[240:243], v[208:223]
    s_waitcnt lgkmcnt(3)
    s_nop 8
    v_mfma_f32_32x32x8bf16_1k v[112:127], v[72:73], v[248:249], v[112:127]
    s_waitcnt lgkmcnt(2)
    v_mfma_f32_32x32x16_bf16 v[128:143], v[68:71], v[244:247], v[208:223]
    s_nop 9
    v_exp_f32 v112, v112
    v_exp_f32 v113, v113
    v_exp_f32 v114, v114
    v_exp_f32 v115, v115
    v_exp_f32 v116, v116
    v_exp_f32 v117, v117
    v_exp_f32 v118, v118
    v_exp_f32 v119, v119
    v_cvt_pk_bf16_f32 v144, v112, v113
    v_cvt_pk_bf16_f32 v145, v114, v115
    v_mfma_f32_32x32x8bf16_1k v[128:143], v[74:75], v[250:251], v[128:143]
    v_exp_f32 v120, v120
    v_exp_f32 v121, v121
    v_exp_f32 v122, v122
    v_exp_f32 v123, v123
    v_cvt_pk_bf16_f32 v146, v116, v117
    v_cvt_pk_bf16_f32 v147, v118, v119
    ds_read_b128 v[88:91], v35 offset:47616
    ds_read_b128 v[92:95], v35 offset:49152
    v_exp_f32 v124, v124
    v_exp_f32 v125, v125
    v_exp_f32 v126, v126
    v_exp_f32 v127, v127
    v_cvt_pk_bf16_f32 v148, v120, v121
    v_cvt_pk_bf16_f32 v149, v122, v123
    v_cvt_pk_bf16_f32 v150, v124, v125
    v_cvt_pk_bf16_f32 v151, v126, v127
    v_exp_f32 v128, v128
    v_exp_f32 v129, v129
    v_exp_f32 v130, v130
    v_exp_f32 v131, v131
    s_waitcnt lgkmcnt(3)
    v_mfma_f32_32x32x16_bf16 v[176:191], v[80:83], v[144:147], 0
    v_exp_f32 v132, v132
    v_exp_f32 v133, v133
    v_exp_f32 v134, v134
    v_exp_f32 v135, v135
    v_cvt_pk_bf16_f32 v152, v128, v129
    v_cvt_pk_bf16_f32 v153, v130, v131
    s_cmp_lg_u32 s42, 0
    s_cbranch_scc1 L_hp_57
    s_lshl_b32 s48, s45, 7
    s_add_u32 s48, s48, 4
    s_add_u32 s50, s48, 131072
    s_cmp_lt_u32 s40, 2
    s_cselect_b32 s50, s48, s50
    v_and_b32 v37, 1, v1
    v_cmp_eq_u32 vcc, 0, v37
    v_mov_b32 v36, s50
    v_mov_b32 v37, s48
    v_cndmask_b32 v36, v36, v37, vcc
    global_load_dword v37, v36, s[22:23] sc1
    s_nop 0
L_hp_57:
    v_exp_f32 v136, v136
    v_exp_f32 v137, v137
    v_exp_f32 v138, v138
    v_exp_f32 v139, v139
    v_cvt_pk_bf16_f32 v154, v132, v133
    v_cvt_pk_bf16_f32 v155, v134, v135
    s_waitcnt lgkmcnt(2)
    v_mfma_f32_32x32x16_bf16 v[176:191], v[84:87], v[148:151], v[176:191]
    v_exp_f32 v140, v140
    v_exp_f32 v141, v141
    v_exp_f32 v142, v142
    v_exp_f32 v143, v143
    v_cvt_pk_bf16_f32 v156, v136, v137
    v_cvt_pk_bf16_f32 v157, v138, v139
    v_cvt_pk_bf16_f32 v158, v140, v141
    v_cvt_pk_bf16_f32 v159, v142, v143
    s_waitcnt lgkmcnt(1)
    v_mfma_f32_32x32x16_bf16 v[192:207], v[88:91], v[152:155], 0
    s_waitcnt lgkmcnt(0)
    v_mfma_f32_32x32x16_bf16 v[192:207], v[92:95], v[156:159], v[192:207]
    s_sub_u32 s51, s71, 720896
    s_cmp_lt_u32 s40, 2
    s_cselect_b32 s52, 0x7f000000, s51
    s_sub_u32 s51, s71, 382976
    s_cmp_lt_u32 s40, 1
    s_cselect_b32 s53, 0x7f000000, s51
    s_cmp_lt_u32 s42, 2
    s_cselect_b32 s54, s52, s53
    s_cmp_lg_u32 s42, 0
    s_nop 2
    s_cbranch_scc1 L_w0_58
    s_cmp_eq_u32 s40, 0
    s_nop 0
    s_cbranch_scc1 L_nokv_59
    s_waitcnt vmcnt(0)
    v_cmp_le_u32 vcc, s62, v37
    s_nop 1
    s_cmp_eq_u64 vcc, -1
    s_nop 1
    s_cbranch_scc1 L_fd_61
    s_mov_b32 s46, 0x200000
    s_nop 0
L_fl_60:
    global_load_dword v10, v36, s[22:23] sc1
    s_waitcnt vmcnt(0)
    v_cmp_le_u32 vcc, s62, v10
    s_nop 1
    s_cmp_eq_u64 vcc, -1
    s_nop 1
    s_cbranch_scc1 L_fd_61
    s_sub_u32 s46, s46, 1
    s_cmp_lg_u32 s46, 0
    s_nop 0
    s_cbranch_scc1 L_fl_60
    s_nop 0
L_fd_61:
L_nokv_59:
L_w0_58:
    s_barrier
    s_add_u32 m0, s66, 40960
    s_add_u32 s63, s53, 40960
    buffer_load_dwordx4 v8, s[24:27], s63 offen sc1 lds
    s_add_u32 m0, s66, 36864
    s_add_u32 s63, s53, 36864
    buffer_load_dwordx4 v8, s[24:27], s63 offen sc1 lds
    s_add_u32 m0, s66, 32768
    s_add_u32 s63, s53, 32768
    buffer_load_dwordx4 v8, s[24:27], s63 offen sc1 lds
    s_add_u32 m0, s66, 28672
    s_add_u32 s63, s53, 28672
    buffer_load_dwordx4 v8, s[24:27], s63 offen sc1 lds
    s_add_u32 m0, s66, 24576
    s_add_u32 s63, s53, 24576
    buffer_load_dwordx4 v8, s[24:27], s63 offen sc1 lds
    s_add_u32 m0, s66, 20480
    s_add_u32 s63, s54, 20480
    buffer_load_dwordx4 v8, s[24:27], s63 offen sc1 lds
    s_add_u32 m0, s66, 16384
    s_add_u32 s63, s52, 16384
    buffer_load_dwordx4 v8, s[24:27], s63 offen sc1 lds
    s_add_u32 m0, s66, 12288
    s_add_u32 s63, s52, 12288
    buffer_load_dwordx4 v8, s[24:27], s63 offen sc1 lds
    s_add_u32 m0, s66, 8192
    s_add_u32 s63, s52, 8192
    buffer_load_dwordx4 v8, s[24:27], s63 offen sc1 lds
    s_add_u32 m0, s66, 4096
    s_add_u32 s63, s52, 4096
    buffer_load_dwordx4 v8, s[24:27], s63 offen sc1 lds
    s_add_u32 m0, s66, 0
    s_add_u32 s63, s52, 0
    buffer_load_dwordx4 v8, s[24:27], s63 offen sc1 lds
    s_cmp_eq_u32 s62, 1
    s_nop 0
    s_cbranch_scc0 L_l1_62
    s_cmp_lt_u32 s70, 364
    s_nop 0
    s_cbranch_scc0 L_notask_63
    s_mov_b32 s36, s16
    s_mov_b32 s37, s17
    s_mov_b32 s38, 2211840
    s_mov_b32 s39, 0x20000
    v_accvgpr_read_b32 v44, a192
    v_accvgpr_read_b32 v45, a193
    v_accvgpr_read_b32 v46, a194
    v_accvgpr_read_b32 v47, a195
    v_accvgpr_read_b32 v48, a196
    s_add_u32 m0, s80, 114688
    s_nop 0
    buffer_load_dwordx4 v44, s[36:39], 0 offen nt lds
    s_add_u32 m0, s80, 115712
    s_nop 0
    buffer_load_dwordx4 v45, s[36:39], 0 offen nt lds
    s_add_u32 m0, s80, 116736
    s_nop 0
    buffer_load_dwordx4 v46, s[36:39], 0 offen nt lds
    s_add_u32 m0, s80, 117760
    s_nop 0
    buffer_load_dwordx4 v47, s[36:39], 0 offen nt lds
    s_add_u32 m0, s80, 118784
    s_nop 0
    buffer_load_dwordx4 v48, s[36:39], 0 offen nt lds
    s_nop 0
L_notask_63:
L_l1_62:
    s_waitcnt vmcnt(9)
    s_barrier
    ds_read_b128 v[64:67], v32 offset:39424
    ds_read_b128 v[76:79], v33 offset:41472
    ds_read_b128 v[68:71], v32 offset:40448
    ds_read_b128 v[96:99], v34 offset:41984
    ds_read_b128 v[100:103], v34 offset:43520
    s_waitcnt lgkmcnt(4)
    v_mfma_f32_32x32x16_bf16 v[112:127], v[64:67], v[240:243], 0
    s_waitcnt lgkmcnt(3)
    s_nop 8
    v_mfma_f32_32x32x8bf16_1k v[112:127], v[76:77], v[248:249], v[112:127]
    s_waitcnt vmcnt(8)
    s_barrier
    s_waitcnt lgkmcnt(2)
    v_mfma_f32_32x32x16_bf16 v[128:143], v[68:71], v[244:247], 0
    ds_read_b128 v[64:67], v32 offset:33792
    ds_read_b128 v[72:75], v33 offset:35840
    s_nop 5
    v_exp_f32 v112, v112
    v_exp_f32 v113, v113
    v_exp_f32 v114, v114
    v_exp_f32 v115, v115
    v_exp_f32 v116, v116
    v_exp_f32 v117, v117
    v_exp_f32 v118, v118
    v_exp_f32 v119, v119
    v_cvt_pk_bf16_f32 v144, v112, v113
    v_cvt_pk_bf16_f32 v145, v114, v115
    v_mfma_f32_32x32x8bf16_1k v[128:143], v[78:79], v[250:251], v[128:143]
    v_exp_f32 v120, v120
    v_exp_f32 v121, v121
    v_exp_f32 v122, v122
    v_exp_f32 v123, v123
    v_cvt_pk_bf16_f32 v146, v116, v117
    v_cvt_pk_bf16_f32 v147, v118, v119
    ds_read_b128 v[80:83], v35 offset:41984
    ds_read_b128 v[84:87], v35 offset:43520
    v_exp_f32 v124, v124
    v_exp_f32 v125, v125
    v_exp_f32 v126, v126
    v_exp_f32 v127, v127
    v_cvt_pk_bf16_f32 v148, v120, v121
    v_cvt_pk_bf16_f32 v149, v122, v123
    v_cvt_pk_bf16_f32 v150, v124, v125
    v_cvt_pk_bf16_f32 v151, v126, v127
    s_waitcnt lgkmcnt(3)
    v_mfma_f32_32x32x16_bf16 v[112:127], v[64:67], v[240:243], 0
    ds_read_b128 v[68:71], v32 offset:34816
    v_exp_f32 v128, v128
    v_exp_f32 v129, v129
    v_exp_f32 v130, v130
    v_exp_f32 v131, v131
    v_mfma_f32_32x32x16_bf16 v[176:191], v[96:99], v[144:147], v[176:191]
    v_exp_f32 v132, v132
    v_exp_f32 v133, v133
    v_exp_f32 v134, v134
    v_exp_f32 v135, v135
    v_cvt_pk_bf16_f32 v152, v128, v129
    v_cvt_pk_bf16_f32 v153, v130, v131
    s_waitcnt lgkmcnt(3)
    v_mfma_f32_32x32x8bf16_1k v[112:127], v[72:73], v[248:249], v[112:127]
    v_exp_f32 v136, v136
    v_exp_f32 v137, v137
    v_exp_f32 v138, v138
    v_exp_f32 v139, v139
    v_cvt_pk_bf16_f32 v154, v132, v133
    v_cvt_pk_bf16_f32 v155, v134, v135
    v_mfma_f32_32x32x16_bf16 v[176:191], v[100:103], v[148:151], v[176:191]
    ds_read_b128 v[88:91], v34 offset:36352
    ds_read_b128 v[92:95], v34 offset:37888
    v_exp_f32 v140, v140
    v_exp_f32 v141, v141
    v_exp_f32 v142, v142
    v_exp_f32 v143, v143
    v_cvt_pk_bf16_f32 v156, v136, v137
    v_cvt_pk_bf16_f32 v157, v138, v139
    v_cvt_pk_bf16_f32 v158, v140, v141
    v_cvt_pk_bf16_f32 v159, v142, v143
    s_waitcnt vmcnt(6)
    s_barrier
    s_waitcnt lgkmcnt(2)
    v_mfma_f32_32x32x16_bf16 v[128:143], v[68:71], v[244:247], 0
    ds_read_b128 v[64:67], v32 offset:28160
    ds_read_b128 v[76:79], v33 offset:30208
    v_exp_f32 v112, v112
    v_exp_f32 v113, v113
    v_exp_f32 v114, v114
    v_exp_f32 v115, v115
    v_mfma_f32_32x32x16_bf16 v[192:207], v[80:83], v[152:155], v[192:207]
    v_exp_f32 v116, v116
    v_exp_f32 v117, v117
    v_exp_f32 v118, v118
    v_exp_f32 v119, v119
    v_cvt_pk_bf16_f32 v144, v112, v113
    v_cvt_pk_bf16_f32 v145, v114, v115
    v_mfma_f32_32x32x8bf16_1k v[128:143], v[74:75], v[250:251], v[128:143]
    v_exp_f32 v120, v120
    v_exp_f32 v121, v121
    v_exp_f32 v122, v122
    v_exp_f32 v123, v123
    v_cvt_pk_bf16_f32 v146, v116, v117
    v_cvt_pk_bf16_f32 v147, v118, v119
    v_mfma_f32_32x32x16_bf16 v[192:207], v[84:87], v[156:159], v[192:207]
    ds_read_b128 v[96:99], v35 offset:36352
    ds_read_b128 v[100:103], v35 offset:37888
    v_exp_f32 v124, v124
    v_exp_f32 v125, v125
    v_exp_f32 v126, v126
    v_exp_f32 v127, v127
    v_cvt_pk_bf16_f32 v148, v120, v121
    v_cvt_pk_bf16_f32 v149, v122, v123
    v_cvt_pk_bf16_f32 v150, v124, v125
    v_cvt_pk_bf16_f32 v151, v126, v127
    s_waitcnt lgkmcnt(3)
    v_mfma_f32_32x32x16_bf16 v[112:127], v[64:67], v[240:243], 0
    ds_read_b128 v[68:71], v32 offset:29184
    v_exp_f32 v128, v128
    v_exp_f32 v129, v129
    v_exp_f32 v130, v130
    v_exp_f32 v131, v131
    v_mfma_f32_32x32x16_bf16 v[176:191], v[88:91], v[144:147], v[176:191]
    v_exp_f32 v132, v132
    v_exp_f32 v133, v133
    v_exp_f32 v134, v134
    v_exp_f32 v135, v135
    v_cvt_pk_bf16_f32 v152, v128, v129
    v_cvt_pk_bf16_f32 v153, v130, v131
    s_waitcnt lgkmcnt(3)
    v_mfma_f32_32x32x8bf16_1k v[112:127], v[76:77], v[248:249], v[112:127]
    v_exp_f32 v136, v136
    v_exp_f32 v137, v137
    v_exp_f32 v138, v138
    v_exp_f32 v139, v139
    v_cvt_pk_bf16_f32 v154, v132, v133
    v_cvt_pk_bf16_f32 v155, v134, v135
    v_mfma_f32_32x32x16_bf16 v[176:191], v[92:95], v[148:151], v[176:191]
    ds_read_b128 v[80:83], v34 offset:30720
    ds_read_b128 v[84:87], v34 offset:32256
    v_exp_f32 v140, v140
    v_exp_f32 v141, v141
    v_exp_f32 v142, v142
    v_exp_f32 v143, v143
    v_cvt_pk_bf16_f32 v156, v136, v137
    v_cvt_pk_bf16_f32 v157, v138, v139
    v_cvt_pk_bf16_f32 v158, v140, v141
    v_cvt_pk_bf16_f32 v159, v142, v143
    s_cmp_eq_u32 s62, 1
    s_nop 0
    s_cbranch_scc0 L_l1_64
    s_lshr_b32 s48, s40, 1
    s_lshl_b32 s48, s48, 12
    s_add_u32 s48, s48, 98304
    s_lshr_b32 s49, s43, 2
    s_add_u32 s49, s49, 0
    s_lshl_b32 s49, s49, 7
    s_add_u32 s48, s48, s49
    v_mov_b32 v53, s48
    global_load_dword v54, v53, s[22:23] sc1
    s_lshr_b32 s48, s40, 1
    s_lshl_b32 s48, s48, 12
    s_add_u32 s48, s48, 98304
    s_lshr_b32 s49, s41, 2
    s_mul_i32 s49, s49, 27
    s_and_b32 s50, s41, 3
    s_mul_i32 s51, s50, 7
    s_add_u32 s49, s49, s51
    s_min_u32 s50, s50, 1
    s_sub_u32 s49, s49, s50
    v_min_u32 v51, 6, v1
    v_add_u32 v51, s49, v51
    v_lshrrev_b32 v51, 2, v51
    v_add_u32 v51, 4, v51
    v_lshl_add_u32 v51, v51, 7, s48
    global_load_dword v52, v51, s[22:23] sc1
    s_add_u32 s48, s67, 3328
    v_mov_b32 v55, s48
    global_load_dwordx2 v[56:57], v55, s[22:23] sc1
    s_nop 0
L_l1_64:
    s_waitcnt vmcnt(4)
    s_barrier
    s_waitcnt lgkmcnt(2)
    v_mfma_f32_32x32x16_bf16 v[128:143], v[68:71], v[244:247], 0
    ds_read_b128 v[64:67], v32 offset:22528
    ds_read_b128 v[72:75], v33 offset:24576
    v_exp_f32 v112, v112
    v_exp_f32 v113, v113
    v_exp_f32 v114, v114
    v_exp_f32 v115, v115
    v_mfma_f32_32x32x16_bf16 v[192:207], v[96:99], v[152:155], v[192:207]
    v_exp_f32 v116, v116
    v_exp_f32 v117, v117
    v_exp_f32 v118, v118
    v_exp_f32 v119, v119
    v_cvt_pk_bf16_f32 v144, v112, v113
    v_cvt_pk_bf16_f32 v145, v114, v115
    v_mfma_f32_32x32x8bf16_1k v[128:143], v[78:79], v[250:251], v[128:143]
    v_exp_f32 v120, v120
    v_exp_f32 v121, v121
    v_exp_f32 v122, v122
    v_exp_f32 v123, v123
    v_cvt_pk_bf16_f32 v146, v116, v117
    v_cvt_pk_bf16_f32 v147, v118, v119
    v_mfma_f32_32x32x16_bf16 v[192:207], v[100:103], v[156:159], v[192:207]
    ds_read_b128 v[88:91], v35 offset:30720
    ds_read_b128 v[92:95], v35 offset:32256
    v_exp_f32 v124, v124
    v_exp_f32 v125, v125
    v_exp_f32 v126, v126
    v_exp_f32 v127, v127
    v_cvt_pk_bf16_f32 v148, v120, v121
    v_cvt_pk_bf16_f32 v149, v122, v123
    v_cvt_pk_bf16_f32 v150, v124, v125
    v_cvt_pk_bf16_f32 v151, v126, v127
    s_waitcnt lgkmcnt(3)
    v_mfma_f32_32x32x16_bf16 v[112:127], v[64:67], v[240:243], 0
    ds_read_b128 v[68:71], v32 offset:23552
    v_exp_f32 v128, v128
    v_exp_f32 v129, v129
    v_exp_f32 v130, v130
    v_exp_f32 v131, v131
    v_mfma_f32_32x32x16_bf16 v[176:191], v[80:83], v[144:147], v[176:191]
    v_exp_f32 v132, v132
    v_exp_f32 v133, v133
    v_exp_f32 v134, v134
    v_exp_f32 v135, v135
    v_cvt_pk_bf16_f32 v152, v128, v129
    v_cvt_pk_bf16_f32 v153, v130, v131
    s_waitcnt lgkmcnt(3)
    v_mfma_f32_32x32x8bf16_1k v[112:127], v[72:73], v[248:249], v[112:127]
    v_exp_f32 v136, v136
    v_exp_f32 v137, v137
    v_exp_f32 v138, v138
    v_exp_f32 v139, v139
    v_cvt_pk_bf16_f32 v154, v132, v133
    v_cvt_pk_bf16_f32 v155, v134, v135
    v_mfma_f32_32x32x16_bf16 v[176:191], v[84:87], v[148:151], v[176:191]
    ds_read_b128 v[96:99], v34 offset:25088
    ds_read_b128 v[100:103], v34 offset:26624
    v_exp_f32 v140, v140
    v_exp_f32 v141, v141
    v_exp_f32 v142, v142
    v_exp_f32 v143, v143
    v_cvt_pk_bf16_f32 v156, v136, v137
    v_cvt_pk_bf16_f32 v157, v138, v139
    v_cvt_pk_bf16_f32 v158, v140, v141
    v_cvt_pk_bf16_f32 v159, v142, v143
    s_cmp_eq_u32 s62, 1
    s_nop 0
    s_cbranch_scc0 L_l1_65
    s_waitcnt vmcnt(0)
    v_cmp_le_u32 vcc, 1, v54
    s_nop 1
    s_cmp_eq_u64 vcc, -1
    s_nop 1
    s_cbranch_scc1 L_fd_67
    s_mov_b32 s46, 0x200000
    s_nop 0
L_fl_66:
    global_load_dword v10, v53, s[22:23] sc1
    s_waitcnt vmcnt(0)
    v_cmp_le_u32 vcc, 1, v10
    s_nop 1
    s_cmp_eq_u64 vcc, -1
    s_nop 1
    s_cbranch_scc1 L_fd_67
    s_sub_u32 s46, s46, 1
    s_cmp_lg_u32 s46, 0
    s_nop 0
    s_cbranch_scc1 L_fl_66
    s_nop 0
L_fd_67:
    s_mov_b32 s46, 0x200000
    s_nop 0
L_xc_68:
    v_readfirstlane_b32 s48, v56
    v_readfirstlane_b32 s49, v57
    s_nop 1
    s_add_u32 s50, s48, s49
    s_lshr_b32 s51, s50, 16
    s_add_u32 s50, s50, s51
    s_lshr_b32 s51, s50, 8
    s_add_u32 s50, s50, s51
    s_and_b32 s50, s50, 0xff
    s_cmp_eq_u32 s50, 16
    s_nop 0
    s_cbranch_scc1 L_xd_69
    global_load_dwordx2 v[56:57], v55, s[22:23] sc1
    s_waitcnt vmcnt(0)
    s_sub_u32 s46, s46, 1
    s_cmp_lg_u32 s46, 0
    s_nop 0
    s_cbranch_scc1 L_xc_68
    s_nop 0
L_xd_69:
    s_getreg_b32 s50, hwreg(HW_REG_XCC_ID, 0, 3)
    s_lshl_b32 s50, s50, 3
    s_lshl_b64 s[50:51], 16, s50
    s_cmp_eq_u64 s[48:49], s[50:51]
    s_cselect_b32 s74, 51736576, 0
    s_cselect_b32 s78, 0, 51736576
    v_cmp_le_u32 vcc, 1, v52
    s_nop 1
    s_cmp_eq_u64 vcc, -1
    s_nop 1
    s_cbranch_scc1 L_fd_71
    s_mov_b32 s46, 0x200000
    s_nop 0
L_fl_70:
    global_load_dword v10, v51, s[22:23] sc1
    s_waitcnt vmcnt(0)
    v_cmp_le_u32 vcc, 1, v10
    s_nop 1
    s_cmp_eq_u64 vcc, -1
    s_nop 1
    s_cbranch_scc1 L_fd_71
    s_sub_u32 s46, s46, 1
    s_cmp_lg_u32 s46, 0
    s_nop 0
    s_cbranch_scc1 L_fl_70
    s_nop 0
L_fd_71:
    s_lshr_b32 s48, s41, 2
    s_mul_i32 s48, s48, 27
    s_and_b32 s49, s41, 3
    s_mul_i32 s50, s49, 7
    s_add_u32 s48, s48, s50
    s_min_u32 s49, s49, 1
    s_sub_u32 s48, s48, s49
    s_lshl_b32 s48, s48, 7
    s_add_u32 s48, s48, 11386880
    buffer_load_dwordx4 a[0:3], v2, s[24:27], s48 offen sc1
    s_add_u32 s48, s48, 13824
    buffer_load_dwordx4 a[4:7], v2, s[24:27], s48 offen sc1
    s_add_u32 s48, s48, 13824
    buffer_load_dwordx4 a[8:11], v2, s[24:27], s48 offen sc1
    s_add_u32 s48, s48, 13824
    buffer_load_dwordx4 a[12:15], v2, s[24:27], s48 offen sc1
    s_add_u32 s48, s48, 13824
    buffer_load_dwordx4 a[16:19], v2, s[24:27], s48 offen sc1
    s_add_u32 s48, s48, 13824
    buffer_load_dwordx4 a[20:23], v2, s[24:27], s48 offen sc1
    s_add_u32 s48, s48, 13824
    buffer_load_dwordx4 a[24:27], v2, s[24:27], s48 offen sc1
    s_add_u32 s48, s48, 13824
    buffer_load_dwordx4 a[28:31], v2, s[24:27], s48 offen sc1
    s_nop 0
L_l1_65:
    s_waitcnt lgkmcnt(2)
    v_mfma_f32_32x32x16_bf16 v[128:143], v[68:71], v[244:247], 0
    ds_read_b128 v[64:67], v32 offset:16896
    ds_read_b128 v[76:79], v33 offset:18944
    v_exp_f32 v112, v112
    v_exp_f32 v113, v113
    v_exp_f32 v114, v114
    v_exp_f32 v115, v115
    s_add_u32 m0, s68, 139264
    s_add_u32 s63, s99, 0
    buffer_load_dwordx4 v253, s[24:27], s63 offen offset:0 sc1 lds
    v_mfma_f32_32x32x16_bf16 v[192:207], v[88:91], v[152:155], v[192:207]
    v_exp_f32 v116, v116
    v_exp_f32 v117, v117
    v_exp_f32 v118, v118
    v_exp_f32 v119, v119
    v_cvt_pk_bf16_f32 v144, v112, v113
    v_cvt_pk_bf16_f32 v145, v114, v115
    buffer_load_dwordx4 v253, s[24:27], s63 offen offset:1024 sc1 lds
    v_mfma_f32_32x32x8bf16_1k v[128:143], v[74:75], v[250:251], v[128:143]
    v_exp_f32 v120, v120
    v_exp_f32 v121, v121
    v_exp_f32 v122, v122
    v_exp_f32 v123, v123
    v_cvt_pk_bf16_f32 v146, v116, v117
    v_cvt_pk_bf16_f32 v147, v118, v119
    s_add_u32 m0, s68, 147456
    s_add_u32 s63, s99, 8192
    buffer_load_dwordx4 v253, s[24:27], s63 offen offset:0 sc1 lds
    v_mfma_f32_32x32x16_bf16 v[192:207], v[92:95], v[156:159], v[192:207]
    ds_read_b128 v[80:83], v35 offset:25088
    ds_read_b128 v[84:87], v35 offset:26624
    v_exp_f32 v124, v124
    v_exp_f32 v125, v125
    v_exp_f32 v126, v126
    v_exp_f32 v127, v127
    v_cvt_pk_bf16_f32 v148, v120, v121
    v_cvt_pk_bf16_f32 v149, v122, v123
    buffer_load_dwordx4 v253, s[24:27], s63 offen offset:1024 sc1 lds
    v_cvt_pk_bf16_f32 v150, v124, v125
    v_cvt_pk_bf16_f32 v151, v126, v127
    s_waitcnt lgkmcnt(3)
    v_mfma_f32_32x32x16_bf16 v[112:127], v[64:67], v[240:243], 0
    ds_read_b128 v[68:71], v32 offset:17920
    v_exp_f32 v128, v128
    v_exp_f32 v129, v129
    v_exp_f32 v130, v130
    v_exp_f32 v131, v131
    v_mfma_f32_32x32x16_bf16 v[176:191], v[96:99], v[144:147], v[176:191]
    v_exp_f32 v132, v132
    v_exp_f32 v133, v133
    v_exp_f32 v134, v134
    v_exp_f32 v135, v135
    v_cvt_pk_bf16_f32 v152, v128, v129
    v_cvt_pk_bf16_f32 v153, v130, v131
    s_add_u32 m0, s68, 155648
    s_add_u32 s63, s99, 16384
    buffer_load_dwordx4 v253, s[24:27], s63 offen offset:0 sc1 lds
    s_waitcnt lgkmcnt(3)
    v_mfma_f32_32x32x8bf16_1k v[112:127], v[76:77], v[248:249], v[112:127]
    v_exp_f32 v136, v136
    v_exp_f32 v137, v137
    v_exp_f32 v138, v138
    v_exp_f32 v139, v139
    v_cvt_pk_bf16_f32 v154, v132, v133
    v_cvt_pk_bf16_f32 v155, v134, v135
    v_mfma_f32_32x32x16_bf16 v[176:191], v[100:103], v[148:151], v[176:191]
    ds_read_b128 v[88:91], v34 offset:19456
    ds_read_b128 v[92:95], v34 offset:20992
    v_exp_f32 v140, v140
    v_exp_f32 v141, v141
    v_exp_f32 v142, v142
    v_exp_f32 v143, v143
    v_cvt_pk_bf16_f32 v156, v136, v137
    v_cvt_pk_bf16_f32 v157, v138, v139
    buffer_load_dwordx4 v253, s[24:27], s63 offen offset:1024 sc1 lds
    v_cvt_pk_bf16_f32 v158, v140, v141
    v_cvt_pk_bf16_f32 v159, v142, v143
    s_waitcnt vmcnt(6)
    s_barrier
    s_waitcnt lgkmcnt(2)
    v_mfma_f32_32x32x16_bf16 v[128:143], v[68:71], v[244:247], 0
    ds_read_b128 v[64:67], v32 offset:11264
    ds_read_b128 v[72:75], v33 offset:13312
    v_exp_f32 v112, v112
    v_exp_f32 v113, v113
    v_exp_f32 v114, v114
    v_exp_f32 v115, v115
    v_mfma_f32_32x32x16_bf16 v[192:207], v[80:83], v[152:155], v[192:207]
    v_exp_f32 v116, v116
    v_exp_f32 v117, v117
    v_exp_f32 v118, v118
    v_exp_f32 v119, v119
    v_cvt_pk_bf16_f32 v144, v112, v113
    v_cvt_pk_bf16_f32 v145, v114, v115
    s_add_u32 m0, s68, 73728
    s_add_u32 s63, s99, 24576
    buffer_load_dwordx4 v253, s[24:27], s63 offen offset:0 sc1 lds
    v_mfma_f32_32x32x8bf16_1k v[128:143], v[78:79], v[250:251], v[128:143]
    v_exp_f32 v120, v120
    v_exp_f32 v121, v121
    v_exp_f32 v122, v122
    v_exp_f32 v123, v123
    v_cvt_pk_bf16_f32 v146, v116, v117
    v_cvt_pk_bf16_f32 v147, v118, v119
    v_mfma_f32_32x32x16_bf16 v[192:207], v[84:87], v[156:159], v[192:207]
    ds_read_b128 v[96:99], v35 offset:19456
    ds_read_b128 v[100:103], v35 offset:20992
    v_exp_f32 v124, v124
    v_exp_f32 v125, v125
    v_exp_f32 v126, v126
    v_exp_f32 v127, v127
    v_cvt_pk_bf16_f32 v148, v120, v121
    v_cvt_pk_bf16_f32 v149, v122, v123
    buffer_load_dwordx4 v253, s[24:27], s63 offen offset:1024 sc1 lds
    v_cvt_pk_bf16_f32 v150, v124, v125
    v_cvt_pk_bf16_f32 v151, v126, v127
    s_cmp_eq_u32 s62, 1
    s_nop 0
    s_cbranch_scc0 L_l1_72
    s_cmp_lt_u32 s70, 364
    s_nop 0
    s_cbranch_scc0 L_notask_73
    v_accvgpr_read_b32 v44, a197
    v_accvgpr_read_b32 v45, a198
    ds_read_b64_tr_b16 v[160:161], v44 offset:0
    ds_read_b64_tr_b16 v[162:163], v44 offset:10240
    ds_read_b64_tr_b16 v[164:165], v44 offset:32
    ds_read_b64_tr_b16 v[166:167], v44 offset:10272
    ds_read_b64_tr_b16 v[168:169], v44 offset:64
    ds_read_b64_tr_b16 v[170:171], v44 offset:10304
    ds_read_b64_tr_b16 v[172:173], v44 offset:96
    ds_read_b64_tr_b16 v[174:175], v44 offset:10336
    ds_read_b64_tr_b16 v[104:105], v44 offset:128
    s_waitcnt lgkmcnt(8)
    ds_read_b64_tr_b16 v[106:107], v44 offset:10368
    s_mov_b32 s48, 4096
    s_mov_b32 s49, 8192
    s_waitcnt lgkmcnt(8)
    buffer_store_dwordx4 v[160:163], v45, s[24:27], 0 offen offset:0 sc1
    s_waitcnt lgkmcnt(6)
    buffer_store_dwordx4 v[164:167], v45, s[24:27], 0 offen offset:2048 sc1
    s_waitcnt lgkmcnt(4)
    buffer_store_dwordx4 v[168:171], v45, s[24:27], s48 offen offset:0 sc1
    s_waitcnt lgkmcnt(2)
    buffer_store_dwordx4 v[172:175], v45, s[24:27], s48 offen offset:2048 sc1
    s_waitcnt lgkmcnt(0)
    buffer_store_dwordx4 v[104:107], v45, s[24:27], s49 offen offset:0 sc1
    s_nop 1
L_notask_73:
L_l1_72:
    s_waitcnt lgkmcnt(3)
    v_mfma_f32_32x32x16_bf16 v[112:127], v[64:67], v[240:243], 0
    ds_read_b128 v[68:71], v32 offset:12288
    v_exp_f32 v128, v128
    v_exp_f32 v129, v129
    v_exp_f32 v130, v130
    v_exp_f32 v131, v131
    s_add_u32 m0, s68, 81920
    s_add_u32 s63, s99, 32768
    buffer_load_dwordx4 v253, s[24:27], s63 offen offset:0 sc1 lds
    v_mfma_f32_32x32x16_bf16 v[176:191], v[88:91], v[144:147], v[176:191]
    v_exp_f32 v132, v132
    v_exp_f32 v133, v133
    v_exp_f32 v134, v134
    v_exp_f32 v135, v135
    v_cvt_pk_bf16_f32 v152, v128, v129
    v_cvt_pk_bf16_f32 v153, v130, v131
    buffer_load_dwordx4 v253, s[24:27], s63 offen offset:1024 sc1 lds
    s_waitcnt lgkmcnt(3)
    v_mfma_f32_32x32x8bf16_1k v[112:127], v[72:73], v[248:249], v[112:127]
    v_exp_f32 v136, v136
    v_exp_f32 v137, v137
    v_exp_f32 v138, v138
    v_exp_f32 v139, v139
    v_cvt_pk_bf16_f32 v154, v132, v133
    v_cvt_pk_bf16_f32 v155, v134, v135
    s_add_u32 m0, s68, 90112
    s_add_u32 s63, s100, 0
    buffer_load_dwordx4 v253, s[24:27], s63 offen offset:0 sc1 lds
    v_mfma_f32_32x32x16_bf16 v[176:191], v[92:95], v[148:151], v[176:191]
    ds_read_b128 v[80:83], v34 offset:13824
    ds_read_b128 v[84:87], v34 offset:15360
    v_exp_f32 v140, v140
    v_exp_f32 v141, v141
    v_exp_f32 v142, v142
    v_exp_f32 v143, v143
    v_cvt_pk_bf16_f32 v156, v136, v137
    v_cvt_pk_bf16_f32 v157, v138, v139
    buffer_load_dwordx4 v253, s[24:27], s63 offen offset:1024 sc1 lds
    v_cvt_pk_bf16_f32 v158, v140, v141
    v_cvt_pk_bf16_f32 v159, v142, v143
    s_waitcnt lgkmcnt(2)
    v_mfma_f32_32x32x16_bf16 v[128:143], v[68:71], v[244:247], 0
    ds_read_b128 v[64:67], v32 offset:5632
    ds_read_b128 v[76:79], v33 offset:7680
    v_exp_f32 v112, v112
    v_exp_f32 v113, v113
    v_exp_f32 v114, v114
    v_exp_f32 v115, v115
    v_mfma_f32_32x32x16_bf16 v[192:207], v[96:99], v[152:155], v[192:207]
    v_exp_f32 v116, v116
    v_exp_f32 v117, v117
    v_exp_f32 v118, v118
    v_exp_f32 v119, v119
    v_cvt_pk_bf16_f32 v144, v112, v113
    v_cvt_pk_bf16_f32 v145, v114, v115
    s_add_u32 m0, s68, 98304
    s_add_u32 s63, s100, 8192
    buffer_load_dwordx4 v253, s[24:27], s63 offen offset:0 sc1 lds
    v_mfma_f32_32x32x8bf16_1k v[128:143], v[74:75], v[250:251], v[128:143]
    v_exp_f32 v120, v120
    v_exp_f32 v121, v121
    v_exp_f32 v122, v122
    v_exp_f32 v123, v123
    v_cvt_pk_bf16_f32 v146, v116, v117
    v_cvt_pk_bf16_f32 v147, v118, v119
    v_mfma_f32_32x32x16_bf16 v[192:207], v[100:103], v[156:159], v[192:207]
    ds_read_b128 v[88:91], v35 offset:13824
    ds_read_b128 v[92:95], v35 offset:15360
    v_exp_f32 v124, v124
    v_exp_f32 v125, v125
    v_exp_f32 v126, v126
    v_exp_f32 v127, v127
    v_cvt_pk_bf16_f32 v148, v120, v121
    v_cvt_pk_bf16_f32 v149, v122, v123
    buffer_load_dwordx4 v253, s[24:27], s63 offen offset:1024 sc1 lds
    v_cvt_pk_bf16_f32 v150, v124, v125
    v_cvt_pk_bf16_f32 v151, v126, v127
    s_barrier
    s_waitcnt lgkmcnt(3)
    v_mfma_f32_32x32x16_bf16 v[112:127], v[64:67], v[240:243], 0
    ds_read_b128 v[68:71], v32 offset:6656
    v_exp_f32 v128, v128
    v_exp_f32 v129, v129
    v_exp_f32 v130, v130
    v_exp_f32 v131, v131
    v_mfma_f32_32x32x16_bf16 v[176:191], v[80:83], v[144:147], v[176:191]
    v_exp_f32 v132, v132
    v_exp_f32 v133, v133
    v_exp_f32 v134, v134
    v_exp_f32 v135, v135
    v_cvt_pk_bf16_f32 v152, v128, v129
    v_cvt_pk_bf16_f32 v153, v130, v131
    s_add_u32 m0, s68, 106496
    s_add_u32 s63, s100, 16384
    buffer_load_dwordx4 v253, s[24:27], s63 offen offset:0 sc1 lds
    s_waitcnt lgkmcnt(3)
    v_mfma_f32_32x32x8bf16_1k v[112:127], v[76:77], v[248:249], v[112:127]
    v_exp_f32 v136, v136
    v_exp_f32 v137, v137
    v_exp_f32 v138, v138
    v_exp_f32 v139, v139
    v_cvt_pk_bf16_f32 v154, v132, v133
    v_cvt_pk_bf16_f32 v155, v134, v135
    v_mfma_f32_32x32x16_bf16 v[176:191], v[84:87], v[148:151], v[176:191]
    ds_read_b128 v[96:99], v34 offset:8192
    ds_read_b128 v[100:103], v34 offset:9728
    v_exp_f32 v140, v140
    v_exp_f32 v141, v141
    v_exp_f32 v142, v142
    v_exp_f32 v143, v143
    v_cvt_pk_bf16_f32 v156, v136, v137
    v_cvt_pk_bf16_f32 v157, v138, v139
    buffer_load_dwordx4 v253, s[24:27], s63 offen offset:1024 sc1 lds
    v_cvt_pk_bf16_f32 v158, v140, v141
    v_cvt_pk_bf16_f32 v159, v142, v143
    s_waitcnt lgkmcnt(2)
    v_mfma_f32_32x32x16_bf16 v[128:143], v[68:71], v[244:247], 0
    ds_read_b128 v[64:67], v32 offset:0
    ds_read_b128 v[72:75], v33 offset:2048
    v_exp_f32 v112, v112
    v_exp_f32 v113, v113
    v_exp_f32 v114, v114
    v_exp_f32 v115, v115
    s_add_u32 m0, s68, 114688
    s_add_u32 s63, s100, 24576
    buffer_load_dwordx4 v253, s[24:27], s63 offen offset:0 sc1 lds
    v_mfma_f32_32x32x16_bf16 v[192:207], v[88:91], v[152:155], v[192:207]
    v_exp_f32 v116, v116
    v_exp_f32 v117, v117
    v_exp_f32 v118, v118
    v_exp_f32 v119, v119
    v_cvt_pk_bf16_f32 v144, v112, v113
    v_cvt_pk_bf16_f32 v145, v114, v115
    buffer_load_dwordx4 v253, s[24:27], s63 offen offset:1024 sc1 lds
    v_mfma_f32_32x32x8bf16_1k v[128:143], v[78:79], v[250:251], v[128:143]
    v_exp_f32 v120, v120
    v_exp_f32 v121, v121
    v_exp_f32 v122, v122
    v_exp_f32 v123, v123
    v_cvt_pk_bf16_f32 v146, v116, v117
    v_cvt_pk_bf16_f32 v147, v118, v119
    s_add_u32 m0, s68, 122880
    s_add_u32 s63, s100, 32768
    buffer_load_dwordx4 v253, s[24:27], s63 offen offset:0 sc1 lds
    v_mfma_f32_32x32x16_bf16 v[192:207], v[92:95], v[156:159], v[192:207]
    ds_read_b128 v[80:83], v35 offset:8192
    ds_read_b128 v[84:87], v35 offset:9728
    v_exp_f32 v124, v124
    v_exp_f32 v125, v125
    v_exp_f32 v126, v126
    v_exp_f32 v127, v127
    v_cvt_pk_bf16_f32 v148, v120, v121
    v_cvt_pk_bf16_f32 v149, v122, v123
    buffer_load_dwordx4 v253, s[24:27], s63 offen offset:1024 sc1 lds
    v_cvt_pk_bf16_f32 v150, v124, v125
    v_cvt_pk_bf16_f32 v151, v126, v127
    s_waitcnt lgkmcnt(3)
    v_mfma_f32_32x32x16_bf16 v[112:127], v[64:67], v[240:243], v[224:239]
    ds_read_b128 v[68:71], v32 offset:1024
    v_exp_f32 v128, v128
    v_exp_f32 v129, v129
    v_exp_f32 v130, v130
    v_exp_f32 v131, v131
    v_mfma_f32_32x32x16_bf16 v[176:191], v[96:99], v[144:147], v[176:191]
    v_exp_f32 v132, v132
    v_exp_f32 v133, v133
    v_exp_f32 v134, v134
    v_exp_f32 v135, v135
    v_cvt_pk_bf16_f32 v152, v128, v129
    v_cvt_pk_bf16_f32 v153, v130, v131
    s_add_u32 m0, s68, 131072
    s_add_u32 s63, s100, 40960
    buffer_load_dwordx4 v253, s[24:27], s63 offen offset:0 sc1 lds
    s_waitcnt lgkmcnt(3)
    v_mfma_f32_32x32x8bf16_1k v[112:127], v[72:73], v[248:249], v[112:127]
    v_exp_f32 v136, v136
    v_exp_f32 v137, v137
    v_exp_f32 v138, v138
    v_exp_f32 v139, v139
    v_cvt_pk_bf16_f32 v154, v132, v133
    v_cvt_pk_bf16_f32 v155, v134, v135
    v_mfma_f32_32x32x16_bf16 v[176:191], v[100:103], v[148:151], v[176:191]
    ds_read_b128 v[88:91], v34 offset:2560
    ds_read_b128 v[92:95], v34 offset:4096
    v_exp_f32 v140, v140
    v_exp_f32 v141, v141
    v_exp_f32 v142, v142
    v_exp_f32 v143, v143
    v_cvt_pk_bf16_f32 v156, v136, v137
    v_cvt_pk_bf16_f32 v157, v138, v139
    buffer_load_dwordx4 v253, s[24:27], s63 offen offset:1024 sc1 lds
    v_cvt_pk_bf16_f32 v158, v140, v141
    v_cvt_pk_bf16_f32 v159, v142, v143
    s_waitcnt lgkmcnt(2)
    v_mfma_f32_32x32x16_bf16 v[128:143], v[68:71], v[244:247], v[224:239]
    v_exp_f32 v112, v112
    v_exp_f32 v113, v113
    v_exp_f32 v114, v114
    v_exp_f32 v115, v115
    v_mfma_f32_32x32x16_bf16 v[192:207], v[80:83], v[152:155], v[192:207]
    v_exp_f32 v116, v116
    v_exp_f32 v117, v117
    v_exp_f32 v118, v118
    v_exp_f32 v119, v119
    v_cvt_pk_bf16_f32 v144, v112, v113
    v_cvt_pk_bf16_f32 v145, v114, v115
    v_mfma_f32_32x32x8bf16_1k v[128:143], v[74:75], v[250:251], v[128:143]
    v_exp_f32 v120, v120
    v_exp_f32 v121, v121
    v_exp_f32 v122, v122
    v_exp_f32 v123, v123
    v_cvt_pk_bf16_f32 v146, v116, v117
    v_cvt_pk_bf16_f32 v147, v118, v119
    v_mfma_f32_32x32x16_bf16 v[192:207], v[84:87], v[156:159], v[192:207]
    ds_read_b128 v[96:99], v35 offset:2560
    ds_read_b128 v[100:103], v35 offset:4096
    v_exp_f32 v124, v124
    v_exp_f32 v125, v125
    v_exp_f32 v126, v126
    v_exp_f32 v127, v127
    v_cvt_pk_bf16_f32 v148, v120, v121
    v_cvt_pk_bf16_f32 v149, v122, v123
    v_cvt_pk_bf16_f32 v150, v124, v125
    v_cvt_pk_bf16_f32 v151, v126, v127
    v_exp_f32 v128, v128
    v_exp_f32 v129, v129
    v_exp_f32 v130, v130
    v_exp_f32 v131, v131
    s_waitcnt lgkmcnt(3)
    v_mfma_f32_32x32x16_bf16 v[176:191], v[88:91], v[144:147], v[176:191]
    v_exp_f32 v132, v132
    v_exp_f32 v133, v133
    v_exp_f32 v134, v134
    v_exp_f32 v135, v135
    v_cvt_pk_bf16_f32 v152, v128, v129
    v_cvt_pk_bf16_f32 v153, v130, v131
    v_exp_f32 v136, v136
    v_exp_f32 v137, v137
    v_exp_f32 v138, v138
    v_exp_f32 v139, v139
    v_cvt_pk_bf16_f32 v154, v132, v133
    v_cvt_pk_bf16_f32 v155, v134, v135
    s_waitcnt lgkmcnt(2)
    v_mfma_f32_32x32x16_bf16 v[176:191], v[92:95], v[148:151], v[176:191]
    v_exp_f32 v140, v140
    v_exp_f32 v141, v141
    v_exp_f32 v142, v142
    v_exp_f32 v143, v143
    v_cvt_pk_bf16_f32 v156, v136, v137
    v_cvt_pk_bf16_f32 v157, v138, v139
    v_cvt_pk_bf16_f32 v158, v140, v141
    v_cvt_pk_bf16_f32 v159, v142, v143
    s_waitcnt lgkmcnt(1)
    v_mfma_f32_32x32x16_bf16 v[192:207], v[96:99], v[152:155], v[192:207]
    s_waitcnt lgkmcnt(0)
    v_mfma_f32_32x32x16_bf16 v[192:207], v[100:103], v[156:159], v[192:207]
    s_mul_i32 s50, s96, 40960
    s_add_u32 s50, s50, 23031808
    s_lshl_b32 s82, s41, 11
    s_add_u32 s82, s82, s50
    s_lshr_b32 s83, s41, 1
    s_lshl_b32 s83, s83, 10
    s_add_u32 s83, s83, s50
    s_and_b32 s53, s41, 1
    s_lshl_b32 s53, s53, 9
    s_add_u32 s83, s83, s53
    s_add_u32 s83, s83, 32768
    s_nop 0
    v_min_f32 v44, v188, v204
    v_max_f32 v45, v188, v204
    v_cmp_nle_f32 vcc, 8.673617379884035e-19, v44
    s_nop 1
    s_mov_b64 s[48:49], vcc
    v_cmp_nge_f32 vcc, 1.152921504606847e+18, v45
    s_nop 1
    s_or_b64 s[48:49], s[48:49], vcc
    v_cmp_u_f32 vcc, v188, v204
    s_nop 1
    s_or_b64 s[48:49], s[48:49], vcc
    s_cmp_eq_u64 s[48:49], 0
    s_nop 0
    s_cbranch_scc1 L_lok_74
    s_sub_u32 s50, 8, s96
    s_cmp_lt_u32 s96, 8
    s_cselect_b32 s50, s50, 0
    s_add_u32 s51, s50, s42
    s_mul_i32 s51, s51, 5632
    v_and_b32 v44, 31, v1
    v_lshrrev_b32 v45, 5, v1
    v_lshlrev_b32 v46, 2, v45
    v_sub_u32 v46, v44, v46
    v_mov_b32 v47, 0xf149f2ca
    v_mov_b32 v160, 0
    v_mov_b32 v161, 1
    v_mov_b32 v162, 2
    v_mov_b32 v163, 3
    v_mov_b32 v164, 8
    v_mov_b32 v165, 9
    v_mov_b32 v166, 10
    v_mov_b32 v167, 11
    v_mov_b32 v168, 16
    v_mov_b32 v169, 17
    v_mov_b32 v170, 18
    v_mov_b32 v171, 19
    v_mov_b32 v172, 24
    v_mov_b32 v173, 25
    v_mov_b32 v174, 26
    v_mov_b32 v175, 27
    v_add_u32 v48, s51, v2
    v_lshl_add_u32 v49, v44, 4, s51
    s_mov_b32 s52, s50
    v_mov_b32 v50, v47
    s_nop 1
L_mx_75:
    ds_read_b128 v[128:131], v48 offset:0
    ds_read_b64 v[132:133], v49 offset:2048
    s_waitcnt lgkmcnt(1)
    v_mfma_f32_32x32x16_bf16 v[112:127], v[128:131], v[240:243], 0
    s_waitcnt lgkmcnt(0)
    s_nop 8
    v_mfma_f32_32x32x8bf16_1k v[112:127], v[132:133], v[248:249], v[112:127]
    s_cmp_lg_u32 s52, 0
    s_nop 10
    s_cbranch_scc1 L_nomask_76
    v_cmp_lt_i32 vcc, v46, v160
    s_nop 1
    v_cndmask_b32 v112, v47, v112, vcc
    v_cmp_lt_i32 vcc, v46, v161
    s_nop 1
    v_cndmask_b32 v113, v47, v113, vcc
    v_cmp_lt_i32 vcc, v46, v162
    s_nop 1
    v_cndmask_b32 v114, v47, v114, vcc
    v_cmp_lt_i32 vcc, v46, v163
    s_nop 1
    v_cndmask_b32 v115, v47, v115, vcc
    v_cmp_lt_i32 vcc, v46, v164
    s_nop 1
    v_cndmask_b32 v116, v47, v116, vcc
    v_cmp_lt_i32 vcc, v46, v165
    s_nop 1
    v_cndmask_b32 v117, v47, v117, vcc
    v_cmp_lt_i32 vcc, v46, v166
    s_nop 1
    v_cndmask_b32 v118, v47, v118, vcc
    v_cmp_lt_i32 vcc, v46, v167
    s_nop 1
    v_cndmask_b32 v119, v47, v119, vcc
    v_cmp_lt_i32 vcc, v46, v168
    s_nop 1
    v_cndmask_b32 v120, v47, v120, vcc
    v_cmp_lt_i32 vcc, v46, v169
    s_nop 1
    v_cndmask_b32 v121, v47, v121, vcc
    v_cmp_lt_i32 vcc, v46, v170
    s_nop 1
    v_cndmask_b32 v122, v47, v122, vcc
    v_cmp_lt_i32 vcc, v46, v171
    s_nop 1
    v_cndmask_b32 v123, v47, v123, vcc
    v_cmp_lt_i32 vcc, v46, v172
    s_nop 1
    v_cndmask_b32 v124, v47, v124, vcc
    v_cmp_lt_i32 vcc, v46, v173
    s_nop 1
    v_cndmask_b32 v125, v47, v125, vcc
    v_cmp_lt_i32 vcc, v46, v174
    s_nop 1
    v_cndmask_b32 v126, v47, v126, vcc
    v_cmp_lt_i32 vcc, v46, v175
    s_nop 1
    v_cndmask_b32 v127, v47, v127, vcc
    s_nop 1
L_nomask_76:
    s_cmp_lg_u32 s52, 8
    s_nop 0
    s_cbranch_scc1 L_nomask_77
    v_cmp_ge_i32 vcc, v46, v160
    s_nop 1
    v_cndmask_b32 v112, v47, v112, vcc
    v_cmp_ge_i32 vcc, v46, v161
    s_nop 1
    v_cndmask_b32 v113, v47, v113, vcc
    v_cmp_ge_i32 vcc, v46, v162
    s_nop 1
    v_cndmask_b32 v114, v47, v114, vcc
    v_cmp_ge_i32 vcc, v46, v163
    s_nop 1
    v_cndmask_b32 v115, v47, v115, vcc
    v_cmp_ge_i32 vcc, v46, v164
    s_nop 1
    v_cndmask_b32 v116, v47, v116, vcc
    v_cmp_ge_i32 vcc, v46, v165
    s_nop 1
    v_cndmask_b32 v117, v47, v117, vcc
    v_cmp_ge_i32 vcc, v46, v166
    s_nop 1
    v_cndmask_b32 v118, v47, v118, vcc
    v_cmp_ge_i32 vcc, v46, v167
    s_nop 1
    v_cndmask_b32 v119, v47, v119, vcc
    v_cmp_ge_i32 vcc, v46, v168
    s_nop 1
    v_cndmask_b32 v120, v47, v120, vcc
    v_cmp_ge_i32 vcc, v46, v169
    s_nop 1
    v_cndmask_b32 v121, v47, v121, vcc
    v_cmp_ge_i32 vcc, v46, v170
    s_nop 1
    v_cndmask_b32 v122, v47, v122, vcc
    v_cmp_ge_i32 vcc, v46, v171
    s_nop 1
    v_cndmask_b32 v123, v47, v123, vcc
    v_cmp_ge_i32 vcc, v46, v172
    s_nop 1
    v_cndmask_b32 v124, v47, v124, vcc
    v_cmp_ge_i32 vcc, v46, v173
    s_nop 1
    v_cndmask_b32 v125, v47, v125, vcc
    v_cmp_ge_i32 vcc, v46, v174
    s_nop 1
    v_cndmask_b32 v126, v47, v126, vcc
    v_cmp_ge_i32 vcc, v46, v175
    s_nop 1
    v_cndmask_b32 v127, v47, v127, vcc
    s_nop 1
L_nomask_77:
    v_max3_f32 v50, v50, v112, v113
    v_max3_f32 v50, v50, v114, v115
    v_max3_f32 v50, v50, v116, v117
    v_max3_f32 v50, v50, v118, v119
    v_max3_f32 v50, v50, v120, v121
    v_max3_f32 v50, v50, v122, v123
    v_max3_f32 v50, v50, v124, v125
    v_max3_f32 v50, v50, v126, v127
    v_add_u32 v48, 5632, v48
    v_add_u32 v49, 5632, v49
    s_add_u32 s52, s52, 1
    s_cmp_le_u32 s52, 8
    s_nop 0
    s_cbranch_scc1 L_mx_75
    v_mov_b32 v51, v50
    s_nop 1
    v_permlane32_swap_b32 v50, v51
    v_max_f32 v50, v50, v51
    v_add_u32 v48, s51, v2
    v_lshl_add_u32 v49, v44, 4, s51
    s_mov_b32 s52, s50
    v_add_u32 v51, 0, v44
    v_cmp_gt_u32 vcc, 20, v44
    s_nop 1
    v_cndmask_b32 v51, 40, v51, vcc
    v_mul_u32_u24 v52, 48, v45
    v_add_u32 v51, v51, v52
    v_lshl_add_u32 v51, v51, 4, s51
    v_mov_b32 v176, 0
    v_mov_b32 v177, 0
    v_mov_b32 v178, 0
    v_mov_b32 v179, 0
    v_mov_b32 v180, 0
    v_mov_b32 v181, 0
    v_mov_b32 v182, 0
    v_mov_b32 v183, 0
    v_mov_b32 v184, 0
    v_mov_b32 v185, 0
    v_mov_b32 v186, 0
    v_mov_b32 v187, 0
    v_mov_b32 v188, 0
    v_mov_b32 v189, 0
    v_mov_b32 v190, 0
    v_mov_b32 v191, 0
    s_nop 1
L_pv_78:
    ds_read_b128 v[128:131], v48 offset:0
    ds_read_b64 v[132:133], v49 offset:2048
    s_waitcnt lgkmcnt(1)
    v_mfma_f32_32x32x16_bf16 v[112:127], v[128:131], v[240:243], 0
    s_waitcnt lgkmcnt(0)
    s_nop 8
    v_mfma_f32_32x32x8bf16_1k v[112:127], v[132:133], v[248:249], v[112:127]
    s_cmp_lg_u32 s52, 0
    s_nop 10
    s_cbranch_scc1 L_nomask_79
    v_cmp_lt_i32 vcc, v46, v160
    s_nop 1
    v_cndmask_b32 v112, v47, v112, vcc
    v_cmp_lt_i32 vcc, v46, v161
    s_nop 1
    v_cndmask_b32 v113, v47, v113, vcc
    v_cmp_lt_i32 vcc, v46, v162
    s_nop 1
    v_cndmask_b32 v114, v47, v114, vcc
    v_cmp_lt_i32 vcc, v46, v163
    s_nop 1
    v_cndmask_b32 v115, v47, v115, vcc
    v_cmp_lt_i32 vcc, v46, v164
    s_nop 1
    v_cndmask_b32 v116, v47, v116, vcc
    v_cmp_lt_i32 vcc, v46, v165
    s_nop 1
    v_cndmask_b32 v117, v47, v117, vcc
    v_cmp_lt_i32 vcc, v46, v166
    s_nop 1
    v_cndmask_b32 v118, v47, v118, vcc
    v_cmp_lt_i32 vcc, v46, v167
    s_nop 1
    v_cndmask_b32 v119, v47, v119, vcc
    v_cmp_lt_i32 vcc, v46, v168
    s_nop 1
    v_cndmask_b32 v120, v47, v120, vcc
    v_cmp_lt_i32 vcc, v46, v169
    s_nop 1
    v_cndmask_b32 v121, v47, v121, vcc
    v_cmp_lt_i32 vcc, v46, v170
    s_nop 1
    v_cndmask_b32 v122, v47, v122, vcc
    v_cmp_lt_i32 vcc, v46, v171
    s_nop 1
    v_cndmask_b32 v123, v47, v123, vcc
    v_cmp_lt_i32 vcc, v46, v172
    s_nop 1
    v_cndmask_b32 v124, v47, v124, vcc
    v_cmp_lt_i32 vcc, v46, v173
    s_nop 1
    v_cndmask_b32 v125, v47, v125, vcc
    v_cmp_lt_i32 vcc, v46, v174
    s_nop 1
    v_cndmask_b32 v126, v47, v126, vcc
    v_cmp_lt_i32 vcc, v46, v175
    s_nop 1
    v_cndmask_b32 v127, v47, v127, vcc
    s_nop 1
L_nomask_79:
    s_cmp_lg_u32 s52, 8
    s_nop 0
    s_cbranch_scc1 L_nomask_80
    v_cmp_ge_i32 vcc, v46, v160
    s_nop 1
    v_cndmask_b32 v112, v47, v112, vcc
    v_cmp_ge_i32 vcc, v46, v161
    s_nop 1
    v_cndmask_b32 v113, v47, v113, vcc
    v_cmp_ge_i32 vcc, v46, v162
    s_nop 1
    v_cndmask_b32 v114, v47, v114, vcc
    v_cmp_ge_i32 vcc, v46, v163
    s_nop 1
    v_cndmask_b32 v115, v47, v115, vcc
    v_cmp_ge_i32 vcc, v46, v164
    s_nop 1
    v_cndmask_b32 v116, v47, v116, vcc
    v_cmp_ge_i32 vcc, v46, v165
    s_nop 1
    v_cndmask_b32 v117, v47, v117, vcc
    v_cmp_ge_i32 vcc, v46, v166
    s_nop 1
    v_cndmask_b32 v118, v47, v118, vcc
    v_cmp_ge_i32 vcc, v46, v167
    s_nop 1
    v_cndmask_b32 v119, v47, v119, vcc
    v_cmp_ge_i32 vcc, v46, v168
    s_nop 1
    v_cndmask_b32 v120, v47, v120, vcc
    v_cmp_ge_i32 vcc, v46, v169
    s_nop 1
    v_cndmask_b32 v121, v47, v121, vcc
    v_cmp_ge_i32 vcc, v46, v170
    s_nop 1
    v_cndmask_b32 v122, v47, v122, vcc
    v_cmp_ge_i32 vcc, v46, v171
    s_nop 1
    v_cndmask_b32 v123, v47, v123, vcc
    v_cmp_ge_i32 vcc, v46, v172
    s_nop 1
    v_cndmask_b32 v124, v47, v124, vcc
    v_cmp_ge_i32 vcc, v46, v173
    s_nop 1
    v_cndmask_b32 v125, v47, v125, vcc
    v_cmp_ge_i32 vcc, v46, v174
    s_nop 1
    v_cndmask_b32 v126, v47, v126, vcc
    v_cmp_ge_i32 vcc, v46, v175
    s_nop 1
    v_cndmask_b32 v127, v47, v127, vcc
    s_nop 1
L_nomask_80:
    ds_read_b128 v[136:139], v51 offset:2560
    ds_read_b128 v[140:143], v51 offset:4096
    v_sub_f32 v112, v112, v50
    v_sub_f32 v113, v113, v50
    v_sub_f32 v114, v114, v50
    v_sub_f32 v115, v115, v50
    v_sub_f32 v116, v116, v50
    v_sub_f32 v117, v117, v50
    v_sub_f32 v118, v118, v50
    v_sub_f32 v119, v119, v50
    v_sub_f32 v120, v120, v50
    v_sub_f32 v121, v121, v50
    v_sub_f32 v122, v122, v50
    v_sub_f32 v123, v123, v50
    v_sub_f32 v124, v124, v50
    v_sub_f32 v125, v125, v50
    v_sub_f32 v126, v126, v50
    v_sub_f32 v127, v127, v50
    v_exp_f32 v112, v112
    v_exp_f32 v113, v113
    v_exp_f32 v114, v114
    v_exp_f32 v115, v115
    v_exp_f32 v116, v116
    v_exp_f32 v117, v117
    v_exp_f32 v118, v118
    v_exp_f32 v119, v119
    v_exp_f32 v120, v120
    v_exp_f32 v121, v121
    v_exp_f32 v122, v122
    v_exp_f32 v123, v123
    v_exp_f32 v124, v124
    v_exp_f32 v125, v125
    v_exp_f32 v126, v126
    v_exp_f32 v127, v127
    v_cvt_pk_bf16_f32 v144, v112, v113
    v_cvt_pk_bf16_f32 v145, v114, v115
    v_cvt_pk_bf16_f32 v146, v116, v117
    v_cvt_pk_bf16_f32 v147, v118, v119
    v_cvt_pk_bf16_f32 v148, v120, v121
    v_cvt_pk_bf16_f32 v149, v122, v123
    v_cvt_pk_bf16_f32 v150, v124, v125
    v_cvt_pk_bf16_f32 v151, v126, v127
    s_waitcnt lgkmcnt(1)
    v_mfma_f32_32x32x16_bf16 v[176:191], v[136:139], v[144:147], v[176:191]
    s_waitcnt lgkmcnt(0)
    v_mfma_f32_32x32x16_bf16 v[176:191], v[140:143], v[148:151], v[176:191]
    v_add_u32 v48, 5632, v48
    v_add_u32 v49, 5632, v49
    v_add_u32 v51, 5632, v51
    s_add_u32 s52, s52, 1
    s_cmp_le_u32 s52, 8
    s_nop 6
    s_cbranch_scc1 L_pv_78
    v_mov_b32 v160, 0
    v_mov_b32 v161, 1
    v_mov_b32 v162, 2
    v_mov_b32 v163, 3
    v_mov_b32 v164, 8
    v_mov_b32 v165, 9
    v_mov_b32 v166, 10
    v_mov_b32 v167, 11
    v_mov_b32 v168, 16
    v_mov_b32 v169, 17
    v_mov_b32 v170, 18
    v_mov_b32 v171, 19
    v_mov_b32 v172, 24
    v_mov_b32 v173, 25
    v_mov_b32 v174, 26
    v_mov_b32 v175, 27
    v_add_u32 v48, s51, v2
    v_lshl_add_u32 v49, v44, 4, s51
    s_mov_b32 s52, s50
    v_mov_b32 v50, v47
    s_nop 1
L_mx_81:
    ds_read_b128 v[128:131], v48 offset:1024
    ds_read_b64 v[132:133], v49 offset:2056
    s_waitcnt lgkmcnt(1)
    v_mfma_f32_32x32x16_bf16 v[112:127], v[128:131], v[244:247], 0
    s_waitcnt lgkmcnt(0)
    s_nop 8
    v_mfma_f32_32x32x8bf16_1k v[112:127], v[132:133], v[250:251], v[112:127]
    s_cmp_lg_u32 s52, 0
    s_nop 10
    s_cbranch_scc1 L_nomask_82
    v_cmp_lt_i32 vcc, v46, v160
    s_nop 1
    v_cndmask_b32 v112, v47, v112, vcc
    v_cmp_lt_i32 vcc, v46, v161
    s_nop 1
    v_cndmask_b32 v113, v47, v113, vcc
    v_cmp_lt_i32 vcc, v46, v162
    s_nop 1
    v_cndmask_b32 v114, v47, v114, vcc
    v_cmp_lt_i32 vcc, v46, v163
    s_nop 1
    v_cndmask_b32 v115, v47, v115, vcc
    v_cmp_lt_i32 vcc, v46, v164
    s_nop 1
    v_cndmask_b32 v116, v47, v116, vcc
    v_cmp_lt_i32 vcc, v46, v165
    s_nop 1
    v_cndmask_b32 v117, v47, v117, vcc
    v_cmp_lt_i32 vcc, v46, v166
    s_nop 1
    v_cndmask_b32 v118, v47, v118, vcc
    v_cmp_lt_i32 vcc, v46, v167
    s_nop 1
    v_cndmask_b32 v119, v47, v119, vcc
    v_cmp_lt_i32 vcc, v46, v168
    s_nop 1
    v_cndmask_b32 v120, v47, v120, vcc
    v_cmp_lt_i32 vcc, v46, v169
    s_nop 1
    v_cndmask_b32 v121, v47, v121, vcc
    v_cmp_lt_i32 vcc, v46, v170
    s_nop 1
    v_cndmask_b32 v122, v47, v122, vcc
    v_cmp_lt_i32 vcc, v46, v171
    s_nop 1
    v_cndmask_b32 v123, v47, v123, vcc
    v_cmp_lt_i32 vcc, v46, v172
    s_nop 1
    v_cndmask_b32 v124, v47, v124, vcc
    v_cmp_lt_i32 vcc, v46, v173
    s_nop 1
    v_cndmask_b32 v125, v47, v125, vcc
    v_cmp_lt_i32 vcc, v46, v174
    s_nop 1
    v_cndmask_b32 v126, v47, v126, vcc
    v_cmp_lt_i32 vcc, v46, v175
    s_nop 1
    v_cndmask_b32 v127, v47, v127, vcc
    s_nop 1
L_nomask_82:
    s_cmp_lg_u32 s52, 8
    s_nop 0
    s_cbranch_scc1 L_nomask_83
    v_cmp_ge_i32 vcc, v46, v160
    s_nop 1
    v_cndmask_b32 v112, v47, v112, vcc
    v_cmp_ge_i32 vcc, v46, v161
    s_nop 1
    v_cndmask_b32 v113, v47, v113, vcc
    v_cmp_ge_i32 vcc, v46, v162
    s_nop 1
    v_cndmask_b32 v114, v47, v114, vcc
    v_cmp_ge_i32 vcc, v46, v163
    s_nop 1
    v_cndmask_b32 v115, v47, v115, vcc
    v_cmp_ge_i32 vcc, v46, v164
    s_nop 1
    v_cndmask_b32 v116, v47, v116, vcc
    v_cmp_ge_i32 vcc, v46, v165
    s_nop 1
    v_cndmask_b32 v117, v47, v117, vcc
    v_cmp_ge_i32 vcc, v46, v166
    s_nop 1
    v_cndmask_b32 v118, v47, v118, vcc
    v_cmp_ge_i32 vcc, v46, v167
    s_nop 1
    v_cndmask_b32 v119, v47, v119, vcc
    v_cmp_ge_i32 vcc, v46, v168
    s_nop 1
    v_cndmask_b32 v120, v47, v120, vcc
    v_cmp_ge_i32 vcc, v46, v169
    s_nop 1
    v_cndmask_b32 v121, v47, v121, vcc
    v_cmp_ge_i32 vcc, v46, v170
    s_nop 1
    v_cndmask_b32 v122, v47, v122, vcc
    v_cmp_ge_i32 vcc, v46, v171
    s_nop 1
    v_cndmask_b32 v123, v47, v123, vcc
    v_cmp_ge_i32 vcc, v46, v172
    s_nop 1
    v_cndmask_b32 v124, v47, v124, vcc
    v_cmp_ge_i32 vcc, v46, v173
    s_nop 1
    v_cndmask_b32 v125, v47, v125, vcc
    v_cmp_ge_i32 vcc, v46, v174
    s_nop 1
    v_cndmask_b32 v126, v47, v126, vcc
    v_cmp_ge_i32 vcc, v46, v175
    s_nop 1
    v_cndmask_b32 v127, v47, v127, vcc
    s_nop 1
L_nomask_83:
    v_max3_f32 v50, v50, v112, v113
    v_max3_f32 v50, v50, v114, v115
    v_max3_f32 v50, v50, v116, v117
    v_max3_f32 v50, v50, v118, v119
    v_max3_f32 v50, v50, v120, v121
    v_max3_f32 v50, v50, v122, v123
    v_max3_f32 v50, v50, v124, v125
    v_max3_f32 v50, v50, v126, v127
    v_add_u32 v48, 5632, v48
    v_add_u32 v49, 5632, v49
    s_add_u32 s52, s52, 1
    s_cmp_le_u32 s52, 8
    s_nop 0
    s_cbranch_scc1 L_mx_81
    v_mov_b32 v51, v50
    s_nop 1
    v_permlane32_swap_b32 v50, v51
    v_max_f32 v50, v50, v51
    v_add_u32 v48, s51, v2
    v_lshl_add_u32 v49, v44, 4, s51
    s_mov_b32 s52, s50
    v_add_u32 v51, 20, v44
    v_cmp_gt_u32 vcc, 20, v44
    s_nop 1
    v_cndmask_b32 v51, 40, v51, vcc
    v_mul_u32_u24 v52, 48, v45
    v_add_u32 v51, v51, v52
    v_lshl_add_u32 v51, v51, 4, s51
    v_mov_b32 v192, 0
    v_mov_b32 v193, 0
    v_mov_b32 v194, 0
    v_mov_b32 v195, 0
    v_mov_b32 v196, 0
    v_mov_b32 v197, 0
    v_mov_b32 v198, 0
    v_mov_b32 v199, 0
    v_mov_b32 v200, 0
    v_mov_b32 v201, 0
    v_mov_b32 v202, 0
    v_mov_b32 v203, 0
    v_mov_b32 v204, 0
    v_mov_b32 v205, 0
    v_mov_b32 v206, 0
    v_mov_b32 v207, 0
    s_nop 1
L_pv_84:
    ds_read_b128 v[128:131], v48 offset:1024
    ds_read_b64 v[132:133], v49 offset:2056
    s_waitcnt lgkmcnt(1)
    v_mfma_f32_32x32x16_bf16 v[112:127], v[128:131], v[244:247], 0
    s_waitcnt lgkmcnt(0)
    s_nop 8
    v_mfma_f32_32x32x8bf16_1k v[112:127], v[132:133], v[250:251], v[112:127]
    s_cmp_lg_u32 s52, 0
    s_nop 10
    s_cbranch_scc1 L_nomask_85
    v_cmp_lt_i32 vcc, v46, v160
    s_nop 1
    v_cndmask_b32 v112, v47, v112, vcc
    v_cmp_lt_i32 vcc, v46, v161
    s_nop 1
    v_cndmask_b32 v113, v47, v113, vcc
    v_cmp_lt_i32 vcc, v46, v162
    s_nop 1
    v_cndmask_b32 v114, v47, v114, vcc
    v_cmp_lt_i32 vcc, v46, v163
    s_nop 1
    v_cndmask_b32 v115, v47, v115, vcc
    v_cmp_lt_i32 vcc, v46, v164
    s_nop 1
    v_cndmask_b32 v116, v47, v116, vcc
    v_cmp_lt_i32 vcc, v46, v165
    s_nop 1
    v_cndmask_b32 v117, v47, v117, vcc
    v_cmp_lt_i32 vcc, v46, v166
    s_nop 1
    v_cndmask_b32 v118, v47, v118, vcc
    v_cmp_lt_i32 vcc, v46, v167
    s_nop 1
    v_cndmask_b32 v119, v47, v119, vcc
    v_cmp_lt_i32 vcc, v46, v168
    s_nop 1
    v_cndmask_b32 v120, v47, v120, vcc
    v_cmp_lt_i32 vcc, v46, v169
    s_nop 1
    v_cndmask_b32 v121, v47, v121, vcc
    v_cmp_lt_i32 vcc, v46, v170
    s_nop 1
    v_cndmask_b32 v122, v47, v122, vcc
    v_cmp_lt_i32 vcc, v46, v171
    s_nop 1
    v_cndmask_b32 v123, v47, v123, vcc
    v_cmp_lt_i32 vcc, v46, v172
    s_nop 1
    v_cndmask_b32 v124, v47, v124, vcc
    v_cmp_lt_i32 vcc, v46, v173
    s_nop 1
    v_cndmask_b32 v125, v47, v125, vcc
    v_cmp_lt_i32 vcc, v46, v174
    s_nop 1
    v_cndmask_b32 v126, v47, v126, vcc
    v_cmp_lt_i32 vcc, v46, v175
    s_nop 1
    v_cndmask_b32 v127, v47, v127, vcc
    s_nop 1
L_nomask_85:
    s_cmp_lg_u32 s52, 8
    s_nop 0
    s_cbranch_scc1 L_nomask_86
    v_cmp_ge_i32 vcc, v46, v160
    s_nop 1
    v_cndmask_b32 v112, v47, v112, vcc
    v_cmp_ge_i32 vcc, v46, v161
    s_nop 1
    v_cndmask_b32 v113, v47, v113, vcc
    v_cmp_ge_i32 vcc, v46, v162
    s_nop 1
    v_cndmask_b32 v114, v47, v114, vcc
    v_cmp_ge_i32 vcc, v46, v163
    s_nop 1
    v_cndmask_b32 v115, v47, v115, vcc
    v_cmp_ge_i32 vcc, v46, v164
    s_nop 1
    v_cndmask_b32 v116, v47, v116, vcc
    v_cmp_ge_i32 vcc, v46, v165
    s_nop 1
    v_cndmask_b32 v117, v47, v117, vcc
    v_cmp_ge_i32 vcc, v46, v166
    s_nop 1
    v_cndmask_b32 v118, v47, v118, vcc
    v_cmp_ge_i32 vcc, v46, v167
    s_nop 1
    v_cndmask_b32 v119, v47, v119, vcc
    v_cmp_ge_i32 vcc, v46, v168
    s_nop 1
    v_cndmask_b32 v120, v47, v120, vcc
    v_cmp_ge_i32 vcc, v46, v169
    s_nop 1
    v_cndmask_b32 v121, v47, v121, vcc
    v_cmp_ge_i32 vcc, v46, v170
    s_nop 1
    v_cndmask_b32 v122, v47, v122, vcc
    v_cmp_ge_i32 vcc, v46, v171
    s_nop 1
    v_cndmask_b32 v123, v47, v123, vcc
    v_cmp_ge_i32 vcc, v46, v172
    s_nop 1
    v_cndmask_b32 v124, v47, v124, vcc
    v_cmp_ge_i32 vcc, v46, v173
    s_nop 1
    v_cndmask_b32 v125, v47, v125, vcc
    v_cmp_ge_i32 vcc, v46, v174
    s_nop 1
    v_cndmask_b32 v126, v47, v126, vcc
    v_cmp_ge_i32 vcc, v46, v175
    s_nop 1
    v_cndmask_b32 v127, v47, v127, vcc
    s_nop 1
L_nomask_86:
    ds_read_b128 v[136:139], v51 offset:2560
    ds_read_b128 v[140:143], v51 offset:4096
    v_sub_f32 v112, v112, v50
    v_sub_f32 v113, v113, v50
    v_sub_f32 v114, v114, v50
    v_sub_f32 v115, v115, v50
    v_sub_f32 v116, v116, v50
    v_sub_f32 v117, v117, v50
    v_sub_f32 v118, v118, v50
    v_sub_f32 v119, v119, v50
    v_sub_f32 v120, v120, v50
    v_sub_f32 v121, v121, v50
    v_sub_f32 v122, v122, v50
    v_sub_f32 v123, v123, v50
    v_sub_f32 v124, v124, v50
    v_sub_f32 v125, v125, v50
    v_sub_f32 v126, v126, v50
    v_sub_f32 v127, v127, v50
    v_exp_f32 v112, v112
    v_exp_f32 v113, v113
    v_exp_f32 v114, v114
    v_exp_f32 v115, v115
    v_exp_f32 v116, v116
    v_exp_f32 v117, v117
    v_exp_f32 v118, v118
    v_exp_f32 v119, v119
    v_exp_f32 v120, v120
    v_exp_f32 v121, v121
    v_exp_f32 v122, v122
    v_exp_f32 v123, v123
    v_exp_f32 v124, v124
    v_exp_f32 v125, v125
    v_exp_f32 v126, v126
    v_exp_f32 v127, v127
    v_cvt_pk_bf16_f32 v144, v112, v113
    v_cvt_pk_bf16_f32 v145, v114, v115
    v_cvt_pk_bf16_f32 v146, v116, v117
    v_cvt_pk_bf16_f32 v147, v118, v119
    v_cvt_pk_bf16_f32 v148, v120, v121
    v_cvt_pk_bf16_f32 v149, v122, v123
    v_cvt_pk_bf16_f32 v150, v124, v125
    v_cvt_pk_bf16_f32 v151, v126, v127
    s_waitcnt lgkmcnt(1)
    v_mfma_f32_32x32x16_bf16 v[192:207], v[136:139], v[144:147], v[192:207]
    s_waitcnt lgkmcnt(0)
    v_mfma_f32_32x32x16_bf16 v[192:207], v[140:143], v[148:151], v[192:207]
    v_add_u32 v48, 5632, v48
    v_add_u32 v49, 5632, v49
    v_add_u32 v51, 5632, v51
    s_add_u32 s52, s52, 1
    s_cmp_le_u32 s52, 8
    s_nop 6
    s_cbranch_scc1 L_pv_84
    s_nop 0
L_lok_74:
    v_rcp_f32 v44, v188
    s_nop 0
    v_pk_mul_f32 v[176:177], v[176:177], v[44:45] op_sel:[0,0] op_sel_hi:[1,0]
    v_pk_mul_f32 v[178:179], v[178:179], v[44:45] op_sel:[0,0] op_sel_hi:[1,0]
    v_pk_mul_f32 v[180:181], v[180:181], v[44:45] op_sel:[0,0] op_sel_hi:[1,0]
    v_pk_mul_f32 v[182:183], v[182:183], v[44:45] op_sel:[0,0] op_sel_hi:[1,0]
    v_pk_mul_f32 v[184:185], v[184:185], v[44:45] op_sel:[0,0] op_sel_hi:[1,0]
    v_pk_mul_f32 v[186:187], v[186:187], v[44:45] op_sel:[0,0] op_sel_hi:[1,0]
    v_cvt_pk_bf16_f32 v144, v176, v177
    v_cvt_pk_bf16_f32 v145, v178, v179
    v_cvt_pk_bf16_f32 v146, v180, v181
    v_cvt_pk_bf16_f32 v147, v182, v183
    v_cvt_pk_bf16_f32 v152, v184, v185
    v_cvt_pk_bf16_f32 v153, v186, v187
    buffer_store_dwordx4 v[144:147], v2, s[24:27], s82 offen offset:0 sc1
    v_rcp_f32 v44, v204
    s_nop 0
    v_pk_mul_f32 v[192:193], v[192:193], v[44:45] op_sel:[0,0] op_sel_hi:[1,0]
    v_pk_mul_f32 v[194:195], v[194:195], v[44:45] op_sel:[0,0] op_sel_hi:[1,0]
    v_pk_mul_f32 v[196:197], v[196:197], v[44:45] op_sel:[0,0] op_sel_hi:[1,0]
    v_pk_mul_f32 v[198:199], v[198:199], v[44:45] op_sel:[0,0] op_sel_hi:[1,0]
    v_pk_mul_f32 v[200:201], v[200:201], v[44:45] op_sel:[0,0] op_sel_hi:[1,0]
    v_pk_mul_f32 v[202:203], v[202:203], v[44:45] op_sel:[0,0] op_sel_hi:[1,0]
    v_cvt_pk_bf16_f32 v148, v192, v193
    v_cvt_pk_bf16_f32 v149, v194, v195
    v_cvt_pk_bf16_f32 v150, v196, v197
    v_cvt_pk_bf16_f32 v151, v198, v199
    v_cvt_pk_bf16_f32 v154, v200, v201
    v_cvt_pk_bf16_f32 v155, v202, v203
    buffer_store_dwordx4 v[148:151], v2, s[24:27], s82 offen offset:1024 sc1
    s_mov_b32 exec_hi, 0
    buffer_store_dwordx4 v[152:155], v2, s[24:27], s83 offen offset:0 sc1
    s_mov_b32 exec_hi, -1
    s_waitcnt vmcnt(15)
    s_barrier
    ds_read_b128 v[64:67], v7 offset:8192
    ds_read_b128 v[68:71], v7 offset:10240
    ds_read_b128 v[72:75], v7 offset:12288
    ds_read_b128 v[76:79], v7 offset:14336
    ds_read_b128 v[80:83], v7 offset:16384
    ds_read_b128 v[84:87], v7 offset:18432
    ds_read_b128 v[88:91], v7 offset:20480
    ds_read_b128 v[92:95], v7 offset:22528
    ds_read_b128 v[96:99], v7 offset:24576
    ds_read_b128 v[100:103], v7 offset:26624
    ds_read_b128 v[104:107], v7 offset:28672
    ds_read_b128 v[108:111], v7 offset:30720
    v_lshlrev_b32 v112, 16, v16
    v_and_b32 v113, 0xffff0000, v16
    v_lshlrev_b32 v114, 16, v17
    v_and_b32 v115, 0xffff0000, v17
    v_lshlrev_b32 v116, 16, v18
    v_and_b32 v117, 0xffff0000, v18
    v_lshlrev_b32 v118, 16, v19
    v_and_b32 v119, 0xffff0000, v19
    v_lshlrev_b32 v120, 16, v20
    v_and_b32 v121, 0xffff0000, v20
    v_lshlrev_b32 v122, 16, v21
    v_and_b32 v123, 0xffff0000, v21
    v_lshlrev_b32 v124, 16, v22
    v_and_b32 v125, 0xffff0000, v22
    v_lshlrev_b32 v126, 16, v23
    v_and_b32 v127, 0xffff0000, v23
    v_lshlrev_b32 v128, 16, v24
    v_and_b32 v129, 0xffff0000, v24
    v_lshlrev_b32 v130, 16, v25
    v_and_b32 v131, 0xffff0000, v25
    v_lshrrev_b32 v44, 5, v1
    v_lshlrev_b32 v44, 10, v44
    v_bfe_u32 v45, v1, 4, 1
    v_lshl_add_u32 v44, v45, 9, v44
    v_and_b32 v45, 15, v1
    v_lshl_add_u32 v44, v45, 4, v44
    s_mul_i32 s48, s64, 2304
    v_add_u32 v59, s48, v44
    s_mul_i32 s48, s64, 1792
    s_add_u32 s48, s48, 256
    v_add_u32 v60, s48, v44
    s_mul_i32 s80, s97, 40960
    s_add_u32 s80, s80, 23031808
    s_add_u32 m0, s68, 0
    s_add_u32 s63, s99, 40960
    buffer_load_dwordx4 v253, s[24:27], s63 offen offset:0 sc1 lds
    buffer_load_dwordx4 v253, s[24:27], s63 offen offset:1024 sc1 lds
    s_add_u32 m0, s68, 8192
    s_add_u32 s63, s99, 49152
    buffer_load_dwordx4 v253, s[24:27], s63 offen offset:0 sc1 lds
    buffer_load_dwordx4 v253, s[24:27], s63 offen offset:1024 sc1 lds
    s_add_u32 m0, s68, 16384
    s_add_u32 s63, s99, 57344
    buffer_load_dwordx4 v253, s[24:27], s63 offen offset:0 sc1 lds
    buffer_load_dwordx4 v253, s[24:27], s63 offen offset:1024 sc1 lds
    s_add_u32 m0, s68, 24576
    s_add_u32 s63, s99, 65536
    buffer_load_dwordx4 v253, s[24:27], s63 offen offset:0 sc1 lds
    buffer_load_dwordx4 v253, s[24:27], s63 offen offset:1024 sc1 lds
    s_add_u32 m0, s68, 32768
    s_add_u32 s63, s99, 73728
    buffer_load_dwordx4 v253, s[24:27], s63 offen offset:0 sc1 lds
    buffer_load_dwordx4 v253, s[24:27], s63 offen offset:1024 sc1 lds
    s_waitcnt vmcnt(10)
    v_mov_b32 v9, s95
    v_mov_b32 v11, 1
    s_mov_b64 exec, 1
    buffer_store_dword v11, v9, s[72:75], 0 offen offset:0
    buffer_store_dword v11, v9, s[76:79], 0 offen offset:0 sc1
    s_mov_b64 exec, -1
    s_add_u32 m0, s68, 40960
    s_add_u32 s63, s99, 81920
    buffer_load_dwordx4 v253, s[24:27], s63 offen offset:0 sc1 lds
    buffer_load_dwordx4 v253, s[24:27], s63 offen offset:1024 sc1 lds
    s_add_u32 m0, s68, 49152
    s_add_u32 s63, s99, 90112
    buffer_load_dwordx4 v253, s[24:27], s63 offen offset:0 sc1 lds
    buffer_load_dwordx4 v253, s[24:27], s63 offen offset:1024 sc1 lds
    s_add_u32 m0, s68, 57344
    s_add_u32 s63, s99, 98304
    buffer_load_dwordx4 v253, s[24:27], s63 offen offset:0 sc1 lds
    buffer_load_dwordx4 v253, s[24:27], s63 offen offset:1024 sc1 lds
    s_cmp_eq_u32 s62, 1
    s_nop 0
    s_cbranch_scc0 L_l1_87
    s_waitcnt vmcnt(43)
    v_accvgpr_read_b32 v160, a0
    v_accvgpr_read_b32 v161, a1
    v_accvgpr_read_b32 v162, a2
    v_accvgpr_read_b32 v163, a3
    v_accvgpr_read_b32 v164, a4
    v_accvgpr_read_b32 v165, a5
    v_accvgpr_read_b32 v166, a6
    v_accvgpr_read_b32 v167, a7
    v_accvgpr_read_b32 v168, a8
    v_accvgpr_read_b32 v169, a9
    v_accvgpr_read_b32 v170, a10
    v_accvgpr_read_b32 v171, a11
    v_accvgpr_read_b32 v172, a12
    v_accvgpr_read_b32 v173, a13
    v_accvgpr_read_b32 v174, a14
    v_accvgpr_read_b32 v175, a15
    v_accvgpr_read_b32 v176, a16
    v_accvgpr_read_b32 v177, a17
    v_accvgpr_read_b32 v178, a18
    v_accvgpr_read_b32 v179, a19
    v_accvgpr_read_b32 v180, a20
    v_accvgpr_read_b32 v181, a21
    v_accvgpr_read_b32 v182, a22
    v_accvgpr_read_b32 v183, a23
    v_accvgpr_read_b32 v184, a24
    v_accvgpr_read_b32 v185, a25
    v_accvgpr_read_b32 v186, a26
    v_accvgpr_read_b32 v187, a27
    v_accvgpr_read_b32 v188, a28
    v_accvgpr_read_b32 v189, a29
    v_accvgpr_read_b32 v190, a30
    v_accvgpr_read_b32 v191, a31
    v_add_f32 v160, v160, v164
    v_add_f32 v161, v161, v165
    v_add_f32 v162, v162, v166
    v_add_f32 v163, v163, v167
    v_add_f32 v160, v160, v168
    v_add_f32 v161, v161, v169
    v_add_f32 v162, v162, v170
    v_add_f32 v163, v163, v171
    v_add_f32 v160, v160, v172
    v_add_f32 v161, v161, v173
    v_add_f32 v162, v162, v174
    v_add_f32 v163, v163, v175
    v_add_f32 v160, v160, v176
    v_add_f32 v161, v161, v177
    v_add_f32 v162, v162, v178
    v_add_f32 v163, v163, v179
    v_add_f32 v160, v160, v180
    v_add_f32 v161, v161, v181
    v_add_f32 v162, v162, v182
    v_add_f32 v163, v163, v183
    v_add_f32 v160, v160, v184
    v_add_f32 v161, v161, v185
    v_add_f32 v162, v162, v186
    v_add_f32 v163, v163, v187
    v_add_f32 v160, v160, v188
    v_add_f32 v161, v161, v189
    v_add_f32 v162, v162, v190
    v_add_f32 v163, v163, v191
    s_add_u32 s48, s66, 69632
    v_add_u32 v45, s48, v2
    v_lshl_add_u32 v46, v1, 2, s48
    ds_write_b128 v45, v[160:163]
    ds_read_b32 v160, v46 offset:0
    ds_read_b32 v161, v46 offset:256
    s_waitcnt lgkmcnt(8)
    ds_read_b32 v162, v46 offset:512
    ds_read_b32 v163, v46 offset:768
    v_cmp_gt_u32 vcc, 32, v1
    s_waitcnt lgkmcnt(0)
    s_nop 0
    v_cndmask_b32 v163, 0, v163, vcc
    v_cvt_pk_bf16_f32 v45, v160, v160
    v_lshlrev_b32 v45, 16, v45
    v_sub_f32 v46, v160, v45
    v_cvt_pk_bf16_f32 v192, v45, v45
    v_cvt_pk_bf16_f32 v193, v46, 0
    v_cvt_pk_bf16_f32 v45, v161, v161
    v_lshlrev_b32 v45, 16, v45
    v_sub_f32 v46, v161, v45
    v_cvt_pk_bf16_f32 v194, v45, v45
    v_cvt_pk_bf16_f32 v195, v46, 0
    v_cvt_pk_bf16_f32 v45, v162, v162
    v_lshlrev_b32 v45, 16, v45
    v_sub_f32 v46, v162, v45
    v_cvt_pk_bf16_f32 v196, v45, v45
    v_cvt_pk_bf16_f32 v197, v46, 0
    v_cvt_pk_bf16_f32 v45, v163, v163
    v_lshlrev_b32 v45, 16, v45
    v_sub_f32 v46, v163, v45
    v_cvt_pk_bf16_f32 v198, v45, v45
    v_cvt_pk_bf16_f32 v199, v46, 0
    v_accvgpr_write_b32 a232, v192
    v_accvgpr_write_b32 a233, v193
    v_accvgpr_write_b32 a234, v194
    v_accvgpr_write_b32 a235, v195
    v_accvgpr_write_b32 a236, v196
    v_accvgpr_write_b32 a237, v197
    v_accvgpr_write_b32 a238, v198
    v_accvgpr_write_b32 a239, v199
    s_nop 1
L_l1_87:
    s_add_u32 s48, s94, 0
    v_and_b32 v9, 15, v1
    v_lshl_add_u32 v9, v9, 2, s48
    global_load_dword v10, v9, s[22:23] sc1
    s_waitcnt vmcnt(0)
    v_cmp_le_u32 vcc, 1, v10
    s_nop 1
    s_cmp_eq_u64 vcc, -1
    s_nop 1
    s_cbranch_scc1 L_fd_89
    s_mov_b32 s46, 0x200000
    s_nop 0
L_fl_88:
    global_load_dword v10, v9, s[22:23] sc1
    s_waitcnt vmcnt(0)
    v_cmp_le_u32 vcc, 1, v10
    s_nop 1
    s_cmp_eq_u64 vcc, -1
    s_nop 1
    s_cbranch_scc1 L_fd_89
    s_sub_u32 s46, s46, 1
    s_cmp_lg_u32 s46, 0
    s_nop 0
    s_cbranch_scc1 L_fl_88
    s_nop 0
L_fd_89:
    s_add_u32 s81, s80, 0
    buffer_load_dwordx4 a[0:3], v59, s[24:27], s81 offen sc1
    buffer_load_dwordx4 a[4:7], v60, s[24:27], s81 offen sc1
    s_add_u32 s81, s80, 4096
    buffer_load_dwordx4 a[8:11], v59, s[24:27], s81 offen sc1
    buffer_load_dwordx4 a[12:15], v60, s[24:27], s81 offen sc1
    s_add_u32 s81, s80, 8192
    buffer_load_dwordx4 a[16:19], v59, s[24:27], s81 offen sc1
    buffer_load_dwordx4 a[20:23], v60, s[24:27], s81 offen sc1
    s_waitcnt vmcnt(4) lgkmcnt(7)
    v_mfma_f32_16x16x32_bf16 v[112:115], v[64:67], a[0:3], v[112:115]
    s_add_u32 s81, s80, 12288
    buffer_load_dwordx4 a[24:27], v59, s[24:27], s81 offen sc1
    v_mfma_f32_16x16x32_bf16 v[132:135], v[64:67], a[4:7], 0
    ds_read_b128 v[64:67], v6 offset:8192
    v_mfma_f32_16x16x32_bf16 v[116:119], v[68:71], a[0:3], v[116:119]
    v_mfma_f32_16x16x32_bf16 v[136:139], v[68:71], a[4:7], 0
    ds_read_b128 v[68:71], v6 offset:10240
    v_mfma_f32_16x16x32_bf16 v[120:123], v[72:75], a[0:3], v[120:123]
    buffer_load_dwordx4 a[28:31], v60, s[24:27], s81 offen sc1
    v_mfma_f32_16x16x32_bf16 v[140:143], v[72:75], a[4:7], 0
    ds_read_b128 v[72:75], v6 offset:12288
    v_mfma_f32_16x16x32_bf16 v[124:127], v[76:79], a[0:3], v[124:127]
    v_mfma_f32_16x16x32_bf16 v[144:147], v[76:79], a[4:7], 0
    ds_read_b128 v[76:79], v6 offset:14336
    v_mfma_f32_16x16x32_bf16 v[128:131], v[80:83], a[0:3], v[128:131]
    s_add_u32 s81, s80, 16384
    buffer_load_dwordx4 a[32:35], v59, s[24:27], s81 offen sc1
    v_mfma_f32_16x16x32_bf16 v[148:151], v[80:83], a[4:7], 0
    ds_read_b128 v[80:83], v6 offset:16384
    s_barrier
    s_waitcnt vmcnt(5) lgkmcnt(7)
    v_mfma_f32_16x16x32_bf16 v[112:115], v[84:87], a[8:11], v[112:115]
    buffer_load_dwordx4 a[36:39], v60, s[24:27], s81 offen sc1
    v_mfma_f32_16x16x32_bf16 v[132:135], v[84:87], a[12:15], v[132:135]
    ds_read_b128 v[84:87], v6 offset:18432
    v_mfma_f32_16x16x32_bf16 v[116:119], v[88:91], a[8:11], v[116:119]
    v_mfma_f32_16x16x32_bf16 v[136:139], v[88:91], a[12:15], v[136:139]
    ds_read_b128 v[88:91], v6 offset:20480
    v_mfma_f32_16x16x32_bf16 v[120:123], v[92:95], a[8:11], v[120:123]
    s_add_u32 s81, s80, 20480
    buffer_load_dwordx4 a[40:43], v59, s[24:27], s81 offen sc1
    v_mfma_f32_16x16x32_bf16 v[140:143], v[92:95], a[12:15], v[140:143]
    ds_read_b128 v[92:95], v6 offset:22528
    v_mfma_f32_16x16x32_bf16 v[124:127], v[96:99], a[8:11], v[124:127]
    v_mfma_f32_16x16x32_bf16 v[144:147], v[96:99], a[12:15], v[144:147]
    ds_read_b128 v[96:99], v5 offset:0
    v_mfma_f32_16x16x32_bf16 v[128:131], v[100:103], a[8:11], v[128:131]
    buffer_load_dwordx4 a[44:47], v60, s[24:27], s81 offen sc1
    v_mfma_f32_16x16x32_bf16 v[148:151], v[100:103], a[12:15], v[148:151]
    ds_read_b128 v[100:103], v5 offset:2048
    s_waitcnt vmcnt(6) lgkmcnt(7)
    v_mfma_f32_16x16x32_bf16 v[112:115], v[104:107], a[16:19], v[112:115]
    s_add_u32 s81, s80, 24576
    buffer_load_dwordx4 a[48:51], v59, s[24:27], s81 offen sc1
    v_mfma_f32_16x16x32_bf16 v[132:135], v[104:107], a[20:23], v[132:135]
    ds_read_b128 v[104:107], v5 offset:4096
    v_mfma_f32_16x16x32_bf16 v[116:119], v[108:111], a[16:19], v[116:119]
    v_mfma_f32_16x16x32_bf16 v[136:139], v[108:111], a[20:23], v[136:139]
    ds_read_b128 v[108:111], v5 offset:6144
    v_mfma_f32_16x16x32_bf16 v[120:123], v[64:67], a[16:19], v[120:123]
    buffer_load_dwordx4 a[52:55], v60, s[24:27], s81 offen sc1
    v_mfma_f32_16x16x32_bf16 v[140:143], v[64:67], a[20:23], v[140:143]
    ds_read_b128 v[64:67], v5 offset:8192
    v_mfma_f32_16x16x32_bf16 v[124:127], v[68:71], a[16:19], v[124:127]
    v_mfma_f32_16x16x32_bf16 v[144:147], v[68:71], a[20:23], v[144:147]
    ds_read_b128 v[68:71], v5 offset:10240
    v_mfma_f32_16x16x32_bf16 v[128:131], v[72:75], a[16:19], v[128:131]
    s_add_u32 s81, s80, 28672
    buffer_load_dwordx4 a[56:59], v59, s[24:27], s81 offen sc1
    v_mfma_f32_16x16x32_bf16 v[148:151], v[72:75], a[20:23], v[148:151]
    ds_read_b128 v[72:75], v5 offset:12288
    s_waitcnt vmcnt(7) lgkmcnt(7)
    v_mfma_f32_16x16x32_bf16 v[112:115], v[76:79], a[24:27], v[112:115]
    buffer_load_dwordx4 a[60:63], v60, s[24:27], s81 offen sc1
    v_mfma_f32_16x16x32_bf16 v[132:135], v[76:79], a[28:31], v[132:135]
    ds_read_b128 v[76:79], v5 offset:14336
    v_mfma_f32_16x16x32_bf16 v[116:119], v[80:83], a[24:27], v[116:119]
    s_add_u32 m0, s68, 65536
    s_add_u32 s63, s100, 49152
    buffer_load_dwordx4 v253, s[24:27], s63 offen offset:0 sc1 lds
    v_mfma_f32_16x16x32_bf16 v[136:139], v[80:83], a[28:31], v[136:139]
    ds_read_b128 v[80:83], v5 offset:16384
    v_mfma_f32_16x16x32_bf16 v[120:123], v[84:87], a[24:27], v[120:123]
    s_add_u32 s81, s80, 32768
    buffer_load_dwordx4 a[64:67], v59, s[24:27], s81 offen sc1
    v_mfma_f32_16x16x32_bf16 v[140:143], v[84:87], a[28:31], v[140:143]
    ds_read_b128 v[84:87], v5 offset:18432
    v_mfma_f32_16x16x32_bf16 v[124:127], v[88:91], a[24:27], v[124:127]
    buffer_load_dwordx4 v253, s[24:27], s63 offen offset:1024 sc1 lds
    v_mfma_f32_16x16x32_bf16 v[144:147], v[88:91], a[28:31], v[144:147]
    ds_read_b128 v[88:91], v5 offset:20480
    v_mfma_f32_16x16x32_bf16 v[128:131], v[92:95], a[24:27], v[128:131]
    buffer_load_dwordx4 a[68:71], v60, s[24:27], s81 offen sc1
    v_mfma_f32_16x16x32_bf16 v[148:151], v[92:95], a[28:31], v[148:151]
    ds_read_b128 v[92:95], v5 offset:22528
    s_cmp_eq_u32 s62, 1
    s_nop 5
    s_cbranch_scc0 L_l1_90
    s_waitcnt vmcnt(56)
    s_nop 0
L_l1_90:
    s_barrier
    s_cmp_eq_u32 s62, 1
    s_nop 0
    s_cbranch_scc0 L_l1_91
    s_cmp_lg_u32 s42, 0
    s_nop 0
    s_cbranch_scc1 L_w0_92
    s_cmp_lt_u32 s70, 364
    s_nop 0
    s_cbranch_scc0 L_notask_93
    s_and_b32 s48, s70, 1
    s_add_u32 s49, s48, 2
    s_mov_b32 s69, 53
    s_cmp_lt_u32 s70, 40
    s_cselect_b32 s48, s48, s49
    s_cselect_b32 s69, 19, s69
    s_sub_u32 s49, s70, 40
    s_lshr_b32 s50, s49, 3
    s_add_u32 s50, s50, 4
    s_cmp_lt_u32 s49, 216
    s_cselect_b32 s48, s50, s48
    s_cselect_b32 s69, 7, s69
    s_lshl_b32 s3, s48, 7
    s_add_u32 s3, s3, 98304
    s_lshr_b32 s49, s48, 1
    s_lshl_b32 s49, s49, 12
    s_and_b32 s48, s48, 1
    s_lshl_b32 s48, s48, 8
    s_add_u32 s48, s48, s49
    s_add_u32 s48, s48, 36352
    v_mov_b32 v9, s48
    v_mov_b32 v11, 1
    s_mov_b64 exec, 1
    global_atomic_add v61, v9, v11, s[22:23] sc0 sc1
    s_mov_b64 exec, -1
    s_nop 0
L_notask_93:
L_w0_92:
L_l1_91:
    s_waitcnt vmcnt(10) lgkmcnt(7)
    v_mfma_f32_16x16x32_bf16 v[112:115], v[96:99], a[32:35], v[112:115]
    s_add_u32 s81, s80, 36864
    buffer_load_dwordx4 a[72:75], v59, s[24:27], s81 offen sc1
    v_mfma_f32_16x16x32_bf16 v[132:135], v[96:99], a[36:39], v[132:135]
    ds_read_b128 v[96:99], v5 offset:24576
    v_mfma_f32_16x16x32_bf16 v[116:119], v[100:103], a[32:35], v[116:119]
    s_add_u32 m0, s68, 73728
    s_add_u32 s63, s100, 57344
    buffer_load_dwordx4 v253, s[24:27], s63 offen offset:0 sc1 lds
    v_mfma_f32_16x16x32_bf16 v[136:139], v[100:103], a[36:39], v[136:139]
    ds_read_b128 v[100:103], v5 offset:26624
    v_mfma_f32_16x16x32_bf16 v[120:123], v[104:107], a[32:35], v[120:123]
    v_mfma_f32_16x16x32_bf16 v[140:143], v[104:107], a[36:39], v[140:143]
    ds_read_b128 v[104:107], v5 offset:28672
    v_mfma_f32_16x16x32_bf16 v[124:127], v[108:111], a[32:35], v[124:127]
    buffer_load_dwordx4 a[76:79], v60, s[24:27], s81 offen sc1
    v_mfma_f32_16x16x32_bf16 v[144:147], v[108:111], a[36:39], v[144:147]
    ds_read_b128 v[108:111], v5 offset:30720
    v_mfma_f32_16x16x32_bf16 v[128:131], v[64:67], a[32:35], v[128:131]
    buffer_load_dwordx4 v253, s[24:27], s63 offen offset:1024 sc1 lds
    v_mfma_f32_16x16x32_bf16 v[148:151], v[64:67], a[36:39], v[148:151]
    ds_read_b128 v[64:67], v5 offset:32768
    s_waitcnt vmcnt(12) lgkmcnt(7)
    v_mfma_f32_16x16x32_bf16 v[112:115], v[68:71], a[40:43], v[112:115]
    v_mfma_f32_16x16x32_bf16 v[132:135], v[68:71], a[44:47], v[132:135]
    ds_read_b128 v[68:71], v5 offset:34816
    v_mfma_f32_16x16x32_bf16 v[116:119], v[72:75], a[40:43], v[116:119]
    s_add_u32 m0, s68, 81920
    s_add_u32 s63, s100, 65536
    buffer_load_dwordx4 v253, s[24:27], s63 offen offset:0 sc1 lds
    v_mfma_f32_16x16x32_bf16 v[136:139], v[72:75], a[44:47], v[136:139]
    ds_read_b128 v[72:75], v5 offset:36864
    v_mfma_f32_16x16x32_bf16 v[120:123], v[76:79], a[40:43], v[120:123]
    v_mfma_f32_16x16x32_bf16 v[140:143], v[76:79], a[44:47], v[140:143]
    ds_read_b128 v[76:79], v5 offset:38912
    v_mfma_f32_16x16x32_bf16 v[124:127], v[80:83], a[40:43], v[124:127]
    buffer_load_dwordx4 v253, s[24:27], s63 offen offset:1024 sc1 lds
    v_mfma_f32_16x16x32_bf16 v[144:147], v[80:83], a[44:47], v[144:147]
    ds_read_b128 v[80:83], v5 offset:40960
    v_mfma_f32_16x16x32_bf16 v[128:131], v[84:87], a[40:43], v[128:131]
    v_mfma_f32_16x16x32_bf16 v[148:151], v[84:87], a[44:47], v[148:151]
    ds_read_b128 v[84:87], v5 offset:43008
    s_waitcnt vmcnt(12) lgkmcnt(7)
    v_mfma_f32_16x16x32_bf16 v[112:115], v[88:91], a[48:51], v[112:115]
    v_mfma_f32_16x16x32_bf16 v[132:135], v[88:91], a[52:55], v[132:135]
    ds_read_b128 v[88:91], v5 offset:45056
    v_mfma_f32_16x16x32_bf16 v[116:119], v[92:95], a[48:51], v[116:119]
    v_mfma_f32_16x16x32_bf16 v[136:139], v[92:95], a[52:55], v[136:139]
    ds_read_b128 v[92:95], v5 offset:47104
    v_mfma_f32_16x16x32_bf16 v[120:123], v[96:99], a[48:51], v[120:123]
    v_mfma_f32_16x16x32_bf16 v[140:143], v[96:99], a[52:55], v[140:143]
    ds_read_b128 v[96:99], v5 offset:49152
    v_mfma_f32_16x16x32_bf16 v[124:127], v[100:103], a[48:51], v[124:127]
    v_mfma_f32_16x16x32_bf16 v[144:147], v[100:103], a[52:55], v[144:147]
    ds_read_b128 v[100:103], v5 offset:51200
    v_mfma_f32_16x16x32_bf16 v[128:131], v[104:107], a[48:51], v[128:131]
    v_mfma_f32_16x16x32_bf16 v[148:151], v[104:107], a[52:55], v[148:151]
    ds_read_b128 v[104:107], v5 offset:53248
    s_waitcnt vmcnt(10) lgkmcnt(7)
    v_mfma_f32_16x16x32_bf16 v[112:115], v[108:111], a[56:59], v[112:115]
    v_mfma_f32_16x16x32_bf16 v[132:135], v[108:111], a[60:63], v[132:135]
    ds_read_b128 v[108:111], v5 offset:55296
    v_mfma_f32_16x16x32_bf16 v[116:119], v[64:67], a[56:59], v[116:119]
    v_mfma_f32_16x16x32_bf16 v[136:139], v[64:67], a[60:63], v[136:139]
    ds_read_b128 v[64:67], v5 offset:57344
    v_mfma_f32_16x16x32_bf16 v[120:123], v[68:71], a[56:59], v[120:123]
    v_mfma_f32_16x16x32_bf16 v[140:143], v[68:71], a[60:63], v[140:143]
    ds_read_b128 v[68:71], v5 offset:59392
    v_mfma_f32_16x16x32_bf16 v[124:127], v[72:75], a[56:59], v[124:127]
    v_mfma_f32_16x16x32_bf16 v[144:147], v[72:75], a[60:63], v[144:147]
    v_mfma_f32_16x16x32_bf16 v[128:131], v[76:79], a[56:59], v[128:131]
    v_mfma_f32_16x16x32_bf16 v[148:151], v[76:79], a[60:63], v[148:151]
    s_waitcnt vmcnt(6) lgkmcnt(5)
    v_mfma_f32_16x16x32_bf16 v[112:115], v[80:83], a[64:67], v[112:115]
    s_mul_i32 s48, s42, 5120
    s_xor_b32 s49, s42, 2
    s_mul_i32 s49, s49, 5120
    s_add_u32 s48, s48, 139264
    s_add_u32 s49, s49, 139264
    v_mfma_f32_16x16x32_bf16 v[132:135], v[80:83], a[68:71], v[132:135]
    v_add_u32 v47, s48, v2
    v_mfma_f32_16x16x32_bf16 v[116:119], v[84:87], a[64:67], v[116:119]
    v_add_u32 v48, s49, v2
    v_mfma_f32_16x16x32_bf16 v[136:139], v[84:87], a[68:71], v[136:139]
    v_lshrrev_b32 v49, 4, v1
    v_and_b32 v50, 15, v1
    v_mfma_f32_16x16x32_bf16 v[120:123], v[88:91], a[64:67], v[120:123]
    s_mul_i32 s50, s97, 40960
    s_mul_i32 s51, s43, 5120
    s_add_u32 s50, s50, s51
    s_lshl_b32 s51, s64, 8
    s_add_u32 s50, s50, s51
    s_add_u32 s50, s50, 28274688
    v_and_b32 v51, 1, v49
    v_lshlrev_b32 v51, 9, v51
    v_mfma_f32_16x16x32_bf16 v[140:143], v[88:91], a[68:71], v[140:143]
    v_lshl_add_u32 v51, v50, 4, v51
    v_lshrrev_b32 v52, 1, v49
    v_mfma_f32_16x16x32_bf16 v[124:127], v[92:95], a[64:67], v[124:127]
    v_lshl_add_u32 v53, v52, 10, v51
    v_lshl_add_u32 v54, v52, 3, v51
    s_add_u32 s51, s50, 4096
    v_mfma_f32_16x16x32_bf16 v[144:147], v[92:95], a[68:71], v[144:147]
    s_lshl_b32 s53, s97, 5
    s_lshl_b32 s54, s64, 4
    s_add_u32 s53, s53, s54
    v_add_u32 v50, s53, v50
    v_lshlrev_b32 v50, 2, v50
    v_mfma_f32_16x16x32_bf16 v[128:131], v[96:99], a[64:67], v[128:131]
    v_lshrrev_b32 v51, 5, v1
    v_lshl_add_u32 v50, v51, 13, v50
    s_lshl_b32 s52, s43, 14
    s_add_u32 s52, s52, 50294784
    v_mov_b32 v55, 0x3f803f80
    v_mfma_f32_16x16x32_bf16 v[148:151], v[96:99], a[68:71], v[148:151]
    s_waitcnt vmcnt(3) lgkmcnt(0)
    v_mfma_f32_16x16x32_bf16 v[132:135], v[100:103], a[76:79], v[132:135]
    v_mfma_f32_16x16x32_bf16 v[136:139], v[104:107], a[76:79], v[136:139]
    v_mfma_f32_16x16x32_bf16 v[140:143], v[108:111], a[76:79], v[140:143]
    v_mfma_f32_16x16x32_bf16 v[144:147], v[64:67], a[76:79], v[144:147]
    v_mfma_f32_16x16x32_bf16 v[148:151], v[68:71], a[76:79], v[148:151]
    v_mfma_f32_16x16x32_bf16 v[112:115], v[100:103], a[72:75], v[112:115]
    s_nop 2
    ds_write_b128 v47, v[132:135] offset:0
    v_mfma_f32_16x16x32_bf16 v[116:119], v[104:107], a[72:75], v[116:119]
    ds_write_b128 v47, v[136:139] offset:1024
    v_mfma_f32_16x16x32_bf16 v[120:123], v[108:111], a[72:75], v[120:123]
    ds_write_b128 v47, v[140:143] offset:2048
    v_mfma_f32_16x16x32_bf16 v[124:127], v[64:67], a[72:75], v[124:127]
    ds_write_b128 v47, v[144:147] offset:3072
    v_mfma_f32_16x16x32_bf16 v[128:131], v[68:71], a[72:75], v[128:131]
    ds_write_b128 v47, v[148:151] offset:4096
    s_waitcnt lgkmcnt(0)
    s_barrier
    ds_read_b128 v[132:135], v48 offset:0
    ds_read_b128 v[136:139], v48 offset:1024
    ds_read_b128 v[140:143], v48 offset:2048
    ds_read_b128 v[144:147], v48 offset:3072
    ds_read_b128 v[148:151], v48 offset:4096
    s_waitcnt lgkmcnt(4)
    v_pk_add_f32 v[112:113], v[112:113], v[132:133]
    v_pk_add_f32 v[114:115], v[114:115], v[134:135]
    v_cvt_pk_bf16_f32 v16, v112, v113
    v_cvt_pk_bf16_f32 v17, v114, v115
    s_waitcnt lgkmcnt(3)
    v_pk_add_f32 v[116:117], v[116:117], v[136:137]
    v_pk_add_f32 v[118:119], v[118:119], v[138:139]
    v_cvt_pk_bf16_f32 v18, v116, v117
    v_cvt_pk_bf16_f32 v19, v118, v119
    buffer_store_dwordx4 v[16:19], v53, s[24:27], s50 offen offset:0 sc1
    s_waitcnt lgkmcnt(2)
    v_pk_add_f32 v[120:121], v[120:121], v[140:141]
    v_pk_add_f32 v[122:123], v[122:123], v[142:143]
    v_cvt_pk_bf16_f32 v20, v120, v121
    v_cvt_pk_bf16_f32 v21, v122, v123
    s_waitcnt lgkmcnt(1)
    v_pk_add_f32 v[124:125], v[124:125], v[144:145]
    v_pk_add_f32 v[126:127], v[126:127], v[146:147]
    v_cvt_pk_bf16_f32 v22, v124, v125
    v_cvt_pk_bf16_f32 v23, v126, v127
    buffer_store_dwordx4 v[20:23], v53, s[24:27], s50 offen offset:2048 sc1
    s_waitcnt lgkmcnt(0)
    v_pk_add_f32 v[128:129], v[128:129], v[148:149]
    v_pk_add_f32 v[130:131], v[130:131], v[150:151]
    v_cvt_pk_bf16_f32 v24, v128, v129
    v_cvt_pk_bf16_f32 v25, v130, v131
    buffer_store_dwordx2 v[24:25], v54, s[24:27], s51 offen offset:0 sc1
    v_dot2_f32_bf16 v56, v16, v55, 0
    v_dot2_f32_bf16 v57, v16, v16, 0
    v_dot2_f32_bf16 v56, v17, v55, v56
    v_dot2_f32_bf16 v57, v17, v17, v57
    v_dot2_f32_bf16 v56, v18, v55, v56
    v_dot2_f32_bf16 v57, v18, v18, v57
    v_dot2_f32_bf16 v56, v19, v55, v56
    v_dot2_f32_bf16 v57, v19, v19, v57
    v_dot2_f32_bf16 v56, v20, v55, v56
    v_dot2_f32_bf16 v57, v20, v20, v57
    v_dot2_f32_bf16 v56, v21, v55, v56
    v_dot2_f32_bf16 v57, v21, v21, v57
    v_dot2_f32_bf16 v56, v22, v55, v56
    v_dot2_f32_bf16 v57, v22, v22, v57
    v_dot2_f32_bf16 v56, v23, v55, v56
    v_dot2_f32_bf16 v57, v23, v23, v57
    v_dot2_f32_bf16 v56, v24, v55, v56
    v_dot2_f32_bf16 v57, v24, v24, v57
    v_dot2_f32_bf16 v56, v25, v55, v56
    v_dot2_f32_bf16 v57, v25, v25, v57
    s_nop 2
    v_permlane32_swap_b32 v56, v57
    v_add_f32 v56, v56, v57
    v_mov_b32 v57, v56
    s_nop 1
    v_permlane16_swap_b32 v56, v57
    v_add_f32 v56, v56, v57
    s_mov_b32 exec_lo, 0xffff
    s_mov_b32 exec_hi, 0xffff
    buffer_store_dword v56, v50, s[24:27], s52 offen offset:0 sc1
    s_mov_b64 exec, -1
    s_mul_i32 s50, s96, 40960
    s_add_u32 s50, s50, 28274688
    v_lshrrev_b32 v40, 5, v1
    v_lshlrev_b32 v41, 10, v40
    v_bfe_u32 v42, v1, 4, 1
    v_lshl_add_u32 v41, v42, 9, v41
    v_and_b32 v43, 15, v1
    v_lshl_add_u32 v41, v43, 4, v41
    v_lshlrev_b32 v39, 9, v42
    v_lshl_add_u32 v39, v40, 8, v39
    v_lshl_add_u32 v39, v43, 4, v39
    s_lshl_b32 s48, s96, 5
    v_add_u32 v47, s48, v43
    v_lshl_add_u32 v47, v40, 4, v47
    v_lshlrev_b32 v47, 2, v47
    v_lshl_add_u32 v47, v42, 13, v47
    s_mul_i32 s52, s96, 110592
    s_add_u32 s52, s52, 36139008
    s_mul_i32 s53, s41, 5120
    s_add_u32 s53, s53, s52
    s_lshr_b32 s48, s41, 2
    s_mul_i32 s48, s48, 7
    s_and_b32 s49, s41, 3
    s_lshl_b32 s54, s49, 1
    s_min_u32 s55, s49, 1
    s_sub_u32 s54, s54, s55
    s_add_u32 s54, s54, s48
    s_add_u32 s54, s54, 80
    s_lshl_b32 s54, s54, 10
    s_add_u32 s54, s54, s52
    s_add_u32 s55, s54, 1024
    s_cmp_eq_u32 s49, 0
    s_cselect_b32 s55, 0x7f000000, s55
    s_add_u32 s56, s53, 4096
    s_barrier
    ds_read_b128 v[64:67], v3 offset:24576
    ds_read_b128 v[68:71], v3 offset:25600
    ds_read_b128 v[72:75], v3 offset:26624
    ds_read_b128 v[76:79], v3 offset:27648
    ds_read_b128 v[80:83], v3 offset:28672
    ds_read_b128 v[84:87], v3 offset:29696
    ds_read_b128 v[88:91], v3 offset:30720
    ds_read_b128 v[92:95], v3 offset:31744
    ds_read_b128 v[96:99], v3 offset:32768
    ds_read_b128 v[100:103], v3 offset:33792
    ds_read_b128 v[104:107], v3 offset:34816
    ds_read_b128 v[108:111], v3 offset:35840
    s_add_u32 m0, s68, 139264
    s_add_u32 s63, s100, 73728
    buffer_load_dwordx4 v253, s[24:27], s63 offen offset:0 sc1 lds
    buffer_load_dwordx4 v253, s[24:27], s63 offen offset:1024 sc1 lds
    s_add_u32 m0, s68, 147456
    s_add_u32 s63, s100, 81920
    buffer_load_dwordx4 v253, s[24:27], s63 offen offset:0 sc1 lds
    buffer_load_dwordx4 v253, s[24:27], s63 offen offset:1024 sc1 lds
    s_add_u32 m0, s68, 155648
    s_add_u32 s63, s100, 90112
    buffer_load_dwordx4 v253, s[24:27], s63 offen offset:0 sc1 lds
    buffer_load_dwordx4 v253, s[24:27], s63 offen offset:1024 sc1 lds
    s_waitcnt vmcnt(6)
    v_mov_b32 v9, s91
    v_mov_b32 v11, 1
    s_mov_b64 exec, 1
    buffer_store_dword v11, v9, s[72:75], 0 offen offset:256
    buffer_store_dword v11, v9, s[76:79], 0 offen offset:256 sc1
    s_mov_b64 exec, -1
    s_add_u32 m0, s68, 0
    s_add_u32 s63, s100, 98304
    buffer_load_dwordx4 v253, s[24:27], s63 offen offset:0 sc1 lds
    buffer_load_dwordx4 v253, s[24:27], s63 offen offset:1024 sc1 lds
    s_add_u32 m0, s68, 8192
    s_add_u32 s63, s100, 106496
    buffer_load_dwordx4 v253, s[24:27], s63 offen offset:0 sc1 lds
    buffer_load_dwordx4 v253, s[24:27], s63 offen offset:1024 sc1 lds
    s_add_u32 s48, s90, 256
    v_and_b32 v9, 15, v1
    v_lshl_add_u32 v9, v9, 2, s48
    global_load_dword v10, v9, s[22:23] sc1
    s_waitcnt vmcnt(0)
    v_cmp_le_u32 vcc, 1, v10
    s_nop 1
    s_cmp_eq_u64 vcc, -1
    s_nop 1
    s_cbranch_scc1 L_fd_95
    s_mov_b32 s46, 0x200000
    s_nop 0
L_fl_94:
    global_load_dword v10, v9, s[22:23] sc1
    s_waitcnt vmcnt(0)
    v_cmp_le_u32 vcc, 1, v10
    s_nop 1
    s_cmp_eq_u64 vcc, -1
    s_nop 1
    s_cbranch_scc1 L_fd_95
    s_sub_u32 s46, s46, 1
    s_cmp_lg_u32 s46, 0
    s_nop 0
    s_cbranch_scc1 L_fl_94
    s_nop 0
L_fd_95:
    s_add_u32 s51, s50, 0
    buffer_load_dwordx4 a[0:3], v41, s[24:27], s51 offen offset:0 sc1
    buffer_load_dwordx4 a[4:7], v41, s[24:27], s51 offen offset:256 sc1
    buffer_load_dwordx4 a[8:11], v41, s[24:27], s51 offen offset:2048 sc1
    buffer_load_dwordx4 a[12:15], v41, s[24:27], s51 offen offset:2304 sc1
    s_add_u32 s51, s50, 4096
    buffer_load_dwordx4 a[16:19], v41, s[24:27], s51 offen offset:0 sc1
    buffer_load_dwordx4 a[20:23], v41, s[24:27], s51 offen offset:256 sc1
    s_waitcnt vmcnt(4) lgkmcnt(9)
    v_mfma_f32_16x16x32_bf16 v[112:115], v[64:67], a[0:3], 0
    v_mfma_f32_16x16x32_bf16 v[116:119], v[64:67], a[4:7], 0
    ds_read_b128 v[64:67], v3 offset:36864
    v_mfma_f32_16x16x32_bf16 v[120:123], v[68:71], a[0:3], 0
    buffer_load_dwordx4 a[24:27], v41, s[24:27], s51 offen offset:2048 sc1
    v_mfma_f32_16x16x32_bf16 v[124:127], v[68:71], a[4:7], 0
    ds_read_b128 v[68:71], v3 offset:37888
    v_mfma_f32_16x16x32_bf16 v[128:131], v[72:75], a[0:3], 0
    v_mfma_f32_16x16x32_bf16 v[132:135], v[72:75], a[4:7], 0
    ds_read_b128 v[72:75], v3 offset:38912
    s_waitcnt lgkmcnt(9)
    v_mfma_f32_16x16x32_bf16 v[136:139], v[76:79], a[0:3], 0
    buffer_load_dwordx4 a[28:31], v41, s[24:27], s51 offen offset:2304 sc1
    v_mfma_f32_16x16x32_bf16 v[140:143], v[76:79], a[4:7], 0
    ds_read_b128 v[76:79], v3 offset:39936
    v_mfma_f32_16x16x32_bf16 v[144:147], v[80:83], a[0:3], 0
    v_mfma_f32_16x16x32_bf16 v[148:151], v[80:83], a[4:7], 0
    ds_read_b128 v[80:83], v3 offset:40960
    v_mfma_f32_16x16x32_bf16 v[152:155], v[84:87], a[0:3], 0
    s_add_u32 s51, s50, 8192
    buffer_load_dwordx4 a[32:35], v41, s[24:27], s51 offen offset:0 sc1
    v_mfma_f32_16x16x32_bf16 v[156:159], v[84:87], a[4:7], 0
    ds_read_b128 v[84:87], v3 offset:41984
    s_cmp_eq_u32 s62, 1
    s_nop 5
    s_cbranch_scc0 L_l1_96
    s_cmp_lg_u32 s42, 0
    s_nop 0
    s_cbranch_scc1 L_w0_97
    s_cmp_lt_u32 s70, 364
    s_nop 0
    s_cbranch_scc0 L_notask_98
    v_readfirstlane_b32 s48, v61
    s_nop 1
    s_cmp_eq_u32 s48, s69
    s_cbranch_scc0 L_notlast_99
    v_lshlrev_b32 v9, 12, v1
    v_add_u32 v9, s3, v9
    v_mov_b32 v11, 1
    s_mov_b64 exec, 0xff
    global_store_dword v9, v11, s[22:23] sc1
    s_mov_b64 exec, -1
    s_nop 0
L_notlast_99:
    s_nop 0
L_notask_98:
L_w0_97:
L_l1_96:
    s_waitcnt vmcnt(5) lgkmcnt(9)
    v_mfma_f32_16x16x32_bf16 v[112:115], v[88:91], a[8:11], v[112:115]
    v_mfma_f32_16x16x32_bf16 v[116:119], v[88:91], a[12:15], v[116:119]
    ds_read_b128 v[88:91], v3 offset:43008
    v_mfma_f32_16x16x32_bf16 v[120:123], v[92:95], a[8:11], v[120:123]
    buffer_load_dwordx4 a[36:39], v41, s[24:27], s51 offen offset:256 sc1
    v_mfma_f32_16x16x32_bf16 v[124:127], v[92:95], a[12:15], v[124:127]
    ds_read_b128 v[92:95], v3 offset:44032
    v_mfma_f32_16x16x32_bf16 v[128:131], v[96:99], a[8:11], v[128:131]
    v_mfma_f32_16x16x32_bf16 v[132:135], v[96:99], a[12:15], v[132:135]
    ds_read_b128 v[96:99], v3 offset:45056
    s_waitcnt lgkmcnt(9)
    v_mfma_f32_16x16x32_bf16 v[136:139], v[100:103], a[8:11], v[136:139]
    buffer_load_dwordx4 a[40:43], v41, s[24:27], s51 offen offset:2048 sc1
    v_mfma_f32_16x16x32_bf16 v[140:143], v[100:103], a[12:15], v[140:143]
    ds_read_b128 v[100:103], v3 offset:46080
    v_mfma_f32_16x16x32_bf16 v[144:147], v[104:107], a[8:11], v[144:147]
    v_mfma_f32_16x16x32_bf16 v[148:151], v[104:107], a[12:15], v[148:151]
    ds_read_b128 v[104:107], v3 offset:47104
    v_mfma_f32_16x16x32_bf16 v[152:155], v[108:111], a[8:11], v[152:155]
    buffer_load_dwordx4 a[44:47], v41, s[24:27], s51 offen offset:2304 sc1
    v_mfma_f32_16x16x32_bf16 v[156:159], v[108:111], a[12:15], v[156:159]
    ds_read_b128 v[108:111], v3 offset:48128
    s_barrier
    s_waitcnt vmcnt(6) lgkmcnt(9)
    v_mfma_f32_16x16x32_bf16 v[112:115], v[64:67], a[16:19], v[112:115]
    v_mfma_f32_16x16x32_bf16 v[116:119], v[64:67], a[20:23], v[116:119]
    ds_read_b128 v[64:67], v3 offset:49152
    v_mfma_f32_16x16x32_bf16 v[120:123], v[68:71], a[16:19], v[120:123]
    s_add_u32 s51, s50, 12288
    buffer_load_dwordx4 a[48:51], v41, s[24:27], s51 offen offset:0 sc1
    v_mfma_f32_16x16x32_bf16 v[124:127], v[68:71], a[20:23], v[124:127]
    ds_read_b128 v[68:71], v3 offset:50176
    v_mfma_f32_16x16x32_bf16 v[128:131], v[72:75], a[16:19], v[128:131]
    v_mfma_f32_16x16x32_bf16 v[132:135], v[72:75], a[20:23], v[132:135]
    ds_read_b128 v[72:75], v3 offset:51200
    s_waitcnt lgkmcnt(9)
    v_mfma_f32_16x16x32_bf16 v[136:139], v[76:79], a[16:19], v[136:139]
    buffer_load_dwordx4 a[52:55], v41, s[24:27], s51 offen offset:256 sc1
    v_mfma_f32_16x16x32_bf16 v[140:143], v[76:79], a[20:23], v[140:143]
    ds_read_b128 v[76:79], v3 offset:52224
    v_mfma_f32_16x16x32_bf16 v[144:147], v[80:83], a[16:19], v[144:147]
    v_mfma_f32_16x16x32_bf16 v[148:151], v[80:83], a[20:23], v[148:151]
    ds_read_b128 v[80:83], v3 offset:53248
    v_mfma_f32_16x16x32_bf16 v[152:155], v[84:87], a[16:19], v[152:155]
    buffer_load_dwordx4 a[56:59], v41, s[24:27], s51 offen offset:2048 sc1
    v_mfma_f32_16x16x32_bf16 v[156:159], v[84:87], a[20:23], v[156:159]
    ds_read_b128 v[84:87], v3 offset:54272
    s_waitcnt vmcnt(7) lgkmcnt(9)
    v_mfma_f32_16x16x32_bf16 v[112:115], v[88:91], a[24:27], v[112:115]
    buffer_load_dwordx4 a[60:63], v41, s[24:27], s51 offen offset:2304 sc1
    v_mfma_f32_16x16x32_bf16 v[116:119], v[88:91], a[28:31], v[116:119]
    ds_read_b128 v[88:91], v3 offset:55296
    v_mfma_f32_16x16x32_bf16 v[120:123], v[92:95], a[24:27], v[120:123]
    v_mfma_f32_16x16x32_bf16 v[124:127], v[92:95], a[28:31], v[124:127]
    ds_read_b128 v[92:95], v3 offset:56320
    v_mfma_f32_16x16x32_bf16 v[128:131], v[96:99], a[24:27], v[128:131]
    s_add_u32 s51, s50, 16384
    buffer_load_dwordx4 a[64:67], v41, s[24:27], s51 offen offset:0 sc1
    v_mfma_f32_16x16x32_bf16 v[132:135], v[96:99], a[28:31], v[132:135]
    ds_read_b128 v[96:99], v3 offset:57344
    s_waitcnt lgkmcnt(9)
    v_mfma_f32_16x16x32_bf16 v[136:139], v[100:103], a[24:27], v[136:139]
    buffer_load_dwordx4 a[68:71], v41, s[24:27], s51 offen offset:256 sc1
    v_mfma_f32_16x16x32_bf16 v[140:143], v[100:103], a[28:31], v[140:143]
    ds_read_b128 v[100:103], v3 offset:58368
    v_mfma_f32_16x16x32_bf16 v[144:147], v[104:107], a[24:27], v[144:147]
    v_mfma_f32_16x16x32_bf16 v[148:151], v[104:107], a[28:31], v[148:151]
    ds_read_b128 v[104:107], v3 offset:59392
    v_mfma_f32_16x16x32_bf16 v[152:155], v[108:111], a[24:27], v[152:155]
    s_mov_b32 s49, 50294784
    buffer_load_dword v48, v47, s[24:27], s49 offen sc1
    v_mfma_f32_16x16x32_bf16 v[156:159], v[108:111], a[28:31], v[156:159]
    ds_read_b128 v[108:111], v3 offset:60416
    s_waitcnt vmcnt(9) lgkmcnt(9)
    v_mfma_f32_16x16x32_bf16 v[112:115], v[64:67], a[32:35], v[112:115]
    buffer_load_dwordx4 a[72:75], v41, s[24:27], s51 offen offset:2048 sc1
    v_mfma_f32_16x16x32_bf16 v[116:119], v[64:67], a[36:39], v[116:119]
    ds_read_b128 v[64:67], v3 offset:61440
    v_mfma_f32_16x16x32_bf16 v[120:123], v[68:71], a[32:35], v[120:123]
    buffer_load_dwordx4 a[76:79], v41, s[24:27], s51 offen offset:2304 sc1
    v_mfma_f32_16x16x32_bf16 v[124:127], v[68:71], a[36:39], v[124:127]
    ds_read_b128 v[68:71], v3 offset:62464
    v_mfma_f32_16x16x32_bf16 v[128:131], v[72:75], a[32:35], v[128:131]
    s_add_u32 s51, s50, 20480
    buffer_load_dwordx4 a[80:83], v41, s[24:27], s51 offen offset:0 sc1
    v_mfma_f32_16x16x32_bf16 v[132:135], v[72:75], a[36:39], v[132:135]
    ds_read_b128 v[72:75], v3 offset:63488
    s_waitcnt lgkmcnt(9)
    v_mfma_f32_16x16x32_bf16 v[136:139], v[76:79], a[32:35], v[136:139]
    s_mov_b32 s49, 50311168
    buffer_load_dword v49, v47, s[24:27], s49 offen sc1
    v_mfma_f32_16x16x32_bf16 v[140:143], v[76:79], a[36:39], v[140:143]
    ds_read_b128 v[76:79], v3 offset:64512
    v_mfma_f32_16x16x32_bf16 v[144:147], v[80:83], a[32:35], v[144:147]
    s_add_u32 m0, s68, 16384
    s_add_u32 s63, s100, 114688
    buffer_load_dwordx4 v253, s[24:27], s63 offen offset:0 sc1 lds
    v_mfma_f32_16x16x32_bf16 v[148:151], v[80:83], a[36:39], v[148:151]
    ds_read_b128 v[80:83], v4 offset:0
    v_mfma_f32_16x16x32_bf16 v[152:155], v[84:87], a[32:35], v[152:155]
    buffer_load_dwordx4 v253, s[24:27], s63 offen offset:1024 sc1 lds
    v_mfma_f32_16x16x32_bf16 v[156:159], v[84:87], a[36:39], v[156:159]
    ds_read_b128 v[84:87], v4 offset:1024
    s_waitcnt vmcnt(13) lgkmcnt(9)
    v_mfma_f32_16x16x32_bf16 v[112:115], v[88:91], a[40:43], v[112:115]
    v_mfma_f32_16x16x32_bf16 v[116:119], v[88:91], a[44:47], v[116:119]
    ds_read_b128 v[88:91], v4 offset:2048
    v_mfma_f32_16x16x32_bf16 v[120:123], v[92:95], a[40:43], v[120:123]
    buffer_load_dwordx4 a[84:87], v41, s[24:27], s51 offen offset:256 sc1
    v_mfma_f32_16x16x32_bf16 v[124:127], v[92:95], a[44:47], v[124:127]
    ds_read_b128 v[92:95], v4 offset:3072
    v_mfma_f32_16x16x32_bf16 v[128:131], v[96:99], a[40:43], v[128:131]
    v_mfma_f32_16x16x32_bf16 v[132:135], v[96:99], a[44:47], v[132:135]
    ds_read_b128 v[96:99], v4 offset:4096
    s_waitcnt lgkmcnt(9)
    v_mfma_f32_16x16x32_bf16 v[136:139], v[100:103], a[40:43], v[136:139]
    buffer_load_dwordx4 a[88:91], v41, s[24:27], s51 offen offset:2048 sc1
    v_mfma_f32_16x16x32_bf16 v[140:143], v[100:103], a[44:47], v[140:143]
    ds_read_b128 v[100:103], v4 offset:5120
    v_mfma_f32_16x16x32_bf16 v[144:147], v[104:107], a[40:43], v[144:147]
    v_mfma_f32_16x16x32_bf16 v[148:151], v[104:107], a[44:47], v[148:151]
    ds_read_b128 v[104:107], v4 offset:6144
    v_mfma_f32_16x16x32_bf16 v[152:155], v[108:111], a[40:43], v[152:155]
    s_mov_b32 s49, 50327552
    buffer_load_dword v50, v47, s[24:27], s49 offen sc1
    v_mfma_f32_16x16x32_bf16 v[156:159], v[108:111], a[44:47], v[156:159]
    ds_read_b128 v[108:111], v4 offset:7168
    s_barrier
    s_waitcnt vmcnt(14) lgkmcnt(9)
    v_mfma_f32_16x16x32_bf16 v[112:115], v[64:67], a[48:51], v[112:115]
    buffer_load_dwordx4 a[92:95], v41, s[24:27], s51 offen offset:2304 sc1
    v_mfma_f32_16x16x32_bf16 v[116:119], v[64:67], a[52:55], v[116:119]
    ds_read_b128 v[64:67], v3 offset:0
    v_mfma_f32_16x16x32_bf16 v[120:123], v[68:71], a[48:51], v[120:123]
    s_add_u32 s51, s50, 24576
    buffer_load_dwordx4 a[96:99], v41, s[24:27], s51 offen offset:0 sc1
    v_mfma_f32_16x16x32_bf16 v[124:127], v[68:71], a[52:55], v[124:127]
    ds_read_b128 v[68:71], v3 offset:1024
    v_mfma_f32_16x16x32_bf16 v[128:131], v[72:75], a[48:51], v[128:131]
    v_mfma_f32_16x16x32_bf16 v[132:135], v[72:75], a[52:55], v[132:135]
    ds_read_b128 v[72:75], v3 offset:2048
    s_waitcnt lgkmcnt(9)
    v_mfma_f32_16x16x32_bf16 v[136:139], v[76:79], a[48:51], v[136:139]
    s_mov_b32 s49, 50343936
    buffer_load_dword v51, v47, s[24:27], s49 offen sc1
    v_mfma_f32_16x16x32_bf16 v[140:143], v[76:79], a[52:55], v[140:143]
    ds_read_b128 v[76:79], v3 offset:3072
    v_mfma_f32_16x16x32_bf16 v[144:147], v[80:83], a[48:51], v[144:147]
    s_add_u32 m0, s68, 24576
    s_add_u32 s63, s100, 122880
    buffer_load_dwordx4 v253, s[24:27], s63 offen offset:0 sc1 lds
    v_mfma_f32_16x16x32_bf16 v[148:151], v[80:83], a[52:55], v[148:151]
    ds_read_b128 v[80:83], v3 offset:4096
    v_mfma_f32_16x16x32_bf16 v[152:155], v[84:87], a[48:51], v[152:155]
    buffer_load_dwordx4 v253, s[24:27], s63 offen offset:1024 sc1 lds
    v_mfma_f32_16x16x32_bf16 v[156:159], v[84:87], a[52:55], v[156:159]
    ds_read_b128 v[84:87], v3 offset:5120
    s_waitcnt vmcnt(17) lgkmcnt(9)
    v_mfma_f32_16x16x32_bf16 v[112:115], v[88:91], a[56:59], v[112:115]
    v_mfma_f32_16x16x32_bf16 v[116:119], v[88:91], a[60:63], v[116:119]
    ds_read_b128 v[88:91], v3 offset:6144
    v_mfma_f32_16x16x32_bf16 v[120:123], v[92:95], a[56:59], v[120:123]
    buffer_load_dwordx4 a[100:103], v41, s[24:27], s51 offen offset:256 sc1
    v_mfma_f32_16x16x32_bf16 v[124:127], v[92:95], a[60:63], v[124:127]
    ds_read_b128 v[92:95], v3 offset:7168
    v_mfma_f32_16x16x32_bf16 v[128:131], v[96:99], a[56:59], v[128:131]
    v_mfma_f32_16x16x32_bf16 v[132:135], v[96:99], a[60:63], v[132:135]
    ds_read_b128 v[96:99], v3 offset:8192
    s_waitcnt lgkmcnt(9)
    v_mfma_f32_16x16x32_bf16 v[136:139], v[100:103], a[56:59], v[136:139]
    buffer_load_dwordx4 a[104:107], v41, s[24:27], s51 offen offset:2048 sc1
    v_mfma_f32_16x16x32_bf16 v[140:143], v[100:103], a[60:63], v[140:143]
    ds_read_b128 v[100:103], v3 offset:9216
    v_mfma_f32_16x16x32_bf16 v[144:147], v[104:107], a[56:59], v[144:147]
    v_mfma_f32_16x16x32_bf16 v[148:151], v[104:107], a[60:63], v[148:151]
    ds_read_b128 v[104:107], v3 offset:10240
    v_mfma_f32_16x16x32_bf16 v[152:155], v[108:111], a[56:59], v[152:155]
    s_mov_b32 s49, 50360320
    buffer_load_dword v52, v47, s[24:27], s49 offen sc1
    v_mfma_f32_16x16x32_bf16 v[156:159], v[108:111], a[60:63], v[156:159]
    ds_read_b128 v[108:111], v3 offset:11264
    s_cmp_eq_u32 s62, 1
    s_nop 5
    s_cbranch_scc0 L_l1_100
    s_lshr_b32 s48, s40, 1
    s_lshl_b32 s48, s48, 12
    s_add_u32 s48, s48, 98304
    s_lshr_b32 s49, s43, 2
    s_add_u32 s49, s49, 2
    s_lshl_b32 s49, s49, 7
    s_add_u32 s48, s48, s49
    v_mov_b32 v38, s48
    global_load_dword v59, v38, s[22:23] sc1
    s_lshl_b32 s48, s45, 7
    s_add_u32 s48, s48, 131072
    v_mov_b32 v44, s48
    global_load_dword v60, v44, s[22:23] sc1
    s_nop 0
L_l1_100:
    s_waitcnt vmcnt(18) lgkmcnt(9)
    v_mfma_f32_16x16x32_bf16 v[112:115], v[64:67], a[64:67], v[112:115]
    buffer_load_dwordx4 a[108:111], v41, s[24:27], s51 offen offset:2304 sc1
    v_mfma_f32_16x16x32_bf16 v[116:119], v[64:67], a[68:71], v[116:119]
    ds_read_b128 v[64:67], v3 offset:12288
    v_mfma_f32_16x16x32_bf16 v[120:123], v[68:71], a[64:67], v[120:123]
    s_add_u32 s51, s50, 28672
    buffer_load_dwordx4 a[112:115], v41, s[24:27], s51 offen offset:0 sc1
    v_mfma_f32_16x16x32_bf16 v[124:127], v[68:71], a[68:71], v[124:127]
    ds_read_b128 v[68:71], v3 offset:13312
    v_mfma_f32_16x16x32_bf16 v[128:131], v[72:75], a[64:67], v[128:131]
    v_mfma_f32_16x16x32_bf16 v[132:135], v[72:75], a[68:71], v[132:135]
    ds_read_b128 v[72:75], v3 offset:14336
    s_waitcnt lgkmcnt(9)
    v_mfma_f32_16x16x32_bf16 v[136:139], v[76:79], a[64:67], v[136:139]
    s_mov_b32 s49, 50376704
    buffer_load_dword v53, v47, s[24:27], s49 offen sc1
    v_mfma_f32_16x16x32_bf16 v[140:143], v[76:79], a[68:71], v[140:143]
    ds_read_b128 v[76:79], v3 offset:15360
    v_mfma_f32_16x16x32_bf16 v[144:147], v[80:83], a[64:67], v[144:147]
    s_add_u32 m0, s68, 32768
    s_add_u32 s63, s100, 131072
    buffer_load_dwordx4 v253, s[24:27], s63 offen offset:0 sc1 lds
    v_mfma_f32_16x16x32_bf16 v[148:151], v[80:83], a[68:71], v[148:151]
    ds_read_b128 v[80:83], v3 offset:16384
    v_mfma_f32_16x16x32_bf16 v[152:155], v[84:87], a[64:67], v[152:155]
    buffer_load_dwordx4 v253, s[24:27], s63 offen offset:1024 sc1 lds
    v_mfma_f32_16x16x32_bf16 v[156:159], v[84:87], a[68:71], v[156:159]
    ds_read_b128 v[84:87], v3 offset:17408
    s_waitcnt vmcnt(20) lgkmcnt(9)
    v_mfma_f32_16x16x32_bf16 v[112:115], v[88:91], a[72:75], v[112:115]
    v_mfma_f32_16x16x32_bf16 v[116:119], v[88:91], a[76:79], v[116:119]
    ds_read_b128 v[88:91], v3 offset:18432
    v_mfma_f32_16x16x32_bf16 v[120:123], v[92:95], a[72:75], v[120:123]
    buffer_load_dwordx4 a[116:119], v41, s[24:27], s51 offen offset:256 sc1
    v_mfma_f32_16x16x32_bf16 v[124:127], v[92:95], a[76:79], v[124:127]
    ds_read_b128 v[92:95], v3 offset:19456
    v_mfma_f32_16x16x32_bf16 v[128:131], v[96:99], a[72:75], v[128:131]
    v_mfma_f32_16x16x32_bf16 v[132:135], v[96:99], a[76:79], v[132:135]
    ds_read_b128 v[96:99], v3 offset:20480
    s_waitcnt lgkmcnt(9)
    v_mfma_f32_16x16x32_bf16 v[136:139], v[100:103], a[72:75], v[136:139]
    buffer_load_dwordx4 a[120:123], v41, s[24:27], s51 offen offset:2048 sc1
    v_mfma_f32_16x16x32_bf16 v[140:143], v[100:103], a[76:79], v[140:143]
    ds_read_b128 v[100:103], v3 offset:21504
    v_mfma_f32_16x16x32_bf16 v[144:147], v[104:107], a[72:75], v[144:147]
    v_mfma_f32_16x16x32_bf16 v[148:151], v[104:107], a[76:79], v[148:151]
    ds_read_b128 v[104:107], v3 offset:22528
    v_mfma_f32_16x16x32_bf16 v[152:155], v[108:111], a[72:75], v[152:155]
    s_mov_b32 s49, 50393088
    buffer_load_dword v54, v47, s[24:27], s49 offen sc1
    v_mfma_f32_16x16x32_bf16 v[156:159], v[108:111], a[76:79], v[156:159]
    ds_read_b128 v[108:111], v3 offset:23552
    s_barrier
    s_waitcnt vmcnt(18) lgkmcnt(9)
    v_mfma_f32_16x16x32_bf16 v[112:115], v[64:67], a[80:83], v[112:115]
    buffer_load_dwordx4 a[124:127], v41, s[24:27], s51 offen offset:2304 sc1
    v_mfma_f32_16x16x32_bf16 v[116:119], v[64:67], a[84:87], v[116:119]
    ds_read_b128 v[64:67], v4 offset:8192
    v_mfma_f32_16x16x32_bf16 v[120:123], v[68:71], a[80:83], v[120:123]
    s_add_u32 s51, s50, 32768
    buffer_load_dwordx4 a[128:131], v41, s[24:27], s51 offen offset:0 sc1
    v_mfma_f32_16x16x32_bf16 v[124:127], v[68:71], a[84:87], v[124:127]
    ds_read_b128 v[68:71], v4 offset:9216
    v_mfma_f32_16x16x32_bf16 v[128:131], v[72:75], a[80:83], v[128:131]
    v_mfma_f32_16x16x32_bf16 v[132:135], v[72:75], a[84:87], v[132:135]
    ds_read_b128 v[72:75], v4 offset:10240
    s_waitcnt lgkmcnt(9)
    v_mfma_f32_16x16x32_bf16 v[136:139], v[76:79], a[80:83], v[136:139]
    s_mov_b32 s49, 50409472
    buffer_load_dword v55, v47, s[24:27], s49 offen sc1
    v_mfma_f32_16x16x32_bf16 v[140:143], v[76:79], a[84:87], v[140:143]
    ds_read_b128 v[76:79], v4 offset:11264
    v_mfma_f32_16x16x32_bf16 v[144:147], v[80:83], a[80:83], v[144:147]
    s_add_u32 m0, s68, 40960
    s_add_u32 s63, s100, 139264
    buffer_load_dwordx4 v253, s[24:27], s63 offen offset:0 sc1 lds
    v_mfma_f32_16x16x32_bf16 v[148:151], v[80:83], a[84:87], v[148:151]
    ds_read_b128 v[80:83], v4 offset:12288
    v_mfma_f32_16x16x32_bf16 v[152:155], v[84:87], a[80:83], v[152:155]
    buffer_load_dwordx4 v253, s[24:27], s63 offen offset:1024 sc1 lds
    v_mfma_f32_16x16x32_bf16 v[156:159], v[84:87], a[84:87], v[156:159]
    ds_read_b128 v[84:87], v4 offset:13312
    s_waitcnt vmcnt(20) lgkmcnt(9)
    v_mfma_f32_16x16x32_bf16 v[112:115], v[88:91], a[88:91], v[112:115]
    v_mfma_f32_16x16x32_bf16 v[116:119], v[88:91], a[92:95], v[116:119]
    ds_read_b128 v[88:91], v4 offset:14336
    v_mfma_f32_16x16x32_bf16 v[120:123], v[92:95], a[88:91], v[120:123]
    buffer_load_dwordx4 a[132:135], v41, s[24:27], s51 offen offset:256 sc1
    v_mfma_f32_16x16x32_bf16 v[124:127], v[92:95], a[92:95], v[124:127]
    ds_read_b128 v[92:95], v4 offset:15360
    v_mfma_f32_16x16x32_bf16 v[128:131], v[96:99], a[88:91], v[128:131]
    v_mfma_f32_16x16x32_bf16 v[132:135], v[96:99], a[92:95], v[132:135]
    ds_read_b128 v[96:99], v4 offset:16384
    s_waitcnt lgkmcnt(9)
    v_mfma_f32_16x16x32_bf16 v[136:139], v[100:103], a[88:91], v[136:139]
    v_mfma_f32_16x16x32_bf16 v[140:143], v[100:103], a[92:95], v[140:143]
    ds_read_b128 v[100:103], v4 offset:17408
    v_mfma_f32_16x16x32_bf16 v[144:147], v[104:107], a[88:91], v[144:147]
    buffer_load_dwordx4 a[136:139], v41, s[24:27], s51 offen offset:2048 sc1
    v_mfma_f32_16x16x32_bf16 v[148:151], v[104:107], a[92:95], v[148:151]
    ds_read_b128 v[104:107], v4 offset:18432
    v_mfma_f32_16x16x32_bf16 v[152:155], v[108:111], a[88:91], v[152:155]
    v_mfma_f32_16x16x32_bf16 v[156:159], v[108:111], a[92:95], v[156:159]
    ds_read_b128 v[108:111], v4 offset:19456
    s_waitcnt vmcnt(17) lgkmcnt(9)
    v_mfma_f32_16x16x32_bf16 v[112:115], v[64:67], a[96:99], v[112:115]
    buffer_load_dwordx4 a[140:143], v41, s[24:27], s51 offen offset:2304 sc1
    v_mfma_f32_16x16x32_bf16 v[116:119], v[64:67], a[100:103], v[116:119]
    ds_read_b128 v[64:67], v4 offset:20480
    v_mfma_f32_16x16x32_bf16 v[120:123], v[68:71], a[96:99], v[120:123]
    v_mfma_f32_16x16x32_bf16 v[124:127], v[68:71], a[100:103], v[124:127]
    ds_read_b128 v[68:71], v4 offset:21504
    v_mfma_f32_16x16x32_bf16 v[128:131], v[72:75], a[96:99], v[128:131]
    s_add_u32 s51, s50, 36864
    buffer_load_dwordx4 a[144:147], v41, s[24:27], s51 offen offset:0 sc1
    v_mfma_f32_16x16x32_bf16 v[132:135], v[72:75], a[100:103], v[132:135]
    ds_read_b128 v[72:75], v4 offset:22528
    s_waitcnt lgkmcnt(9)
    v_mfma_f32_16x16x32_bf16 v[136:139], v[76:79], a[96:99], v[136:139]
    s_add_u32 m0, s68, 49152
    s_add_u32 s63, s100, 147456
    buffer_load_dwordx4 v253, s[24:27], s63 offen offset:0 sc1 lds
    v_mfma_f32_16x16x32_bf16 v[140:143], v[76:79], a[100:103], v[140:143]
    ds_read_b128 v[76:79], v4 offset:23552
    v_mfma_f32_16x16x32_bf16 v[144:147], v[80:83], a[96:99], v[144:147]
    v_mfma_f32_16x16x32_bf16 v[148:151], v[80:83], a[100:103], v[148:151]
    ds_read_b128 v[80:83], v4 offset:24576
    v_mfma_f32_16x16x32_bf16 v[152:155], v[84:87], a[96:99], v[152:155]
    buffer_load_dwordx4 v253, s[24:27], s63 offen offset:1024 sc1 lds
    v_mfma_f32_16x16x32_bf16 v[156:159], v[84:87], a[100:103], v[156:159]
    ds_read_b128 v[84:87], v4 offset:25600
    s_cmp_eq_u32 s62, 1
    s_nop 5
    s_cbranch_scc0 L_l1_101
    s_waitcnt vmcnt(19)
    v_cmp_le_u32 vcc, 1, v59
    s_nop 1
    s_cmp_eq_u64 vcc, -1
    s_nop 1
    s_cbranch_scc1 L_fd_103
    s_mov_b32 s46, 0x200000
    s_nop 0
L_fl_102:
    global_load_dword v10, v38, s[22:23] sc1
    s_waitcnt vmcnt(0)
    v_cmp_le_u32 vcc, 1, v10
    s_nop 1
    s_cmp_eq_u64 vcc, -1
    s_nop 1
    s_cbranch_scc1 L_fd_103
    s_sub_u32 s46, s46, 1
    s_cmp_lg_u32 s46, 0
    s_nop 0
    s_cbranch_scc1 L_fl_102
    s_nop 0
L_fd_103:
    v_cmp_le_u32 vcc, 16, v60
    s_nop 1
    s_cmp_eq_u64 vcc, -1
    s_nop 1
    s_cbranch_scc1 L_fd_105
    s_mov_b32 s46, 0x200000
    s_nop 0
L_fl_104:
    global_load_dword v10, v44, s[22:23] sc1
    s_waitcnt vmcnt(0)
    v_cmp_le_u32 vcc, 16, v10
    s_nop 1
    s_cmp_eq_u64 vcc, -1
    s_nop 1
    s_cbranch_scc1 L_fd_105
    s_sub_u32 s46, s46, 1
    s_cmp_lg_u32 s46, 0
    s_nop 0
    s_cbranch_scc1 L_fl_104
    s_nop 0
L_fd_105:
L_l1_101:
    s_waitcnt vmcnt(18) lgkmcnt(9)
    v_mfma_f32_16x16x32_bf16 v[112:115], v[88:91], a[104:107], v[112:115]
    v_add_f32 v48, v48, v49
    v_add_f32 v48, v48, v50
    v_mfma_f32_16x16x32_bf16 v[116:119], v[88:91], a[108:111], v[116:119]
    ds_read_b128 v[88:91], v4 offset:26624
    v_add_f32 v48, v48, v51
    v_mfma_f32_16x16x32_bf16 v[120:123], v[92:95], a[104:107], v[120:123]
    buffer_load_dwordx4 a[148:151], v41, s[24:27], s51 offen offset:256 sc1
    v_add_f32 v48, v48, v52
    v_mfma_f32_16x16x32_bf16 v[124:127], v[92:95], a[108:111], v[124:127]
    ds_read_b128 v[92:95], v4 offset:27648
    s_waitcnt vmcnt(17)
    v_add_f32 v48, v48, v53
    v_mfma_f32_16x16x32_bf16 v[128:131], v[96:99], a[104:107], v[128:131]
    s_waitcnt vmcnt(12)
    v_add_f32 v48, v48, v54
    s_waitcnt vmcnt(9)
    v_add_f32 v48, v48, v55
    v_mfma_f32_16x16x32_bf16 v[132:135], v[96:99], a[108:111], v[132:135]
    ds_read_b128 v[96:99], v4 offset:28672
    v_mov_b32 v49, v48
    s_waitcnt lgkmcnt(9)
    v_mfma_f32_16x16x32_bf16 v[136:139], v[100:103], a[104:107], v[136:139]
    v_permlane16_swap_b32 v48, v49
    v_mfma_f32_16x16x32_bf16 v[140:143], v[100:103], a[108:111], v[140:143]
    ds_read_b128 v[100:103], v4 offset:29696
    v_mfma_f32_16x16x32_bf16 v[144:147], v[104:107], a[104:107], v[144:147]
    buffer_load_dwordx4 a[152:155], v41, s[24:27], s51 offen offset:2048 sc1
    v_mfma_f32_16x16x32_bf16 v[148:151], v[104:107], a[108:111], v[148:151]
    ds_read_b128 v[104:107], v4 offset:30720
    v_mfma_f32_16x16x32_bf16 v[152:155], v[108:111], a[104:107], v[152:155]
    v_mfma_f32_16x16x32_bf16 v[156:159], v[108:111], a[108:111], v[156:159]
    ds_read_b128 v[108:111], v4 offset:31744
    s_barrier
    s_waitcnt lgkmcnt(9)
    v_mfma_f32_16x16x32_bf16 v[112:115], v[64:67], a[112:115], v[112:115]
    v_mul_f32 v50, 0.0015625, v48
    v_mul_f32 v55, 0.0015625, v49
    v_fma_f32 v55, -v50, v50, v55
    v_max_f32 v55, 0, v55
    v_add_f32 v55, 1e-05, v55
    v_rsq_f32 v52, v55
    s_nop 0
    v_mul_f32 v52, v52, v52
    v_mfma_f32_16x16x32_bf16 v[116:119], v[64:67], a[116:119], v[116:119]
    ds_read_b128 v[64:67], v2 offset:0
    v_mov_b32 v51, v50
    v_mov_b32 v53, v52
    v_mfma_f32_16x16x32_bf16 v[120:123], v[68:71], a[112:115], v[120:123]
    buffer_load_dwordx4 a[156:159], v41, s[24:27], s51 offen offset:2304 sc1
    v_permlane32_swap_b32 v50, v51
    v_mfma_f32_16x16x32_bf16 v[124:127], v[68:71], a[116:119], v[124:127]
    ds_read_b128 v[68:71], v2 offset:1024
    v_permlane32_swap_b32 v52, v53
    v_mfma_f32_16x16x32_bf16 v[128:131], v[72:75], a[112:115], v[128:131]
    v_cvt_pk_bf16_f32 v45, v50, v50
    v_lshlrev_b32 v45, 16, v45
    v_sub_f32 v46, v50, v45
    v_cvt_pk_bf16_f32 v54, -v45, -v46
    v_cvt_pk_bf16_f32 v55, -v45, 0
    v_cvt_pk_bf16_f32 v45, v51, v51
    v_lshlrev_b32 v45, 16, v45
    v_sub_f32 v46, v51, v45
    v_cvt_pk_bf16_f32 v56, -v45, -v46
    v_cvt_pk_bf16_f32 v57, -v45, 0
    v_mfma_f32_16x16x32_bf16 v[132:135], v[72:75], a[116:119], v[132:135]
    ds_read_b128 v[72:75], v2 offset:2048
    v_lshrrev_b32 v48, 4, v1
    s_waitcnt lgkmcnt(9)
    v_mfma_f32_16x16x32_bf16 v[136:139], v[76:79], a[112:115], v[136:139]
    s_add_u32 m0, s68, 139264
    s_add_u32 s63, s100, 155648
    buffer_load_dwordx4 v253, s[24:27], s63 offen offset:0 sc1 lds
    v_cmp_eq_u32 vcc, 0, v48
    v_mfma_f32_16x16x32_bf16 v[140:143], v[76:79], a[116:119], v[140:143]
    ds_read_b128 v[76:79], v2 offset:3072
    v_mfma_f32_16x16x32_bf16 v[144:147], v[80:83], a[112:115], v[144:147]
    v_mfma_f32_16x16x32_bf16 v[148:151], v[80:83], a[116:119], v[148:151]
    ds_read_b128 v[80:83], v2 offset:4096
    v_mfma_f32_16x16x32_bf16 v[152:155], v[84:87], a[112:115], v[152:155]
    buffer_load_dwordx4 v253, s[24:27], s63 offen offset:1024 sc1 lds
    v_mfma_f32_16x16x32_bf16 v[156:159], v[84:87], a[116:119], v[156:159]
    ds_read_b128 v[84:87], v2 offset:5120
    s_waitcnt lgkmcnt(9)
    v_mfma_f32_16x16x32_bf16 v[112:115], v[88:91], a[120:123], v[112:115]
    v_cndmask_b32 v216, 0, v54, vcc
    v_cndmask_b32 v217, 0, v55, vcc
    v_mfma_f32_16x16x32_bf16 v[116:119], v[88:91], a[124:127], v[116:119]
    ds_read_b128 v[88:91], v2 offset:6144
    v_cndmask_b32 v218, 0, v56, vcc
    v_mfma_f32_16x16x32_bf16 v[120:123], v[92:95], a[120:123], v[120:123]
    s_add_u32 m0, s68, 57344
    s_add_u32 s63, s100, 163840
    buffer_load_dwordx4 v253, s[24:27], s63 offen offset:0 sc1 lds
    v_cndmask_b32 v219, 0, v57, vcc
    v_mfma_f32_16x16x32_bf16 v[124:127], v[92:95], a[124:127], v[124:127]
    ds_read_b128 v[92:95], v2 offset:7168
    v_cmp_eq_u32 vcc, 1, v48
    v_mfma_f32_16x16x32_bf16 v[128:131], v[96:99], a[120:123], v[128:131]
    s_nop 0
    v_cndmask_b32 v220, 0, v54, vcc
    v_cndmask_b32 v221, 0, v55, vcc
    v_mfma_f32_16x16x32_bf16 v[132:135], v[96:99], a[124:127], v[132:135]
    ds_read_b128 v[96:99], v2 offset:8192
    v_cndmask_b32 v222, 0, v56, vcc
    s_waitcnt lgkmcnt(9)
    v_mfma_f32_16x16x32_bf16 v[136:139], v[100:103], a[120:123], v[136:139]
    v_cndmask_b32 v223, 0, v57, vcc
    v_mfma_f32_16x16x32_bf16 v[140:143], v[100:103], a[124:127], v[140:143]
    ds_read_b128 v[100:103], v2 offset:9216
    v_mfma_f32_16x16x32_bf16 v[144:147], v[104:107], a[120:123], v[144:147]
    buffer_load_dwordx4 v253, s[24:27], s63 offen offset:1024 sc1 lds
    v_mfma_f32_16x16x32_bf16 v[148:151], v[104:107], a[124:127], v[148:151]
    ds_read_b128 v[104:107], v2 offset:10240
    v_mfma_f32_16x16x32_bf16 v[152:155], v[108:111], a[120:123], v[152:155]
    v_mfma_f32_16x16x32_bf16 v[156:159], v[108:111], a[124:127], v[156:159]
    ds_read_b128 v[108:111], v2 offset:11264
    s_waitcnt vmcnt(12) lgkmcnt(9)
    v_mfma_f32_16x16x32_bf16 v[112:115], v[64:67], a[128:131], v[112:115]
    v_cmp_eq_u32 vcc, 2, v48
    s_nop 1
    v_cndmask_b32 v224, 0, v54, vcc
    v_mfma_f32_16x16x32_bf16 v[116:119], v[64:67], a[132:135], v[116:119]
    ds_read_b128 v[64:67], v2 offset:12288
    v_cndmask_b32 v225, 0, v55, vcc
    v_mfma_f32_16x16x32_bf16 v[120:123], v[68:71], a[128:131], v[120:123]
    s_add_u32 m0, s68, 65536
    s_add_u32 s63, s100, 172032
    buffer_load_dwordx4 v253, s[24:27], s63 offen offset:0 sc1 lds
    v_cndmask_b32 v226, 0, v56, vcc
    v_mfma_f32_16x16x32_bf16 v[124:127], v[68:71], a[132:135], v[124:127]
    ds_read_b128 v[68:71], v2 offset:13312
    v_cndmask_b32 v227, 0, v57, vcc
    v_mfma_f32_16x16x32_bf16 v[128:131], v[72:75], a[128:131], v[128:131]
    v_cmp_eq_u32 vcc, 3, v48
    s_nop 1
    v_cndmask_b32 v228, 0, v54, vcc
    v_mfma_f32_16x16x32_bf16 v[132:135], v[72:75], a[132:135], v[132:135]
    ds_read_b128 v[72:75], v2 offset:14336
    v_cndmask_b32 v229, 0, v55, vcc
    s_waitcnt lgkmcnt(9)
    v_mfma_f32_16x16x32_bf16 v[136:139], v[76:79], a[128:131], v[136:139]
    v_cndmask_b32 v230, 0, v56, vcc
    v_mfma_f32_16x16x32_bf16 v[140:143], v[76:79], a[132:135], v[140:143]
    ds_read_b128 v[76:79], v2 offset:15360
    v_mfma_f32_16x16x32_bf16 v[144:147], v[80:83], a[128:131], v[144:147]
    buffer_load_dwordx4 v253, s[24:27], s63 offen offset:1024 sc1 lds
    v_mfma_f32_16x16x32_bf16 v[148:151], v[80:83], a[132:135], v[148:151]
    ds_read_b128 v[80:83], v2 offset:16384
    v_mfma_f32_16x16x32_bf16 v[152:155], v[84:87], a[128:131], v[152:155]
    v_mfma_f32_16x16x32_bf16 v[156:159], v[84:87], a[132:135], v[156:159]
    ds_read_b128 v[84:87], v2 offset:17408
    s_waitcnt vmcnt(12) lgkmcnt(9)
    v_mfma_f32_16x16x32_bf16 v[112:115], v[88:91], a[136:139], v[112:115]
    v_cndmask_b32 v231, 0, v57, vcc
    v_mfma_f32_16x16x32_bf16 v[116:119], v[88:91], a[140:143], v[116:119]
    ds_read_b128 v[88:91], v2 offset:18432
    v_mfma_f32_16x16x32_bf16 v[120:123], v[92:95], a[136:139], v[120:123]
    s_add_u32 m0, s68, 73728
    s_add_u32 s63, s100, 180224
    buffer_load_dwordx4 v253, s[24:27], s63 offen offset:0 sc1 lds
    v_mfma_f32_16x16x32_bf16 v[124:127], v[92:95], a[140:143], v[124:127]
    ds_read_b128 v[92:95], v2 offset:19456
    v_mfma_f32_16x16x32_bf16 v[128:131], v[96:99], a[136:139], v[128:131]
    v_mfma_f32_16x16x32_bf16 v[132:135], v[96:99], a[140:143], v[132:135]
    ds_read_b128 v[96:99], v2 offset:20480
    s_waitcnt lgkmcnt(9)
    v_mfma_f32_16x16x32_bf16 v[136:139], v[100:103], a[136:139], v[136:139]
    v_mfma_f32_16x16x32_bf16 v[140:143], v[100:103], a[140:143], v[140:143]
    ds_read_b128 v[100:103], v2 offset:21504
    v_mfma_f32_16x16x32_bf16 v[144:147], v[104:107], a[136:139], v[144:147]
    buffer_load_dwordx4 v253, s[24:27], s63 offen offset:1024 sc1 lds
    v_mfma_f32_16x16x32_bf16 v[148:151], v[104:107], a[140:143], v[148:151]
    ds_read_b128 v[104:107], v2 offset:22528
    v_mfma_f32_16x16x32_bf16 v[152:155], v[108:111], a[136:139], v[152:155]
    v_mfma_f32_16x16x32_bf16 v[156:159], v[108:111], a[140:143], v[156:159]
    ds_read_b128 v[108:111], v2 offset:23552
    s_barrier
    s_waitcnt vmcnt(10) lgkmcnt(9)
    v_mfma_f32_16x16x32_bf16 v[112:115], v[64:67], a[144:147], v[112:115]
    v_mfma_f32_16x16x32_bf16 v[116:119], v[64:67], a[148:151], v[116:119]
    ds_read_b128 v[64:67], v2 offset:24576
    v_mfma_f32_16x16x32_bf16 v[120:123], v[68:71], a[144:147], v[120:123]
    v_mfma_f32_16x16x32_bf16 v[124:127], v[68:71], a[148:151], v[124:127]
    ds_read_b128 v[68:71], v2 offset:25600
    v_mfma_f32_16x16x32_bf16 v[128:131], v[72:75], a[144:147], v[128:131]
    s_add_u32 m0, s68, 147456
    s_add_u32 s63, s100, 188416
    buffer_load_dwordx4 v253, s[24:27], s63 offen offset:0 sc1 lds
    v_mfma_f32_16x16x32_bf16 v[132:135], v[72:75], a[148:151], v[132:135]
    ds_read_b128 v[72:75], v2 offset:26624
    s_waitcnt lgkmcnt(9)
    v_mfma_f32_16x16x32_bf16 v[136:139], v[76:79], a[144:147], v[136:139]
    v_mfma_f32_16x16x32_bf16 v[140:143], v[76:79], a[148:151], v[140:143]
    ds_read_b128 v[76:79], v2 offset:27648
    v_mfma_f32_16x16x32_bf16 v[144:147], v[80:83], a[144:147], v[144:147]
    v_mfma_f32_16x16x32_bf16 v[148:151], v[80:83], a[148:151], v[148:151]
    ds_read_b128 v[80:83], v2 offset:28672
    v_mfma_f32_16x16x32_bf16 v[152:155], v[84:87], a[144:147], v[152:155]
    v_mfma_f32_16x16x32_bf16 v[156:159], v[84:87], a[148:151], v[156:159]
    ds_read_b128 v[84:87], v2 offset:29696
    v_mfma_f32_16x16x16bf16_1k v[160:163], a[234:235], v[224:225], 0
    v_mfma_f32_16x16x16bf16_1k v[164:167], a[234:235], v[226:227], 0
    v_mfma_f32_16x16x16bf16_1k v[168:171], a[234:235], v[228:229], 0
    v_mfma_f32_16x16x16bf16_1k v[172:175], a[234:235], v[230:231], 0
    buffer_load_dwordx4 v253, s[24:27], s63 offen offset:1024 sc1 lds
    v_mfma_f32_16x16x16bf16_1k v[176:179], a[236:237], v[216:217], 0
    v_mfma_f32_16x16x16bf16_1k v[180:183], a[236:237], v[218:219], 0
    v_mfma_f32_16x16x16bf16_1k v[184:187], a[236:237], v[220:221], 0
    v_mfma_f32_16x16x16bf16_1k v[188:191], a[236:237], v[222:223], 0
    s_waitcnt vmcnt(10) lgkmcnt(9)
    v_mfma_f32_16x16x32_bf16 v[112:115], v[88:91], a[152:155], v[112:115]
    v_mfma_f32_16x16x32_bf16 v[116:119], v[88:91], a[156:159], v[116:119]
    ds_read_b128 v[88:91], v2 offset:30720
    v_mfma_f32_16x16x32_bf16 v[120:123], v[92:95], a[152:155], v[120:123]
    v_mfma_f32_16x16x32_bf16 v[124:127], v[92:95], a[156:159], v[124:127]
    ds_read_b128 v[92:95], v2 offset:31744
    v_mfma_f32_16x16x32_bf16 v[128:131], v[96:99], a[152:155], v[128:131]
    v_mfma_f32_16x16x32_bf16 v[132:135], v[96:99], a[156:159], v[132:135]
    ds_read_b128 v[96:99], v2 offset:32768
    s_waitcnt lgkmcnt(9)
    v_mfma_f32_16x16x32_bf16 v[136:139], v[100:103], a[152:155], v[136:139]
    s_add_u32 m0, s68, 155648
    s_add_u32 s63, s100, 196608
    buffer_load_dwordx4 v253, s[24:27], s63 offen offset:0 sc1 lds
    v_mfma_f32_16x16x32_bf16 v[140:143], v[100:103], a[156:159], v[140:143]
    ds_read_b128 v[100:103], v2 offset:33792
    v_mfma_f32_16x16x32_bf16 v[144:147], v[104:107], a[152:155], v[144:147]
    v_mfma_f32_16x16x32_bf16 v[148:151], v[104:107], a[156:159], v[148:151]
    ds_read_b128 v[104:107], v2 offset:34816
    v_mfma_f32_16x16x32_bf16 v[152:155], v[108:111], a[152:155], v[152:155]
    v_mfma_f32_16x16x32_bf16 v[156:159], v[108:111], a[156:159], v[156:159]
    ds_read_b128 v[108:111], v2 offset:35840
    v_mfma_f32_16x16x16bf16_1k v[112:115], a[232:233], v[216:217], v[112:115]
    v_mfma_f32_16x16x16bf16_1k v[116:119], a[232:233], v[218:219], v[116:119]
    v_mfma_f32_16x16x16bf16_1k v[120:123], a[232:233], v[220:221], v[120:123]
    v_mfma_f32_16x16x16bf16_1k v[124:127], a[232:233], v[222:223], v[124:127]
    v_mfma_f32_16x16x16bf16_1k v[128:131], a[232:233], v[224:225], v[128:131]
    v_mfma_f32_16x16x16bf16_1k v[132:135], a[232:233], v[226:227], v[132:135]
    v_mfma_f32_16x16x16bf16_1k v[136:139], a[232:233], v[228:229], v[136:139]
    buffer_load_dwordx4 v253, s[24:27], s63 offen offset:1024 sc1 lds
    v_mfma_f32_16x16x16bf16_1k v[140:143], a[232:233], v[230:231], v[140:143]
    v_mfma_f32_16x16x16bf16_1k v[144:147], a[234:235], v[216:217], v[144:147]
    v_mfma_f32_16x16x16bf16_1k v[148:151], a[234:235], v[218:219], v[148:151]
    v_mfma_f32_16x16x16bf16_1k v[152:155], a[234:235], v[220:221], v[152:155]
    v_mfma_f32_16x16x16bf16_1k v[156:159], a[234:235], v[222:223], v[156:159]
    s_waitcnt lgkmcnt(8)
    v_mfma_f32_16x16x32_bf16 v[160:163], v[64:67], a[0:3], v[160:163]
    v_mfma_f32_16x16x32_bf16 v[164:167], v[64:67], a[4:7], v[164:167]
    ds_read_b128 v[64:67], v2 offset:36864
    v_mfma_f32_16x16x32_bf16 v[168:171], v[68:71], a[0:3], v[168:171]
    s_add_u32 m0, s68, 0
    s_add_u32 s63, s100, 204800
    buffer_load_dwordx4 v253, s[24:27], s63 offen offset:0 sc1 lds
    v_mfma_f32_16x16x32_bf16 v[172:175], v[68:71], a[4:7], v[172:175]
    ds_read_b128 v[68:71], v2 offset:37888
    v_max_f32 v112, 0, v112
    v_mfma_f32_16x16x32_bf16 v[176:179], v[72:75], a[0:3], v[176:179]
    v_mul_f32 v120, v120, v52
    v_mfma_f32_16x16x32_bf16 v[180:183], v[72:75], a[4:7], v[180:183]
    ds_read_b128 v[72:75], v2 offset:38912
    v_mfma_f32_16x16x32_bf16 v[184:187], v[76:79], a[0:3], v[184:187]
    buffer_load_dwordx4 v253, s[24:27], s63 offen offset:1024 sc1 lds
    v_mfma_f32_16x16x32_bf16 v[188:191], v[76:79], a[4:7], v[188:191]
    ds_read_b128 v[76:79], v2 offset:39936
    s_waitcnt lgkmcnt(8)
    v_mfma_f32_16x16x32_bf16 v[160:163], v[80:83], a[8:11], v[160:163]
    v_mul_f32 v112, v112, v120
    v_max_f32 v113, 0, v113
    v_mfma_f32_16x16x32_bf16 v[164:167], v[80:83], a[12:15], v[164:167]
    ds_read_b128 v[80:83], v2 offset:40960
    v_mul_f32 v121, v121, v52
    v_mfma_f32_16x16x32_bf16 v[168:171], v[84:87], a[8:11], v[168:171]
    s_add_u32 m0, s68, 81920
    s_add_u32 s63, s100, 212992
    buffer_load_dwordx4 v253, s[24:27], s63 offen offset:0 sc1 lds
    v_mul_f32 v113, v113, v121
    v_mfma_f32_16x16x32_bf16 v[172:175], v[84:87], a[12:15], v[172:175]
    ds_read_b128 v[84:87], v2 offset:41984
    v_max_f32 v114, 0, v114
    v_mfma_f32_16x16x32_bf16 v[176:179], v[88:91], a[8:11], v[176:179]
    v_mul_f32 v122, v122, v52
    v_mfma_f32_16x16x32_bf16 v[180:183], v[88:91], a[12:15], v[180:183]
    ds_read_b128 v[88:91], v2 offset:43008
    v_mfma_f32_16x16x32_bf16 v[184:187], v[92:95], a[8:11], v[184:187]
    buffer_load_dwordx4 v253, s[24:27], s63 offen offset:1024 sc1 lds
    v_mfma_f32_16x16x32_bf16 v[188:191], v[92:95], a[12:15], v[188:191]
    ds_read_b128 v[92:95], v2 offset:44032
    s_waitcnt vmcnt(14)
    s_barrier
    s_waitcnt lgkmcnt(8)
    v_mfma_f32_16x16x32_bf16 v[160:163], v[96:99], a[16:19], v[160:163]
    v_mul_f32 v114, v114, v122
    v_max_f32 v115, 0, v115
    v_mfma_f32_16x16x32_bf16 v[164:167], v[96:99], a[20:23], v[164:167]
    ds_read_b128 v[96:99], v2 offset:45056
    v_mul_f32 v123, v123, v52
    v_mfma_f32_16x16x32_bf16 v[168:171], v[100:103], a[16:19], v[168:171]
    s_add_u32 m0, s68, 8192
    s_add_u32 s63, s100, 221184
    buffer_load_dwordx4 v253, s[24:27], s63 offen offset:0 sc1 lds
    v_mul_f32 v115, v115, v123
    v_mfma_f32_16x16x32_bf16 v[172:175], v[100:103], a[20:23], v[172:175]
    ds_read_b128 v[100:103], v2 offset:46080
    v_cvt_pk_bf16_f32 v208, v112, v113
    v_mfma_f32_16x16x32_bf16 v[176:179], v[104:107], a[16:19], v[176:179]
    v_cvt_pk_bf16_f32 v209, v114, v115
    v_mfma_f32_16x16x32_bf16 v[180:183], v[104:107], a[20:23], v[180:183]
    ds_read_b128 v[104:107], v2 offset:47104
    v_mfma_f32_16x16x32_bf16 v[184:187], v[108:111], a[16:19], v[184:187]
    buffer_load_dwordx4 v253, s[24:27], s63 offen offset:1024 sc1 lds
    v_mfma_f32_16x16x32_bf16 v[188:191], v[108:111], a[20:23], v[188:191]
    ds_read_b128 v[108:111], v2 offset:48128
    s_waitcnt lgkmcnt(8)
    v_mfma_f32_16x16x32_bf16 v[160:163], v[64:67], a[24:27], v[160:163]
    v_max_f32 v116, 0, v116
    v_mul_f32 v124, v124, v53
    v_mfma_f32_16x16x32_bf16 v[164:167], v[64:67], a[28:31], v[164:167]
    ds_read_b128 v[64:67], v2 offset:49152
    v_mul_f32 v116, v116, v124
    v_mfma_f32_16x16x32_bf16 v[168:171], v[68:71], a[24:27], v[168:171]
    s_add_u32 m0, s68, 16384
    s_add_u32 s63, s100, 229376
    buffer_load_dwordx4 v253, s[24:27], s63 offen offset:0 sc1 lds
    v_max_f32 v117, 0, v117
    v_mfma_f32_16x16x32_bf16 v[172:175], v[68:71], a[28:31], v[172:175]
    ds_read_b128 v[68:71], v2 offset:50176
    v_mul_f32 v125, v125, v53
    v_mfma_f32_16x16x32_bf16 v[176:179], v[72:75], a[24:27], v[176:179]
    v_mul_f32 v117, v117, v125
    v_mfma_f32_16x16x32_bf16 v[180:183], v[72:75], a[28:31], v[180:183]
    ds_read_b128 v[72:75], v2 offset:51200
    v_mfma_f32_16x16x32_bf16 v[184:187], v[76:79], a[24:27], v[184:187]
    buffer_load_dwordx4 v253, s[24:27], s63 offen offset:1024 sc1 lds
    v_mfma_f32_16x16x32_bf16 v[188:191], v[76:79], a[28:31], v[188:191]
    ds_read_b128 v[76:79], v2 offset:52224
    s_waitcnt lgkmcnt(8)
    v_mfma_f32_16x16x32_bf16 v[160:163], v[80:83], a[32:35], v[160:163]
    v_max_f32 v118, 0, v118
    v_mul_f32 v126, v126, v53
    v_mfma_f32_16x16x32_bf16 v[164:167], v[80:83], a[36:39], v[164:167]
    ds_read_b128 v[80:83], v2 offset:53248
    v_mul_f32 v118, v118, v126
    v_mfma_f32_16x16x32_bf16 v[168:171], v[84:87], a[32:35], v[168:171]
    s_add_u32 m0, s68, 24576
    s_add_u32 s63, s100, 237568
    buffer_load_dwordx4 v253, s[24:27], s63 offen offset:0 sc1 lds
    v_max_f32 v119, 0, v119
    v_mfma_f32_16x16x32_bf16 v[172:175], v[84:87], a[36:39], v[172:175]
    ds_read_b128 v[84:87], v2 offset:54272
    v_mul_f32 v127, v127, v53
    v_mfma_f32_16x16x32_bf16 v[176:179], v[88:91], a[32:35], v[176:179]
    v_mul_f32 v119, v119, v127
    v_mfma_f32_16x16x32_bf16 v[180:183], v[88:91], a[36:39], v[180:183]
    ds_read_b128 v[88:91], v2 offset:55296
    v_mfma_f32_16x16x32_bf16 v[184:187], v[92:95], a[32:35], v[184:187]
    buffer_load_dwordx4 v253, s[24:27], s63 offen offset:1024 sc1 lds
    v_mfma_f32_16x16x32_bf16 v[188:191], v[92:95], a[36:39], v[188:191]
    ds_read_b128 v[92:95], v2 offset:56320
    s_waitcnt lgkmcnt(8)
    v_mfma_f32_16x16x32_bf16 v[160:163], v[96:99], a[40:43], v[160:163]
    v_cvt_pk_bf16_f32 v210, v116, v117
    v_cvt_pk_bf16_f32 v211, v118, v119
    v_mfma_f32_16x16x32_bf16 v[164:167], v[96:99], a[44:47], v[164:167]
    ds_read_b128 v[96:99], v4 offset:8192
    v_mfma_f32_16x16x32_bf16 v[168:171], v[100:103], a[40:43], v[168:171]
    v_permlane32_swap_b32 v208, v210
    v_permlane32_swap_b32 v209, v211
    v_mfma_f32_16x16x32_bf16 v[172:175], v[100:103], a[44:47], v[172:175]
    ds_read_b128 v[100:103], v4 offset:9216
    buffer_store_dwordx4 v[208:211], v39, s[24:27], s53 offen offset:0 sc1
    v_mfma_f32_16x16x32_bf16 v[176:179], v[104:107], a[40:43], v[176:179]
    v_mfma_f32_16x16x32_bf16 v[180:183], v[104:107], a[44:47], v[180:183]
    ds_read_b128 v[104:107], v4 offset:10240
    v_mfma_f32_16x16x32_bf16 v[184:187], v[108:111], a[40:43], v[184:187]
    v_mfma_f32_16x16x32_bf16 v[188:191], v[108:111], a[44:47], v[188:191]
    ds_read_b128 v[108:111], v4 offset:11264
    s_waitcnt lgkmcnt(8)
    v_mfma_f32_16x16x32_bf16 v[160:163], v[64:67], a[48:51], v[160:163]
    v_max_f32 v128, 0, v128
    v_mul_f32 v136, v136, v52
    v_mfma_f32_16x16x32_bf16 v[164:167], v[64:67], a[52:55], v[164:167]
    ds_read_b128 v[64:67], v4 offset:12288
    v_mul_f32 v128, v128, v136
    v_mfma_f32_16x16x32_bf16 v[168:171], v[68:71], a[48:51], v[168:171]
    s_add_u32 m0, s68, 90112
    s_add_u32 s63, s100, 245760
    buffer_load_dwordx4 v253, s[24:27], s63 offen offset:0 sc1 lds
    v_max_f32 v129, 0, v129
    v_mfma_f32_16x16x32_bf16 v[172:175], v[68:71], a[52:55], v[172:175]
    ds_read_b128 v[68:71], v4 offset:13312
    v_mul_f32 v137, v137, v52
    v_mfma_f32_16x16x32_bf16 v[176:179], v[72:75], a[48:51], v[176:179]
    v_mul_f32 v129, v129, v137
    v_mfma_f32_16x16x32_bf16 v[180:183], v[72:75], a[52:55], v[180:183]
    ds_read_b128 v[72:75], v4 offset:14336
    v_mfma_f32_16x16x32_bf16 v[184:187], v[76:79], a[48:51], v[184:187]
    buffer_load_dwordx4 v253, s[24:27], s63 offen offset:1024 sc1 lds
    v_mfma_f32_16x16x32_bf16 v[188:191], v[76:79], a[52:55], v[188:191]
    ds_read_b128 v[76:79], v4 offset:15360
    s_waitcnt vmcnt(17)
    s_barrier
    s_waitcnt lgkmcnt(8)
    v_mfma_f32_16x16x32_bf16 v[160:163], v[80:83], a[56:59], v[160:163]
    v_max_f32 v130, 0, v130
    v_mul_f32 v138, v138, v52
    v_mfma_f32_16x16x32_bf16 v[164:167], v[80:83], a[60:63], v[164:167]
    ds_read_b128 v[80:83], v2 offset:57344
    v_mul_f32 v130, v130, v138
    v_mfma_f32_16x16x32_bf16 v[168:171], v[84:87], a[56:59], v[168:171]
    s_add_u32 m0, s68, 32768
    s_add_u32 s63, s100, 253952
    buffer_load_dwordx4 v253, s[24:27], s63 offen offset:0 sc1 lds
    v_max_f32 v131, 0, v131
    v_mfma_f32_16x16x32_bf16 v[172:175], v[84:87], a[60:63], v[172:175]
    ds_read_b128 v[84:87], v2 offset:58368
    v_mul_f32 v139, v139, v52
    v_mfma_f32_16x16x32_bf16 v[176:179], v[88:91], a[56:59], v[176:179]
    v_mul_f32 v131, v131, v139
    v_mfma_f32_16x16x32_bf16 v[180:183], v[88:91], a[60:63], v[180:183]
    ds_read_b128 v[88:91], v2 offset:59392
    v_mfma_f32_16x16x32_bf16 v[184:187], v[92:95], a[56:59], v[184:187]
    buffer_load_dwordx4 v253, s[24:27], s63 offen offset:1024 sc1 lds
    v_mfma_f32_16x16x32_bf16 v[188:191], v[92:95], a[60:63], v[188:191]
    ds_read_b128 v[92:95], v2 offset:60416
    s_waitcnt lgkmcnt(8)
    v_mfma_f32_16x16x32_bf16 v[160:163], v[96:99], a[64:67], v[160:163]
    v_cvt_pk_bf16_f32 v212, v128, v129
    v_cvt_pk_bf16_f32 v213, v130, v131
    v_mfma_f32_16x16x32_bf16 v[164:167], v[96:99], a[68:71], v[164:167]
    ds_read_b128 v[96:99], v2 offset:61440
    v_max_f32 v132, 0, v132
    v_mfma_f32_16x16x32_bf16 v[168:171], v[100:103], a[64:67], v[168:171]
    s_add_u32 m0, s68, 40960
    s_add_u32 s63, s100, 262144
    buffer_load_dwordx4 v253, s[24:27], s63 offen offset:0 sc1 lds
    v_mul_f32 v140, v140, v53
    v_mfma_f32_16x16x32_bf16 v[172:175], v[100:103], a[68:71], v[172:175]
    ds_read_b128 v[100:103], v2 offset:62464
    v_mul_f32 v132, v132, v140
    v_mfma_f32_16x16x32_bf16 v[176:179], v[104:107], a[64:67], v[176:179]
    v_max_f32 v133, 0, v133
    v_mfma_f32_16x16x32_bf16 v[180:183], v[104:107], a[68:71], v[180:183]
    ds_read_b128 v[104:107], v2 offset:63488
    v_mfma_f32_16x16x32_bf16 v[184:187], v[108:111], a[64:67], v[184:187]
    buffer_load_dwordx4 v253, s[24:27], s63 offen offset:1024 sc1 lds
    v_mfma_f32_16x16x32_bf16 v[188:191], v[108:111], a[68:71], v[188:191]
    ds_read_b128 v[108:111], v2 offset:64512
    s_waitcnt lgkmcnt(8)
    v_mfma_f32_16x16x32_bf16 v[160:163], v[64:67], a[72:75], v[160:163]
    v_mul_f32 v141, v141, v53
    v_mul_f32 v133, v133, v141
    v_mfma_f32_16x16x32_bf16 v[164:167], v[64:67], a[76:79], v[164:167]
    ds_read_b128 v[64:67], v3 offset:0
    v_max_f32 v134, 0, v134
    v_mfma_f32_16x16x32_bf16 v[168:171], v[68:71], a[72:75], v[168:171]
    s_add_u32 m0, s68, 98304
    s_add_u32 s63, s100, 270336
    buffer_load_dwordx4 v253, s[24:27], s63 offen offset:0 sc1 lds
    v_mul_f32 v142, v142, v53
    v_mfma_f32_16x16x32_bf16 v[172:175], v[68:71], a[76:79], v[172:175]
    ds_read_b128 v[68:71], v3 offset:1024
    v_mul_f32 v134, v134, v142
    v_mfma_f32_16x16x32_bf16 v[176:179], v[72:75], a[72:75], v[176:179]
    v_max_f32 v135, 0, v135
    v_mfma_f32_16x16x32_bf16 v[180:183], v[72:75], a[76:79], v[180:183]
    ds_read_b128 v[72:75], v3 offset:2048
    v_mfma_f32_16x16x32_bf16 v[184:187], v[76:79], a[72:75], v[184:187]
    buffer_load_dwordx4 v253, s[24:27], s63 offen offset:1024 sc1 lds
    v_mfma_f32_16x16x32_bf16 v[188:191], v[76:79], a[76:79], v[188:191]
    ds_read_b128 v[76:79], v3 offset:3072
    s_waitcnt lgkmcnt(8)
    v_mfma_f32_16x16x32_bf16 v[160:163], v[80:83], a[80:83], v[160:163]
    v_mul_f32 v143, v143, v53
    v_mul_f32 v135, v135, v143
    v_mfma_f32_16x16x32_bf16 v[164:167], v[80:83], a[84:87], v[164:167]
    ds_read_b128 v[80:83], v3 offset:4096
    v_cvt_pk_bf16_f32 v214, v132, v133
    v_mfma_f32_16x16x32_bf16 v[168:171], v[84:87], a[80:83], v[168:171]
    s_add_u32 m0, s68, 106496
    s_add_u32 s63, s100, 278528
    buffer_load_dwordx4 v253, s[24:27], s63 offen offset:0 sc1 lds
    v_cvt_pk_bf16_f32 v215, v134, v135
    v_mfma_f32_16x16x32_bf16 v[172:175], v[84:87], a[84:87], v[172:175]
    ds_read_b128 v[84:87], v3 offset:5120
    v_mfma_f32_16x16x32_bf16 v[176:179], v[88:91], a[80:83], v[176:179]
    v_permlane32_swap_b32 v212, v214
    v_mfma_f32_16x16x32_bf16 v[180:183], v[88:91], a[84:87], v[180:183]
    ds_read_b128 v[88:91], v3 offset:6144
    v_mfma_f32_16x16x32_bf16 v[184:187], v[92:95], a[80:83], v[184:187]
    buffer_load_dwordx4 v253, s[24:27], s63 offen offset:1024 sc1 lds
    v_mfma_f32_16x16x32_bf16 v[188:191], v[92:95], a[84:87], v[188:191]
    ds_read_b128 v[92:95], v3 offset:7168
    s_waitcnt lgkmcnt(8)
    v_mfma_f32_16x16x32_bf16 v[160:163], v[96:99], a[88:91], v[160:163]
    v_permlane32_swap_b32 v213, v215
    buffer_store_dwordx4 v[212:215], v39, s[24:27], s53 offen offset:1024 sc1
    v_mfma_f32_16x16x32_bf16 v[164:167], v[96:99], a[92:95], v[164:167]
    ds_read_b128 v[96:99], v3 offset:8192
    v_max_f32 v144, 0, v144
    v_mfma_f32_16x16x32_bf16 v[168:171], v[100:103], a[88:91], v[168:171]
    v_mul_f32 v152, v152, v52
    v_mul_f32 v144, v144, v152
    v_mfma_f32_16x16x32_bf16 v[172:175], v[100:103], a[92:95], v[172:175]
    ds_read_b128 v[100:103], v3 offset:9216
    v_max_f32 v145, 0, v145
    v_mfma_f32_16x16x32_bf16 v[176:179], v[104:107], a[88:91], v[176:179]
    v_mfma_f32_16x16x32_bf16 v[180:183], v[104:107], a[92:95], v[180:183]
    ds_read_b128 v[104:107], v3 offset:10240
    v_mfma_f32_16x16x32_bf16 v[184:187], v[108:111], a[88:91], v[184:187]
    v_mfma_f32_16x16x32_bf16 v[188:191], v[108:111], a[92:95], v[188:191]
    ds_read_b128 v[108:111], v3 offset:11264
    s_waitcnt vmcnt(22)
    s_barrier
    s_waitcnt lgkmcnt(8)
    v_mfma_f32_16x16x32_bf16 v[160:163], v[64:67], a[96:99], v[160:163]
    v_mul_f32 v153, v153, v52
    v_mul_f32 v145, v145, v153
    v_mfma_f32_16x16x32_bf16 v[164:167], v[64:67], a[100:103], v[164:167]
    ds_read_b128 v[64:67], v3 offset:12288
    v_max_f32 v146, 0, v146
    v_mfma_f32_16x16x32_bf16 v[168:171], v[68:71], a[96:99], v[168:171]
    s_add_u32 m0, s68, 139264
    s_add_u32 s63, s101, 0
    buffer_load_dwordx4 v253, s[24:27], s63 offen offset:0 sc1 lds
    v_mul_f32 v154, v154, v52
    v_mfma_f32_16x16x32_bf16 v[172:175], v[68:71], a[100:103], v[172:175]
    ds_read_b128 v[68:71], v3 offset:13312
    v_mul_f32 v146, v146, v154
    v_mfma_f32_16x16x32_bf16 v[176:179], v[72:75], a[96:99], v[176:179]
    v_max_f32 v147, 0, v147
    v_mfma_f32_16x16x32_bf16 v[180:183], v[72:75], a[100:103], v[180:183]
    ds_read_b128 v[72:75], v3 offset:14336
    v_mfma_f32_16x16x32_bf16 v[184:187], v[76:79], a[96:99], v[184:187]
    buffer_load_dwordx4 v253, s[24:27], s63 offen offset:1024 sc1 lds
    v_mfma_f32_16x16x32_bf16 v[188:191], v[76:79], a[100:103], v[188:191]
    ds_read_b128 v[76:79], v3 offset:15360
    s_waitcnt lgkmcnt(8)
    v_mfma_f32_16x16x32_bf16 v[160:163], v[80:83], a[104:107], v[160:163]
    v_mul_f32 v155, v155, v52
    v_mul_f32 v147, v147, v155
    v_mfma_f32_16x16x32_bf16 v[164:167], v[80:83], a[108:111], v[164:167]
    ds_read_b128 v[80:83], v4 offset:16384
    v_cvt_pk_bf16_f32 v208, v144, v145
    v_mfma_f32_16x16x32_bf16 v[168:171], v[84:87], a[104:107], v[168:171]
    s_add_u32 m0, s68, 49152
    s_add_u32 s63, s101, 8192
    buffer_load_dwordx4 v253, s[24:27], s63 offen offset:0 sc1 lds
    v_cvt_pk_bf16_f32 v209, v146, v147
    v_mfma_f32_16x16x32_bf16 v[172:175], v[84:87], a[108:111], v[172:175]
    ds_read_b128 v[84:87], v4 offset:17408
    v_max_f32 v148, 0, v148
    v_mfma_f32_16x16x32_bf16 v[176:179], v[88:91], a[104:107], v[176:179]
    v_mul_f32 v156, v156, v53
    v_mfma_f32_16x16x32_bf16 v[180:183], v[88:91], a[108:111], v[180:183]
    ds_read_b128 v[88:91], v4 offset:18432
    v_mfma_f32_16x16x32_bf16 v[184:187], v[92:95], a[104:107], v[184:187]
    buffer_load_dwordx4 v253, s[24:27], s63 offen offset:1024 sc1 lds
    v_mfma_f32_16x16x32_bf16 v[188:191], v[92:95], a[108:111], v[188:191]
    ds_read_b128 v[92:95], v4 offset:19456
    s_waitcnt lgkmcnt(8)
    v_mfma_f32_16x16x32_bf16 v[160:163], v[96:99], a[112:115], v[160:163]
    v_mul_f32 v148, v148, v156
    v_max_f32 v149, 0, v149
    v_mfma_f32_16x16x32_bf16 v[164:167], v[96:99], a[116:119], v[164:167]
    ds_read_b128 v[96:99], v4 offset:20480
    v_mul_f32 v157, v157, v53
    v_mfma_f32_16x16x32_bf16 v[168:171], v[100:103], a[112:115], v[168:171]
    s_add_u32 m0, s68, 57344
    s_add_u32 s63, s101, 16384
    buffer_load_dwordx4 v253, s[24:27], s63 offen offset:0 sc1 lds
    v_mul_f32 v149, v149, v157
    v_mfma_f32_16x16x32_bf16 v[172:175], v[100:103], a[116:119], v[172:175]
    ds_read_b128 v[100:103], v4 offset:21504
    v_max_f32 v150, 0, v150
    v_mfma_f32_16x16x32_bf16 v[176:179], v[104:107], a[112:115], v[176:179]
    v_mul_f32 v158, v158, v53
    v_mfma_f32_16x16x32_bf16 v[180:183], v[104:107], a[116:119], v[180:183]
    ds_read_b128 v[104:107], v4 offset:22528
    v_mfma_f32_16x16x32_bf16 v[184:187], v[108:111], a[112:115], v[184:187]
    buffer_load_dwordx4 v253, s[24:27], s63 offen offset:1024 sc1 lds
    v_mfma_f32_16x16x32_bf16 v[188:191], v[108:111], a[116:119], v[188:191]
    ds_read_b128 v[108:111], v4 offset:23552
    s_waitcnt lgkmcnt(8)
    v_mfma_f32_16x16x32_bf16 v[160:163], v[64:67], a[120:123], v[160:163]
    v_mul_f32 v150, v150, v158
    v_max_f32 v151, 0, v151
    v_mfma_f32_16x16x32_bf16 v[164:167], v[64:67], a[124:127], v[164:167]
    ds_read_b128 v[64:67], v4 offset:24576
    v_mul_f32 v159, v159, v53
    v_mfma_f32_16x16x32_bf16 v[168:171], v[68:71], a[120:123], v[168:171]
    s_add_u32 m0, s68, 114688
    s_add_u32 s63, s101, 24576
    buffer_load_dwordx4 v253, s[24:27], s63 offen offset:0 sc1 lds
    v_mul_f32 v151, v151, v159
    v_mfma_f32_16x16x32_bf16 v[172:175], v[68:71], a[124:127], v[172:175]
    ds_read_b128 v[68:71], v4 offset:25600
    v_cvt_pk_bf16_f32 v210, v148, v149
    v_mfma_f32_16x16x32_bf16 v[176:179], v[72:75], a[120:123], v[176:179]
    v_cvt_pk_bf16_f32 v211, v150, v151
    v_mfma_f32_16x16x32_bf16 v[180:183], v[72:75], a[124:127], v[180:183]
    ds_read_b128 v[72:75], v4 offset:26624
    v_mfma_f32_16x16x32_bf16 v[184:187], v[76:79], a[120:123], v[184:187]
    buffer_load_dwordx4 v253, s[24:27], s63 offen offset:1024 sc1 lds
    v_mfma_f32_16x16x32_bf16 v[188:191], v[76:79], a[124:127], v[188:191]
    ds_read_b128 v[76:79], v4 offset:27648
    s_waitcnt lgkmcnt(8)
    v_mfma_f32_16x16x32_bf16 v[160:163], v[80:83], a[128:131], v[160:163]
    v_permlane32_swap_b32 v208, v210
    v_mfma_f32_16x16x32_bf16 v[164:167], v[80:83], a[132:135], v[164:167]
    ds_read_b128 v[80:83], v4 offset:28672
    v_permlane32_swap_b32 v209, v211
    v_mfma_f32_16x16x32_bf16 v[168:171], v[84:87], a[128:131], v[168:171]
    s_add_u32 m0, s68, 122880
    s_add_u32 s63, s101, 32768
    buffer_load_dwordx4 v253, s[24:27], s63 offen offset:0 sc1 lds
    buffer_store_dwordx4 v[208:211], v39, s[24:27], s53 offen offset:2048 sc1
    v_mfma_f32_16x16x32_bf16 v[172:175], v[84:87], a[132:135], v[172:175]
    ds_read_b128 v[84:87], v4 offset:29696
    v_mfma_f32_16x16x32_bf16 v[176:179], v[88:91], a[128:131], v[176:179]
    v_mfma_f32_16x16x32_bf16 v[180:183], v[88:91], a[132:135], v[180:183]
    ds_read_b128 v[88:91], v4 offset:30720
    v_mfma_f32_16x16x32_bf16 v[184:187], v[92:95], a[128:131], v[184:187]
    buffer_load_dwordx4 v253, s[24:27], s63 offen offset:1024 sc1 lds
    v_mfma_f32_16x16x32_bf16 v[188:191], v[92:95], a[132:135], v[188:191]
    ds_read_b128 v[92:95], v4 offset:31744
    s_waitcnt vmcnt(27)
    s_barrier
    s_waitcnt lgkmcnt(8)
    v_mfma_f32_16x16x32_bf16 v[160:163], v[96:99], a[136:139], v[160:163]
    v_mfma_f32_16x16x32_bf16 v[164:167], v[96:99], a[140:143], v[164:167]
    ds_read_b128 v[96:99], v2 offset:0
    v_mfma_f32_16x16x32_bf16 v[168:171], v[100:103], a[136:139], v[168:171]
    v_mfma_f32_16x16x32_bf16 v[172:175], v[100:103], a[140:143], v[172:175]
    ds_read_b128 v[100:103], v2 offset:1024
    v_mfma_f32_16x16x32_bf16 v[176:179], v[104:107], a[136:139], v[176:179]
    v_mfma_f32_16x16x32_bf16 v[180:183], v[104:107], a[140:143], v[180:183]
    ds_read_b128 v[104:107], v2 offset:2048
    v_mfma_f32_16x16x32_bf16 v[184:187], v[108:111], a[136:139], v[184:187]
    v_mfma_f32_16x16x32_bf16 v[188:191], v[108:111], a[140:143], v[188:191]
    ds_read_b128 v[108:111], v2 offset:3072
    s_waitcnt lgkmcnt(8)
    v_mfma_f32_16x16x32_bf16 v[160:163], v[64:67], a[144:147], v[160:163]
    v_mfma_f32_16x16x32_bf16 v[164:167], v[64:67], a[148:151], v[164:167]
    ds_read_b128 v[64:67], v2 offset:4096
    v_mfma_f32_16x16x32_bf16 v[168:171], v[68:71], a[144:147], v[168:171]
    v_mfma_f32_16x16x32_bf16 v[172:175], v[68:71], a[148:151], v[172:175]
    ds_read_b128 v[68:71], v2 offset:5120
    v_mfma_f32_16x16x32_bf16 v[176:179], v[72:75], a[144:147], v[176:179]
    s_add_u32 m0, s68, 65536
    s_add_u32 s63, s101, 40960
    buffer_load_dwordx4 v253, s[24:27], s63 offen offset:0 sc1 lds
    v_mfma_f32_16x16x32_bf16 v[180:183], v[72:75], a[148:151], v[180:183]
    ds_read_b128 v[72:75], v2 offset:6144
    v_mfma_f32_16x16x32_bf16 v[184:187], v[76:79], a[144:147], v[184:187]
    v_mfma_f32_16x16x32_bf16 v[188:191], v[76:79], a[148:151], v[188:191]
    ds_read_b128 v[76:79], v2 offset:7168
    v_mfma_f32_16x16x16bf16_1k v[112:115], a[236:237], v[224:225], 0
    v_mfma_f32_16x16x16bf16_1k v[116:119], a[236:237], v[226:227], 0
    v_mfma_f32_16x16x16bf16_1k v[120:123], a[236:237], v[228:229], 0
    v_mfma_f32_16x16x16bf16_1k v[124:127], a[236:237], v[230:231], 0
    v_mfma_f32_16x16x16bf16_1k v[128:131], a[238:239], v[216:217], 0
    buffer_load_dwordx4 v253, s[24:27], s63 offen offset:1024 sc1 lds
    v_mfma_f32_16x16x16bf16_1k v[132:135], a[238:239], v[218:219], 0
    v_mfma_f32_16x16x16bf16_1k v[136:139], a[238:239], v[220:221], 0
    v_mfma_f32_16x16x16bf16_1k v[140:143], a[238:239], v[222:223], 0
    s_waitcnt lgkmcnt(8)
    v_mfma_f32_16x16x32_bf16 v[160:163], v[80:83], a[152:155], v[160:163]
    v_mfma_f32_16x16x32_bf16 v[164:167], v[80:83], a[156:159], v[164:167]
    ds_read_b128 v[80:83], v3 offset:16384
    v_mfma_f32_16x16x32_bf16 v[168:171], v[84:87], a[152:155], v[168:171]
    s_add_u32 m0, s68, 73728
    s_add_u32 s63, s101, 49152
    buffer_load_dwordx4 v253, s[24:27], s63 offen offset:0 sc1 lds
    v_mfma_f32_16x16x32_bf16 v[172:175], v[84:87], a[156:159], v[172:175]
    ds_read_b128 v[84:87], v3 offset:17408
    v_mfma_f32_16x16x32_bf16 v[176:179], v[88:91], a[152:155], v[176:179]
    v_mfma_f32_16x16x32_bf16 v[180:183], v[88:91], a[156:159], v[180:183]
    ds_read_b128 v[88:91], v3 offset:18432
    v_mfma_f32_16x16x32_bf16 v[184:187], v[92:95], a[152:155], v[184:187]
    buffer_load_dwordx4 v253, s[24:27], s63 offen offset:1024 sc1 lds
    v_mfma_f32_16x16x32_bf16 v[188:191], v[92:95], a[156:159], v[188:191]
    ds_read_b128 v[92:95], v3 offset:19456
    s_waitcnt lgkmcnt(8)
    v_mfma_f32_16x16x32_bf16 v[112:115], v[96:99], a[0:3], v[112:115]
    v_mfma_f32_16x16x32_bf16 v[116:119], v[96:99], a[4:7], v[116:119]
    ds_read_b128 v[96:99], v3 offset:20480
    v_mfma_f32_16x16x32_bf16 v[120:123], v[100:103], a[0:3], v[120:123]
    s_add_u32 m0, s68, 131072
    s_add_u32 s63, s101, 57344
    buffer_load_dwordx4 v253, s[24:27], s63 offen offset:0 sc1 lds
    v_mfma_f32_16x16x32_bf16 v[124:127], v[100:103], a[4:7], v[124:127]
    ds_read_b128 v[100:103], v3 offset:21504
    v_max_f32 v160, 0, v160
    v_mfma_f32_16x16x32_bf16 v[128:131], v[104:107], a[0:3], v[128:131]
    v_mul_f32 v168, v168, v52
    v_mul_f32 v160, v160, v168
    v_mfma_f32_16x16x32_bf16 v[132:135], v[104:107], a[4:7], v[132:135]
    ds_read_b128 v[104:107], v3 offset:22528
    v_max_f32 v161, 0, v161
    v_mfma_f32_16x16x32_bf16 v[136:139], v[108:111], a[0:3], v[136:139]
    buffer_load_dwordx4 v253, s[24:27], s63 offen offset:1024 sc1 lds
    v_mfma_f32_16x16x32_bf16 v[140:143], v[108:111], a[4:7], v[140:143]
    ds_read_b128 v[108:111], v3 offset:23552
    s_waitcnt lgkmcnt(8)
    v_mfma_f32_16x16x32_bf16 v[112:115], v[64:67], a[8:11], v[112:115]
    v_mul_f32 v169, v169, v52
    v_mul_f32 v161, v161, v169
    v_mfma_f32_16x16x32_bf16 v[116:119], v[64:67], a[12:15], v[116:119]
    ds_read_b128 v[64:67], v2 offset:8192
    v_max_f32 v162, 0, v162
    v_mfma_f32_16x16x32_bf16 v[120:123], v[68:71], a[8:11], v[120:123]
    v_mul_f32 v170, v170, v52
    v_mfma_f32_16x16x32_bf16 v[124:127], v[68:71], a[12:15], v[124:127]
    ds_read_b128 v[68:71], v2 offset:9216
    v_mul_f32 v162, v162, v170
    v_mfma_f32_16x16x32_bf16 v[128:131], v[72:75], a[8:11], v[128:131]
    v_max_f32 v163, 0, v163
    v_mul_f32 v171, v171, v52
    v_mfma_f32_16x16x32_bf16 v[132:135], v[72:75], a[12:15], v[132:135]
    ds_read_b128 v[72:75], v2 offset:10240
    v_mul_f32 v163, v163, v171
    v_mfma_f32_16x16x32_bf16 v[136:139], v[76:79], a[8:11], v[136:139]
    v_mfma_f32_16x16x32_bf16 v[140:143], v[76:79], a[12:15], v[140:143]
    ds_read_b128 v[76:79], v2 offset:11264
    s_waitcnt vmcnt(29)
    s_barrier
    s_waitcnt lgkmcnt(8)
    v_mfma_f32_16x16x32_bf16 v[112:115], v[80:83], a[16:19], v[112:115]
    v_cvt_pk_bf16_f32 v212, v160, v161
    v_cvt_pk_bf16_f32 v213, v162, v163
    v_mfma_f32_16x16x32_bf16 v[116:119], v[80:83], a[20:23], v[116:119]
    ds_read_b128 v[80:83], v2 offset:12288
    v_max_f32 v164, 0, v164
    v_mfma_f32_16x16x32_bf16 v[120:123], v[84:87], a[16:19], v[120:123]
    s_add_u32 m0, s68, 147456
    s_add_u32 s63, s101, 65536
    buffer_load_dwordx4 v253, s[24:27], s63 offen offset:0 sc1 lds
    v_mul_f32 v172, v172, v53
    v_mfma_f32_16x16x32_bf16 v[124:127], v[84:87], a[20:23], v[124:127]
    ds_read_b128 v[84:87], v2 offset:13312
    v_mul_f32 v164, v164, v172
    v_mfma_f32_16x16x32_bf16 v[128:131], v[88:91], a[16:19], v[128:131]
    v_max_f32 v165, 0, v165
    v_mul_f32 v173, v173, v53
    v_mfma_f32_16x16x32_bf16 v[132:135], v[88:91], a[20:23], v[132:135]
    ds_read_b128 v[88:91], v2 offset:14336
    v_mul_f32 v165, v165, v173
    v_mfma_f32_16x16x32_bf16 v[136:139], v[92:95], a[16:19], v[136:139]
    buffer_load_dwordx4 v253, s[24:27], s63 offen offset:1024 sc1 lds
    v_mfma_f32_16x16x32_bf16 v[140:143], v[92:95], a[20:23], v[140:143]
    ds_read_b128 v[92:95], v2 offset:15360
    s_waitcnt lgkmcnt(8)
    v_mfma_f32_16x16x32_bf16 v[112:115], v[96:99], a[24:27], v[112:115]
    v_max_f32 v166, 0, v166
    v_mul_f32 v174, v174, v53
    v_mfma_f32_16x16x32_bf16 v[116:119], v[96:99], a[28:31], v[116:119]
    ds_read_b128 v[96:99], v2 offset:16384
    v_mul_f32 v166, v166, v174
    v_mfma_f32_16x16x32_bf16 v[120:123], v[100:103], a[24:27], v[120:123]
    v_max_f32 v167, 0, v167
    v_mul_f32 v175, v175, v53
    v_mfma_f32_16x16x32_bf16 v[124:127], v[100:103], a[28:31], v[124:127]
    ds_read_b128 v[100:103], v2 offset:17408
    v_mul_f32 v167, v167, v175
    v_mfma_f32_16x16x32_bf16 v[128:131], v[104:107], a[24:27], v[128:131]
    v_cvt_pk_bf16_f32 v214, v164, v165
    v_cvt_pk_bf16_f32 v215, v166, v167
    v_mfma_f32_16x16x32_bf16 v[132:135], v[104:107], a[28:31], v[132:135]
    ds_read_b128 v[104:107], v2 offset:18432
    v_mfma_f32_16x16x32_bf16 v[136:139], v[108:111], a[24:27], v[136:139]
    v_mfma_f32_16x16x32_bf16 v[140:143], v[108:111], a[28:31], v[140:143]
    ds_read_b128 v[108:111], v2 offset:19456
    s_waitcnt lgkmcnt(8)
    v_mfma_f32_16x16x32_bf16 v[112:115], v[64:67], a[32:35], v[112:115]
    v_permlane32_swap_b32 v212, v214
    v_mfma_f32_16x16x32_bf16 v[116:119], v[64:67], a[36:39], v[116:119]
    ds_read_b128 v[64:67], v2 offset:20480
    v_permlane32_swap_b32 v213, v215
    v_mfma_f32_16x16x32_bf16 v[120:123], v[68:71], a[32:35], v[120:123]
    s_add_u32 m0, s68, 155648
    s_add_u32 s63, s101, 73728
    buffer_load_dwordx4 v253, s[24:27], s63 offen offset:0 sc1 lds
    buffer_store_dwordx4 v[212:215], v39, s[24:27], s53 offen offset:3072 sc1
    v_mfma_f32_16x16x32_bf16 v[124:127], v[68:71], a[36:39], v[124:127]
    ds_read_b128 v[68:71], v2 offset:21504
    v_max_f32 v176, 0, v176
    v_mfma_f32_16x16x32_bf16 v[128:131], v[72:75], a[32:35], v[128:131]
    v_mul_f32 v184, v184, v52
    v_mul_f32 v176, v176, v184
    v_mfma_f32_16x16x32_bf16 v[132:135], v[72:75], a[36:39], v[132:135]
    ds_read_b128 v[72:75], v2 offset:22528
    v_max_f32 v177, 0, v177
    v_mfma_f32_16x16x32_bf16 v[136:139], v[76:79], a[32:35], v[136:139]
    buffer_load_dwordx4 v253, s[24:27], s63 offen offset:1024 sc1 lds
    v_mfma_f32_16x16x32_bf16 v[140:143], v[76:79], a[36:39], v[140:143]
    ds_read_b128 v[76:79], v2 offset:23552
    s_waitcnt lgkmcnt(8)
    v_mfma_f32_16x16x32_bf16 v[112:115], v[80:83], a[40:43], v[112:115]
    v_mul_f32 v185, v185, v52
    v_mul_f32 v177, v177, v185
    v_mfma_f32_16x16x32_bf16 v[116:119], v[80:83], a[44:47], v[116:119]
    ds_read_b128 v[80:83], v2 offset:24576
    v_max_f32 v178, 0, v178
    v_mfma_f32_16x16x32_bf16 v[120:123], v[84:87], a[40:43], v[120:123]
    s_add_u32 m0, s68, 0
    s_add_u32 s63, s101, 81920
    buffer_load_dwordx4 v253, s[24:27], s63 offen offset:0 sc1 lds
    v_mul_f32 v186, v186, v52
    v_mfma_f32_16x16x32_bf16 v[124:127], v[84:87], a[44:47], v[124:127]
    ds_read_b128 v[84:87], v2 offset:25600
    v_mul_f32 v178, v178, v186
    v_mfma_f32_16x16x32_bf16 v[128:131], v[88:91], a[40:43], v[128:131]
    v_max_f32 v179, 0, v179
    v_mul_f32 v187, v187, v52
    v_mfma_f32_16x16x32_bf16 v[132:135], v[88:91], a[44:47], v[132:135]
    ds_read_b128 v[88:91], v2 offset:26624
    v_mul_f32 v179, v179, v187
    v_mfma_f32_16x16x32_bf16 v[136:139], v[92:95], a[40:43], v[136:139]
    buffer_load_dwordx4 v253, s[24:27], s63 offen offset:1024 sc1 lds
    v_mfma_f32_16x16x32_bf16 v[140:143], v[92:95], a[44:47], v[140:143]
    ds_read_b128 v[92:95], v2 offset:27648
    s_waitcnt lgkmcnt(8)
    v_mfma_f32_16x16x32_bf16 v[112:115], v[96:99], a[48:51], v[112:115]
    v_cvt_pk_bf16_f32 v208, v176, v177
    v_cvt_pk_bf16_f32 v209, v178, v179
    v_mfma_f32_16x16x32_bf16 v[116:119], v[96:99], a[52:55], v[116:119]
    ds_read_b128 v[96:99], v2 offset:28672
    v_max_f32 v180, 0, v180
    v_mfma_f32_16x16x32_bf16 v[120:123], v[100:103], a[48:51], v[120:123]
    v_mul_f32 v188, v188, v53
    v_mfma_f32_16x16x32_bf16 v[124:127], v[100:103], a[52:55], v[124:127]
    ds_read_b128 v[100:103], v2 offset:29696
    v_mul_f32 v180, v180, v188
    v_mfma_f32_16x16x32_bf16 v[128:131], v[104:107], a[48:51], v[128:131]
    v_max_f32 v181, 0, v181
    v_mul_f32 v189, v189, v53
    v_mfma_f32_16x16x32_bf16 v[132:135], v[104:107], a[52:55], v[132:135]
    ds_read_b128 v[104:107], v2 offset:30720
    v_mul_f32 v181, v181, v189
    v_mfma_f32_16x16x32_bf16 v[136:139], v[108:111], a[48:51], v[136:139]
    v_mfma_f32_16x16x32_bf16 v[140:143], v[108:111], a[52:55], v[140:143]
    ds_read_b128 v[108:111], v2 offset:31744
    s_waitcnt vmcnt(29)
    s_barrier
    s_waitcnt lgkmcnt(8)
    v_mfma_f32_16x16x32_bf16 v[112:115], v[64:67], a[56:59], v[112:115]
    v_max_f32 v182, 0, v182
    v_mul_f32 v190, v190, v53
    v_mfma_f32_16x16x32_bf16 v[116:119], v[64:67], a[60:63], v[116:119]
    ds_read_b128 v[64:67], v3 offset:24576
    v_mul_f32 v182, v182, v190
    v_mfma_f32_16x16x32_bf16 v[120:123], v[68:71], a[56:59], v[120:123]
    s_add_u32 m0, s68, 8192
    s_add_u32 s63, s101, 90112
    buffer_load_dwordx4 v253, s[24:27], s63 offen offset:0 sc1 lds
    v_max_f32 v183, 0, v183
    v_mfma_f32_16x16x32_bf16 v[124:127], v[68:71], a[60:63], v[124:127]
    ds_read_b128 v[68:71], v3 offset:25600
    v_mul_f32 v191, v191, v53
    v_mfma_f32_16x16x32_bf16 v[128:131], v[72:75], a[56:59], v[128:131]
    v_mul_f32 v183, v183, v191
    v_cvt_pk_bf16_f32 v210, v180, v181
    v_mfma_f32_16x16x32_bf16 v[132:135], v[72:75], a[60:63], v[132:135]
    ds_read_b128 v[72:75], v3 offset:26624
    v_cvt_pk_bf16_f32 v211, v182, v183
    v_mfma_f32_16x16x32_bf16 v[136:139], v[76:79], a[56:59], v[136:139]
    buffer_load_dwordx4 v253, s[24:27], s63 offen offset:1024 sc1 lds
    v_mfma_f32_16x16x32_bf16 v[140:143], v[76:79], a[60:63], v[140:143]
    ds_read_b128 v[76:79], v3 offset:27648
    s_waitcnt lgkmcnt(8)
    v_mfma_f32_16x16x32_bf16 v[112:115], v[80:83], a[64:67], v[112:115]
    v_permlane32_swap_b32 v208, v210
    v_mfma_f32_16x16x32_bf16 v[116:119], v[80:83], a[68:71], v[116:119]
    ds_read_b128 v[80:83], v3 offset:28672
    v_permlane32_swap_b32 v209, v211
    v_mfma_f32_16x16x32_bf16 v[120:123], v[84:87], a[64:67], v[120:123]
    s_add_u32 m0, s68, 81920
    s_add_u32 s63, s101, 98304
    buffer_load_dwordx4 v253, s[24:27], s63 offen offset:0 sc1 lds
    buffer_store_dwordx4 v[208:211], v39, s[24:27], s56 offen offset:0 sc1
    v_mfma_f32_16x16x32_bf16 v[124:127], v[84:87], a[68:71], v[124:127]
    ds_read_b128 v[84:87], v3 offset:29696
    v_mfma_f32_16x16x32_bf16 v[128:131], v[88:91], a[64:67], v[128:131]
    v_mfma_f32_16x16x32_bf16 v[132:135], v[88:91], a[68:71], v[132:135]
    ds_read_b128 v[88:91], v3 offset:30720
    v_mfma_f32_16x16x32_bf16 v[136:139], v[92:95], a[64:67], v[136:139]
    buffer_load_dwordx4 v253, s[24:27], s63 offen offset:1024 sc1 lds
    v_mfma_f32_16x16x32_bf16 v[140:143], v[92:95], a[68:71], v[140:143]
    ds_read_b128 v[92:95], v3 offset:31744
    s_waitcnt lgkmcnt(8)
    v_mfma_f32_16x16x32_bf16 v[112:115], v[96:99], a[72:75], v[112:115]
    v_mfma_f32_16x16x32_bf16 v[116:119], v[96:99], a[76:79], v[116:119]
    ds_read_b128 v[96:99], v2 offset:32768
    v_mfma_f32_16x16x32_bf16 v[120:123], v[100:103], a[72:75], v[120:123]
    v_mfma_f32_16x16x32_bf16 v[124:127], v[100:103], a[76:79], v[124:127]
    ds_read_b128 v[100:103], v2 offset:33792
    v_mfma_f32_16x16x32_bf16 v[128:131], v[104:107], a[72:75], v[128:131]
    v_mfma_f32_16x16x32_bf16 v[132:135], v[104:107], a[76:79], v[132:135]
    ds_read_b128 v[104:107], v2 offset:34816
    v_mfma_f32_16x16x32_bf16 v[136:139], v[108:111], a[72:75], v[136:139]
    v_mfma_f32_16x16x32_bf16 v[140:143], v[108:111], a[76:79], v[140:143]
    ds_read_b128 v[108:111], v2 offset:35840
    s_waitcnt vmcnt(1)
    v_mov_b32 v9, s95
    v_mov_b32 v11, 1
    s_mov_b64 exec, 1
    buffer_store_dword v11, v9, s[72:75], 0 offen offset:512
    buffer_store_dword v11, v9, s[76:79], 0 offen offset:512 sc1
    s_mov_b64 exec, -1
    v_lshrrev_b32 v44, 5, v1
    v_lshlrev_b32 v44, 10, v44
    v_bfe_u32 v45, v1, 4, 1
    v_lshl_add_u32 v44, v45, 9, v44
    v_and_b32 v45, 15, v1
    v_lshl_add_u32 v44, v45, 4, v44
    s_mul_i32 s48, s64, 2304
    v_add_u32 v59, s48, v44
    s_mul_i32 s48, s64, 1792
    s_add_u32 s48, s48, 256
    v_add_u32 v60, s48, v44
    s_mul_i32 s80, s97, 110592
    s_add_u32 s80, s80, 36139008
    s_waitcnt lgkmcnt(8)
    v_mfma_f32_16x16x32_bf16 v[112:115], v[64:67], a[80:83], v[112:115]
    v_mfma_f32_16x16x32_bf16 v[116:119], v[64:67], a[84:87], v[116:119]
    ds_read_b128 v[64:67], v2 offset:36864
    v_mfma_f32_16x16x32_bf16 v[120:123], v[68:71], a[80:83], v[120:123]
    v_mfma_f32_16x16x32_bf16 v[124:127], v[68:71], a[84:87], v[124:127]
    ds_read_b128 v[68:71], v2 offset:37888
    v_mfma_f32_16x16x32_bf16 v[128:131], v[72:75], a[80:83], v[128:131]
    v_mfma_f32_16x16x32_bf16 v[132:135], v[72:75], a[84:87], v[132:135]
    ds_read_b128 v[72:75], v2 offset:38912
    v_mfma_f32_16x16x32_bf16 v[136:139], v[76:79], a[80:83], v[136:139]
    v_mfma_f32_16x16x32_bf16 v[140:143], v[76:79], a[84:87], v[140:143]
    ds_read_b128 v[76:79], v2 offset:39936
    s_waitcnt lgkmcnt(8)
    v_mfma_f32_16x16x32_bf16 v[112:115], v[80:83], a[88:91], v[112:115]
    v_mfma_f32_16x16x32_bf16 v[116:119], v[80:83], a[92:95], v[116:119]
    ds_read_b128 v[80:83], v2 offset:40960
    v_mfma_f32_16x16x32_bf16 v[120:123], v[84:87], a[88:91], v[120:123]
    v_mfma_f32_16x16x32_bf16 v[124:127], v[84:87], a[92:95], v[124:127]
    ds_read_b128 v[84:87], v2 offset:41984
    v_mfma_f32_16x16x32_bf16 v[128:131], v[88:91], a[88:91], v[128:131]
    v_mfma_f32_16x16x32_bf16 v[132:135], v[88:91], a[92:95], v[132:135]
    ds_read_b128 v[88:91], v2 offset:43008
    v_mfma_f32_16x16x32_bf16 v[136:139], v[92:95], a[88:91], v[136:139]
    v_mfma_f32_16x16x32_bf16 v[140:143], v[92:95], a[92:95], v[140:143]
    ds_read_b128 v[92:95], v2 offset:44032
    s_barrier
    s_add_u32 s48, s94, 512
    v_and_b32 v9, 15, v1
    v_lshl_add_u32 v9, v9, 2, s48
    global_load_dword v47, v9, s[22:23] sc1
    s_waitcnt lgkmcnt(8)
    v_mfma_f32_16x16x32_bf16 v[112:115], v[96:99], a[96:99], v[112:115]
    v_mfma_f32_16x16x32_bf16 v[116:119], v[96:99], a[100:103], v[116:119]
    ds_read_b128 v[96:99], v2 offset:45056
    v_mfma_f32_16x16x32_bf16 v[120:123], v[100:103], a[96:99], v[120:123]
    s_add_u32 m0, s68, 16384
    s_add_u32 s63, s101, 106496
    buffer_load_dwordx4 v253, s[24:27], s63 offen offset:0 sc1 lds
    v_mfma_f32_16x16x32_bf16 v[124:127], v[100:103], a[100:103], v[124:127]
    ds_read_b128 v[100:103], v2 offset:46080
    v_mfma_f32_16x16x32_bf16 v[128:131], v[104:107], a[96:99], v[128:131]
    v_mfma_f32_16x16x32_bf16 v[132:135], v[104:107], a[100:103], v[132:135]
    ds_read_b128 v[104:107], v2 offset:47104
    v_mfma_f32_16x16x32_bf16 v[136:139], v[108:111], a[96:99], v[136:139]
    buffer_load_dwordx4 v253, s[24:27], s63 offen offset:1024 sc1 lds
    v_mfma_f32_16x16x32_bf16 v[140:143], v[108:111], a[100:103], v[140:143]
    ds_read_b128 v[108:111], v2 offset:48128
    s_waitcnt lgkmcnt(8)
    v_mfma_f32_16x16x32_bf16 v[112:115], v[64:67], a[104:107], v[112:115]
    v_mfma_f32_16x16x32_bf16 v[116:119], v[64:67], a[108:111], v[116:119]
    ds_read_b128 v[64:67], v3 offset:32768
    v_mfma_f32_16x16x32_bf16 v[120:123], v[68:71], a[104:107], v[120:123]
    s_add_u32 m0, s68, 24576
    s_add_u32 s63, s101, 114688
    buffer_load_dwordx4 v253, s[24:27], s63 offen offset:0 sc1 lds
    v_mfma_f32_16x16x32_bf16 v[124:127], v[68:71], a[108:111], v[124:127]
    ds_read_b128 v[68:71], v3 offset:33792
    v_mfma_f32_16x16x32_bf16 v[128:131], v[72:75], a[104:107], v[128:131]
    v_mfma_f32_16x16x32_bf16 v[132:135], v[72:75], a[108:111], v[132:135]
    ds_read_b128 v[72:75], v3 offset:34816
    v_mfma_f32_16x16x32_bf16 v[136:139], v[76:79], a[104:107], v[136:139]
    buffer_load_dwordx4 v253, s[24:27], s63 offen offset:1024 sc1 lds
    v_mfma_f32_16x16x32_bf16 v[140:143], v[76:79], a[108:111], v[140:143]
    ds_read_b128 v[76:79], v3 offset:35840
    s_waitcnt lgkmcnt(8)
    v_mfma_f32_16x16x32_bf16 v[112:115], v[80:83], a[112:115], v[112:115]
    v_lshlrev_b32 v152, 16, v16
    v_and_b32 v153, 0xffff0000, v16
    v_mfma_f32_16x16x32_bf16 v[116:119], v[80:83], a[116:119], v[116:119]
    ds_read_b128 v[80:83], v3 offset:36864
    v_lshlrev_b32 v154, 16, v17
    v_mfma_f32_16x16x32_bf16 v[120:123], v[84:87], a[112:115], v[120:123]
    s_add_u32 m0, s68, 90112
    s_add_u32 s63, s101, 122880
    buffer_load_dwordx4 v253, s[24:27], s63 offen offset:0 sc1 lds
    v_and_b32 v155, 0xffff0000, v17
    v_mfma_f32_16x16x32_bf16 v[124:127], v[84:87], a[116:119], v[124:127]
    ds_read_b128 v[84:87], v3 offset:37888
    v_lshlrev_b32 v156, 16, v18
    v_mfma_f32_16x16x32_bf16 v[128:131], v[88:91], a[112:115], v[128:131]
    v_and_b32 v157, 0xffff0000, v18
    v_lshlrev_b32 v158, 16, v19
    v_mfma_f32_16x16x32_bf16 v[132:135], v[88:91], a[116:119], v[132:135]
    ds_read_b128 v[88:91], v3 offset:38912
    v_and_b32 v159, 0xffff0000, v19
    v_mfma_f32_16x16x32_bf16 v[136:139], v[92:95], a[112:115], v[136:139]
    buffer_load_dwordx4 v253, s[24:27], s63 offen offset:1024 sc1 lds
    v_mfma_f32_16x16x32_bf16 v[140:143], v[92:95], a[116:119], v[140:143]
    ds_read_b128 v[92:95], v3 offset:39936
    s_waitcnt vmcnt(6)
    v_cmp_le_u32 vcc, 1, v47
    s_nop 1
    s_cmp_eq_u64 vcc, -1
    s_nop 1
    s_cbranch_scc1 L_fd_107
    s_mov_b32 s46, 0x200000
    s_nop 0
L_fl_106:
    global_load_dword v10, v9, s[22:23] sc1
    s_waitcnt vmcnt(0)
    v_cmp_le_u32 vcc, 1, v10
    s_nop 1
    s_cmp_eq_u64 vcc, -1
    s_nop 1
    s_cbranch_scc1 L_fd_107
    s_sub_u32 s46, s46, 1
    s_cmp_lg_u32 s46, 0
    s_nop 0
    s_cbranch_scc1 L_fl_106
    s_nop 0
L_fd_107:
    s_waitcnt lgkmcnt(8)
    v_mfma_f32_16x16x32_bf16 v[112:115], v[96:99], a[120:123], v[112:115]
    v_lshlrev_b32 v160, 16, v20
    v_and_b32 v161, 0xffff0000, v20
    v_mfma_f32_16x16x32_bf16 v[116:119], v[96:99], a[124:127], v[116:119]
    ds_read_b128 v[96:99], v3 offset:40960
    v_lshlrev_b32 v162, 16, v21
    v_mfma_f32_16x16x32_bf16 v[120:123], v[100:103], a[120:123], v[120:123]
    s_add_u32 s81, s80, 0
    buffer_load_dwordx4 a[160:163], v59, s[24:27], s81 offen sc1
    v_and_b32 v163, 0xffff0000, v21
    v_mfma_f32_16x16x32_bf16 v[124:127], v[100:103], a[124:127], v[124:127]
    ds_read_b128 v[100:103], v3 offset:41984
    v_lshlrev_b32 v164, 16, v22
    v_mfma_f32_16x16x32_bf16 v[128:131], v[104:107], a[120:123], v[128:131]
    v_and_b32 v165, 0xffff0000, v22
    v_lshlrev_b32 v166, 16, v23
    v_mfma_f32_16x16x32_bf16 v[132:135], v[104:107], a[124:127], v[132:135]
    ds_read_b128 v[104:107], v3 offset:43008
    v_and_b32 v167, 0xffff0000, v23
    v_mfma_f32_16x16x32_bf16 v[136:139], v[108:111], a[120:123], v[136:139]
    buffer_load_dwordx4 a[164:167], v60, s[24:27], s81 offen sc1
    v_mfma_f32_16x16x32_bf16 v[140:143], v[108:111], a[124:127], v[140:143]
    ds_read_b128 v[108:111], v3 offset:44032
    s_waitcnt lgkmcnt(8)
    v_mfma_f32_16x16x32_bf16 v[112:115], v[64:67], a[128:131], v[112:115]
    s_add_u32 s81, s80, 4096
    buffer_load_dwordx4 a[168:171], v59, s[24:27], s81 offen sc1
    v_lshlrev_b32 v168, 16, v24
    v_mfma_f32_16x16x32_bf16 v[116:119], v[64:67], a[132:135], v[116:119]
    ds_read_b128 v[64:67], v3 offset:45056
    v_and_b32 v169, 0xffff0000, v24
    v_mfma_f32_16x16x32_bf16 v[120:123], v[68:71], a[128:131], v[120:123]
    buffer_load_dwordx4 a[172:175], v60, s[24:27], s81 offen sc1
    v_lshlrev_b32 v170, 16, v25
    v_mfma_f32_16x16x32_bf16 v[124:127], v[68:71], a[132:135], v[124:127]
    ds_read_b128 v[68:71], v3 offset:46080
    v_and_b32 v171, 0xffff0000, v25
    v_mfma_f32_16x16x32_bf16 v[128:131], v[72:75], a[128:131], v[128:131]
    v_mfma_f32_16x16x32_bf16 v[132:135], v[72:75], a[132:135], v[132:135]
    ds_read_b128 v[72:75], v3 offset:47104
    v_mfma_f32_16x16x32_bf16 v[136:139], v[76:79], a[128:131], v[136:139]
    v_mfma_f32_16x16x32_bf16 v[140:143], v[76:79], a[132:135], v[140:143]
    ds_read_b128 v[76:79], v3 offset:48128
    s_waitcnt lgkmcnt(8)
    v_mfma_f32_16x16x32_bf16 v[112:115], v[80:83], a[136:139], v[112:115]
    s_add_u32 s81, s80, 8192
    buffer_load_dwordx4 a[176:179], v59, s[24:27], s81 offen sc1
    v_mfma_f32_16x16x32_bf16 v[116:119], v[80:83], a[140:143], v[116:119]
    v_mfma_f32_16x16x32_bf16 v[120:123], v[84:87], a[136:139], v[120:123]
    buffer_load_dwordx4 a[180:183], v60, s[24:27], s81 offen sc1
    v_mfma_f32_16x16x32_bf16 v[124:127], v[84:87], a[140:143], v[124:127]
    v_mfma_f32_16x16x32_bf16 v[128:131], v[88:91], a[136:139], v[128:131]
    v_mfma_f32_16x16x32_bf16 v[132:135], v[88:91], a[140:143], v[132:135]
    v_mfma_f32_16x16x32_bf16 v[136:139], v[92:95], a[136:139], v[136:139]
    v_mfma_f32_16x16x32_bf16 v[140:143], v[92:95], a[140:143], v[140:143]
    s_waitcnt lgkmcnt(4)
    v_mfma_f32_16x16x32_bf16 v[112:115], v[96:99], a[144:147], v[112:115]
    v_mfma_f32_16x16x32_bf16 v[116:119], v[96:99], a[148:151], v[116:119]
    v_mfma_f32_16x16x32_bf16 v[120:123], v[100:103], a[144:147], v[120:123]
    s_add_u32 s81, s80, 12288
    buffer_load_dwordx4 a[184:187], v59, s[24:27], s81 offen sc1
    v_mfma_f32_16x16x32_bf16 v[124:127], v[100:103], a[148:151], v[124:127]
    v_mfma_f32_16x16x32_bf16 v[128:131], v[104:107], a[144:147], v[128:131]
    v_mfma_f32_16x16x32_bf16 v[132:135], v[104:107], a[148:151], v[132:135]
    v_mfma_f32_16x16x32_bf16 v[136:139], v[108:111], a[144:147], v[136:139]
    buffer_load_dwordx4 a[188:191], v60, s[24:27], s81 offen sc1
    v_mfma_f32_16x16x32_bf16 v[140:143], v[108:111], a[148:151], v[140:143]
    s_waitcnt lgkmcnt(0)
    v_mfma_f32_16x16x32_bf16 v[112:115], v[64:67], a[152:155], v[112:115]
    v_mfma_f32_16x16x32_bf16 v[116:119], v[64:67], a[156:159], v[116:119]
    v_mfma_f32_16x16x32_bf16 v[120:123], v[68:71], a[152:155], v[120:123]
    s_add_u32 s81, s80, 16384
    buffer_load_dwordx4 a[192:195], v59, s[24:27], s81 offen sc1
    v_mfma_f32_16x16x32_bf16 v[124:127], v[68:71], a[156:159], v[124:127]
    v_mfma_f32_16x16x32_bf16 v[128:131], v[72:75], a[152:155], v[128:131]
    v_mfma_f32_16x16x32_bf16 v[132:135], v[72:75], a[156:159], v[132:135]
    v_mfma_f32_16x16x32_bf16 v[136:139], v[76:79], a[152:155], v[136:139]
    buffer_load_dwordx4 a[196:199], v60, s[24:27], s81 offen sc1
    v_mfma_f32_16x16x32_bf16 v[140:143], v[76:79], a[156:159], v[140:143]
    s_barrier
    ds_read_b128 v[64:67], v7 offset:8192
    ds_read_b128 v[68:71], v7 offset:10240
    ds_read_b128 v[72:75], v7 offset:12288
    ds_read_b128 v[76:79], v7 offset:14336
    ds_read_b128 v[80:83], v5 offset:49152
    ds_read_b128 v[84:87], v5 offset:51200
    ds_read_b128 v[88:91], v5 offset:53248
    ds_read_b128 v[92:95], v5 offset:55296
    ds_read_b128 v[96:99], v5 offset:57344
    ds_read_b128 v[100:103], v5 offset:59392
    ds_read_b128 v[104:107], v5 offset:61440
    ds_read_b128 v[108:111], v5 offset:63488
    s_add_u32 s81, s80, 20480
    buffer_load_dwordx4 a[200:203], v59, s[24:27], s81 offen sc1
    buffer_load_dwordx4 a[204:207], v60, s[24:27], s81 offen sc1
    s_waitcnt vmcnt(10) lgkmcnt(7)
    v_mfma_f32_16x16x32_bf16 v[152:155], v[64:67], a[160:163], v[152:155]
    s_add_u32 s81, s80, 24576
    buffer_load_dwordx4 a[208:211], v59, s[24:27], s81 offen sc1
    v_mfma_f32_16x16x32_bf16 v[172:175], v[64:67], a[164:167], 0
    ds_read_b128 v[64:67], v6 offset:49152
    v_mfma_f32_16x16x32_bf16 v[156:159], v[68:71], a[160:163], v[156:159]
    s_add_u32 m0, s68, 32768
    s_add_u32 s63, s101, 131072
    buffer_load_dwordx4 v253, s[24:27], s63 offen offset:0 sc1 lds
    v_max_f32 v112, 0, v112
    v_mul_f32 v120, v120, v52
    v_mfma_f32_16x16x32_bf16 v[176:179], v[68:71], a[164:167], 0
    ds_read_b128 v[68:71], v6 offset:51200
    v_mul_f32 v112, v112, v120
    v_max_f32 v113, 0, v113
    v_mfma_f32_16x16x32_bf16 v[160:163], v[72:75], a[160:163], v[160:163]
    buffer_load_dwordx4 a[212:215], v60, s[24:27], s81 offen sc1
    v_mul_f32 v121, v121, v52
    v_mul_f32 v113, v113, v121
    v_mfma_f32_16x16x32_bf16 v[180:183], v[72:75], a[164:167], 0
    ds_read_b128 v[72:75], v6 offset:53248
    v_max_f32 v114, 0, v114
    v_mfma_f32_16x16x32_bf16 v[164:167], v[76:79], a[160:163], v[164:167]
    buffer_load_dwordx4 v253, s[24:27], s63 offen offset:1024 sc1 lds
    v_mfma_f32_16x16x32_bf16 v[184:187], v[76:79], a[164:167], 0
    ds_read_b128 v[76:79], v6 offset:55296
    v_mfma_f32_16x16x32_bf16 v[168:171], v[80:83], a[160:163], v[168:171]
    s_add_u32 s81, s80, 28672
    buffer_load_dwordx4 a[0:3], v59, s[24:27], s81 offen sc1
    v_mfma_f32_16x16x32_bf16 v[188:191], v[80:83], a[164:167], 0
    ds_read_b128 v[80:83], v6 offset:57344
    s_waitcnt vmcnt(13) lgkmcnt(7)
    v_mfma_f32_16x16x32_bf16 v[152:155], v[84:87], a[168:171], v[152:155]
    buffer_load_dwordx4 a[4:7], v60, s[24:27], s81 offen sc1
    v_mul_f32 v122, v122, v52
    v_mul_f32 v114, v114, v122
    v_mfma_f32_16x16x32_bf16 v[172:175], v[84:87], a[172:175], v[172:175]
    ds_read_b128 v[84:87], v6 offset:59392
    v_max_f32 v115, 0, v115
    v_mul_f32 v123, v123, v52
    v_mfma_f32_16x16x32_bf16 v[156:159], v[88:91], a[168:171], v[156:159]
    s_add_u32 m0, s68, 40960
    s_add_u32 s63, s101, 139264
    buffer_load_dwordx4 v253, s[24:27], s63 offen offset:0 sc1 lds
    v_mul_f32 v115, v115, v123
    v_cvt_pk_bf16_f32 v212, v112, v113
    v_mfma_f32_16x16x32_bf16 v[176:179], v[88:91], a[172:175], v[176:179]
    ds_read_b128 v[88:91], v6 offset:61440
    v_cvt_pk_bf16_f32 v213, v114, v115
    v_max_f32 v116, 0, v116
    v_mfma_f32_16x16x32_bf16 v[160:163], v[92:95], a[168:171], v[160:163]
    s_add_u32 s81, s80, 32768
    buffer_load_dwordx4 a[8:11], v59, s[24:27], s81 offen sc1
    v_mul_f32 v124, v124, v53
    v_mul_f32 v116, v116, v124
    v_mfma_f32_16x16x32_bf16 v[180:183], v[92:95], a[172:175], v[180:183]
    ds_read_b128 v[92:95], v6 offset:63488
    v_max_f32 v117, 0, v117
    v_mfma_f32_16x16x32_bf16 v[164:167], v[96:99], a[168:171], v[164:167]
    buffer_load_dwordx4 v253, s[24:27], s63 offen offset:1024 sc1 lds
    v_mfma_f32_16x16x32_bf16 v[184:187], v[96:99], a[172:175], v[184:187]
    ds_read_b128 v[96:99], v6 offset:0
    v_mfma_f32_16x16x32_bf16 v[168:171], v[100:103], a[168:171], v[168:171]
    buffer_load_dwordx4 a[12:15], v60, s[24:27], s81 offen sc1
    v_mfma_f32_16x16x32_bf16 v[188:191], v[100:103], a[172:175], v[188:191]
    ds_read_b128 v[100:103], v6 offset:2048
    s_barrier
    s_waitcnt vmcnt(16) lgkmcnt(7)
    v_mfma_f32_16x16x32_bf16 v[152:155], v[104:107], a[176:179], v[152:155]
    s_add_u32 s81, s80, 36864
    buffer_load_dwordx4 a[16:19], v59, s[24:27], s81 offen sc1
    v_mul_f32 v125, v125, v53
    v_mfma_f32_16x16x32_bf16 v[172:175], v[104:107], a[180:183], v[172:175]
    ds_read_b128 v[104:107], v6 offset:4096
    v_mul_f32 v117, v117, v125
    v_mfma_f32_16x16x32_bf16 v[156:159], v[108:111], a[176:179], v[156:159]
    s_add_u32 m0, s68, 139264
    s_add_u32 s63, s101, 147456
    buffer_load_dwordx4 v253, s[24:27], s63 offen offset:0 sc1 lds
    v_max_f32 v118, 0, v118
    v_mfma_f32_16x16x32_bf16 v[176:179], v[108:111], a[180:183], v[176:179]
    ds_read_b128 v[108:111], v6 offset:6144
    v_mul_f32 v126, v126, v53
    v_mfma_f32_16x16x32_bf16 v[160:163], v[64:67], a[176:179], v[160:163]
    v_mul_f32 v118, v118, v126
    v_max_f32 v119, 0, v119
    v_mfma_f32_16x16x32_bf16 v[180:183], v[64:67], a[180:183], v[180:183]
    ds_read_b128 v[64:67], v6 offset:8192
    v_mul_f32 v127, v127, v53
    v_mfma_f32_16x16x32_bf16 v[164:167], v[68:71], a[176:179], v[164:167]
    buffer_load_dwordx4 a[20:23], v60, s[24:27], s81 offen sc1
    v_mul_f32 v119, v119, v127
    v_mfma_f32_16x16x32_bf16 v[184:187], v[68:71], a[180:183], v[184:187]
    ds_read_b128 v[68:71], v6 offset:10240
    v_cvt_pk_bf16_f32 v214, v116, v117
    v_mfma_f32_16x16x32_bf16 v[168:171], v[72:75], a[176:179], v[168:171]
    buffer_load_dwordx4 v253, s[24:27], s63 offen offset:1024 sc1 lds
    v_cvt_pk_bf16_f32 v215, v118, v119
    v_mfma_f32_16x16x32_bf16 v[188:191], v[72:75], a[180:183], v[188:191]
    ds_read_b128 v[72:75], v6 offset:12288
    s_waitcnt vmcnt(18) lgkmcnt(7)
    v_mfma_f32_16x16x32_bf16 v[152:155], v[76:79], a[184:187], v[152:155]
    s_add_u32 s81, s80, 40960
    buffer_load_dwordx4 a[24:27], v59, s[24:27], s81 offen sc1
    v_permlane32_swap_b32 v212, v214
    v_mfma_f32_16x16x32_bf16 v[172:175], v[76:79], a[188:191], v[172:175]
    ds_read_b128 v[76:79], v6 offset:14336
    v_permlane32_swap_b32 v213, v215
    v_mfma_f32_16x16x32_bf16 v[156:159], v[80:83], a[184:187], v[156:159]
    s_add_u32 m0, s68, 49152
    s_add_u32 s63, s101, 155648
    buffer_load_dwordx4 v253, s[24:27], s63 offen offset:0 sc1 lds
    buffer_store_dwordx4 v[212:215], v39, s[24:27], s54 offen offset:0 sc1
    v_mfma_f32_16x16x32_bf16 v[176:179], v[80:83], a[188:191], v[176:179]
    ds_read_b128 v[80:83], v7 offset:0
    v_max_f32 v128, 0, v128
    v_mfma_f32_16x16x32_bf16 v[160:163], v[84:87], a[184:187], v[160:163]
    v_mul_f32 v136, v136, v52
    v_mul_f32 v128, v128, v136
    v_mfma_f32_16x16x32_bf16 v[180:183], v[84:87], a[188:191], v[180:183]
    ds_read_b128 v[84:87], v7 offset:2048
    v_max_f32 v129, 0, v129
    v_mfma_f32_16x16x32_bf16 v[164:167], v[88:91], a[184:187], v[164:167]
    buffer_load_dwordx4 a[28:31], v60, s[24:27], s81 offen sc1
    v_mul_f32 v137, v137, v52
    v_mfma_f32_16x16x32_bf16 v[184:187], v[88:91], a[188:191], v[184:187]
    ds_read_b128 v[88:91], v7 offset:4096
    v_mul_f32 v129, v129, v137
    v_mfma_f32_16x16x32_bf16 v[168:171], v[92:95], a[184:187], v[168:171]
    buffer_load_dwordx4 v253, s[24:27], s63 offen offset:1024 sc1 lds
    v_max_f32 v130, 0, v130
    v_mfma_f32_16x16x32_bf16 v[188:191], v[92:95], a[188:191], v[188:191]
    ds_read_b128 v[92:95], v7 offset:6144
    v_mul_f32 v138, v138, v52
    s_waitcnt vmcnt(21) lgkmcnt(7)
    v_mfma_f32_16x16x32_bf16 v[152:155], v[96:99], a[192:195], v[152:155]
    s_add_u32 s81, s80, 45056
    buffer_load_dwordx4 a[32:35], v59, s[24:27], s81 offen sc1
    v_mul_f32 v130, v130, v138
    v_mfma_f32_16x16x32_bf16 v[172:175], v[96:99], a[196:199], v[172:175]
    ds_read_b128 v[96:99], v7 offset:16384
    v_max_f32 v131, 0, v131
    v_mfma_f32_16x16x32_bf16 v[156:159], v[100:103], a[192:195], v[156:159]
    s_add_u32 m0, s68, 98304
    s_add_u32 s63, s101, 163840
    buffer_load_dwordx4 v253, s[24:27], s63 offen offset:0 sc1 lds
    v_mul_f32 v139, v139, v52
    v_mfma_f32_16x16x32_bf16 v[176:179], v[100:103], a[196:199], v[176:179]
    ds_read_b128 v[100:103], v7 offset:18432
    v_mul_f32 v131, v131, v139
    v_mfma_f32_16x16x32_bf16 v[160:163], v[104:107], a[192:195], v[160:163]
    v_cvt_pk_bf16_f32 v208, v128, v129
    v_cvt_pk_bf16_f32 v209, v130, v131
    v_mfma_f32_16x16x32_bf16 v[180:183], v[104:107], a[196:199], v[180:183]
    ds_read_b128 v[104:107], v7 offset:20480
    v_max_f32 v132, 0, v132
    v_mfma_f32_16x16x32_bf16 v[164:167], v[108:111], a[192:195], v[164:167]
    buffer_load_dwordx4 a[36:39], v60, s[24:27], s81 offen sc1
    v_mul_f32 v140, v140, v53
    v_mfma_f32_16x16x32_bf16 v[184:187], v[108:111], a[196:199], v[184:187]
    ds_read_b128 v[108:111], v7 offset:22528
    v_mul_f32 v132, v132, v140
    v_mfma_f32_16x16x32_bf16 v[168:171], v[64:67], a[192:195], v[168:171]
    buffer_load_dwordx4 v253, s[24:27], s63 offen offset:1024 sc1 lds
    v_max_f32 v133, 0, v133
    v_mfma_f32_16x16x32_bf16 v[188:191], v[64:67], a[196:199], v[188:191]
    ds_read_b128 v[64:67], v7 offset:24576
    v_mul_f32 v141, v141, v53
    s_waitcnt vmcnt(23) lgkmcnt(7)
    v_mfma_f32_16x16x32_bf16 v[152:155], v[68:71], a[200:203], v[152:155]
    s_add_u32 s81, s80, 49152
    buffer_load_dwordx4 a[40:43], v59, s[24:27], s81 offen sc1
    v_mul_f32 v133, v133, v141
    v_mfma_f32_16x16x32_bf16 v[172:175], v[68:71], a[204:207], v[172:175]
    ds_read_b128 v[68:71], v7 offset:26624
    v_max_f32 v134, 0, v134
    v_mfma_f32_16x16x32_bf16 v[156:159], v[72:75], a[200:203], v[156:159]
    s_add_u32 m0, s68, 106496
    s_add_u32 s63, s101, 172032
    buffer_load_dwordx4 v253, s[24:27], s63 offen offset:0 sc1 lds
    v_mul_f32 v142, v142, v53
    v_mfma_f32_16x16x32_bf16 v[176:179], v[72:75], a[204:207], v[176:179]
    ds_read_b128 v[72:75], v7 offset:28672
    v_mul_f32 v134, v134, v142
    v_mfma_f32_16x16x32_bf16 v[160:163], v[76:79], a[200:203], v[160:163]
    v_max_f32 v135, 0, v135
    v_mul_f32 v143, v143, v53
    v_mfma_f32_16x16x32_bf16 v[180:183], v[76:79], a[204:207], v[180:183]
    ds_read_b128 v[76:79], v7 offset:30720
    v_mul_f32 v135, v135, v143
    v_mfma_f32_16x16x32_bf16 v[164:167], v[80:83], a[200:203], v[164:167]
    buffer_load_dwordx4 a[44:47], v60, s[24:27], s81 offen sc1
    v_cvt_pk_bf16_f32 v210, v132, v133
    v_mfma_f32_16x16x32_bf16 v[184:187], v[80:83], a[204:207], v[184:187]
    ds_read_b128 v[80:83], v5 offset:0
    v_cvt_pk_bf16_f32 v211, v134, v135
    v_mfma_f32_16x16x32_bf16 v[168:171], v[84:87], a[200:203], v[168:171]
    buffer_load_dwordx4 v253, s[24:27], s63 offen offset:1024 sc1 lds
    v_mfma_f32_16x16x32_bf16 v[188:191], v[84:87], a[204:207], v[188:191]
    ds_read_b128 v[84:87], v5 offset:2048
    v_permlane32_swap_b32 v208, v210
    s_barrier
    s_waitcnt vmcnt(24) lgkmcnt(7)
    v_mfma_f32_16x16x32_bf16 v[152:155], v[88:91], a[208:211], v[152:155]
    s_add_u32 s81, s80, 53248
    buffer_load_dwordx4 a[48:51], v59, s[24:27], s81 offen sc1
    v_permlane32_swap_b32 v209, v211
    v_mfma_f32_16x16x32_bf16 v[172:175], v[88:91], a[212:215], v[172:175]
    ds_read_b128 v[88:91], v5 offset:4096
    buffer_store_dwordx4 v[208:211], v39, s[24:27], s55 offen offset:0 sc1
    v_mfma_f32_16x16x32_bf16 v[156:159], v[92:95], a[208:211], v[156:159]
    s_add_u32 m0, s68, 57344
    s_add_u32 s63, s101, 180224
    buffer_load_dwordx4 v253, s[24:27], s63 offen offset:0 sc1 lds
    v_mfma_f32_16x16x32_bf16 v[176:179], v[92:95], a[212:215], v[176:179]
    ds_read_b128 v[92:95], v5 offset:6144
    v_mfma_f32_16x16x32_bf16 v[160:163], v[96:99], a[208:211], v[160:163]
    v_mfma_f32_16x16x32_bf16 v[180:183], v[96:99], a[212:215], v[180:183]
    ds_read_b128 v[96:99], v5 offset:8192
    v_mfma_f32_16x16x32_bf16 v[164:167], v[100:103], a[208:211], v[164:167]
    buffer_load_dwordx4 a[52:55], v60, s[24:27], s81 offen sc1
    v_mfma_f32_16x16x32_bf16 v[184:187], v[100:103], a[212:215], v[184:187]
    ds_read_b128 v[100:103], v5 offset:10240
    v_mfma_f32_16x16x32_bf16 v[168:171], v[104:107], a[208:211], v[168:171]
    buffer_load_dwordx4 v253, s[24:27], s63 offen offset:1024 sc1 lds
    v_mfma_f32_16x16x32_bf16 v[188:191], v[104:107], a[212:215], v[188:191]
    ds_read_b128 v[104:107], v5 offset:12288
    s_waitcnt vmcnt(26) lgkmcnt(7)
    v_mfma_f32_16x16x32_bf16 v[152:155], v[108:111], a[0:3], v[152:155]
    s_add_u32 s81, s80, 57344
    buffer_load_dwordx4 a[56:59], v59, s[24:27], s81 offen sc1
    v_mfma_f32_16x16x32_bf16 v[172:175], v[108:111], a[4:7], v[172:175]
    ds_read_b128 v[108:111], v5 offset:14336
    v_mfma_f32_16x16x32_bf16 v[156:159], v[64:67], a[0:3], v[156:159]
    s_add_u32 m0, s68, 65536
    s_add_u32 s63, s101, 188416
    buffer_load_dwordx4 v253, s[24:27], s63 offen offset:0 sc1 lds
    v_mfma_f32_16x16x32_bf16 v[176:179], v[64:67], a[4:7], v[176:179]
    ds_read_b128 v[64:67], v6 offset:16384
    v_mfma_f32_16x16x32_bf16 v[160:163], v[68:71], a[0:3], v[160:163]
    v_mfma_f32_16x16x32_bf16 v[180:183], v[68:71], a[4:7], v[180:183]
    ds_read_b128 v[68:71], v6 offset:18432
    v_mfma_f32_16x16x32_bf16 v[164:167], v[72:75], a[0:3], v[164:167]
    buffer_load_dwordx4 a[60:63], v60, s[24:27], s81 offen sc1
    v_mfma_f32_16x16x32_bf16 v[184:187], v[72:75], a[4:7], v[184:187]
    ds_read_b128 v[72:75], v6 offset:20480
    v_mfma_f32_16x16x32_bf16 v[168:171], v[76:79], a[0:3], v[168:171]
    buffer_load_dwordx4 v253, s[24:27], s63 offen offset:1024 sc1 lds
    v_mfma_f32_16x16x32_bf16 v[188:191], v[76:79], a[4:7], v[188:191]
    ds_read_b128 v[76:79], v6 offset:22528
    s_waitcnt vmcnt(26) lgkmcnt(7)
    v_mfma_f32_16x16x32_bf16 v[152:155], v[80:83], a[8:11], v[152:155]
    s_add_u32 s81, s80, 61440
    buffer_load_dwordx4 a[64:67], v59, s[24:27], s81 offen sc1
    v_mfma_f32_16x16x32_bf16 v[172:175], v[80:83], a[12:15], v[172:175]
    ds_read_b128 v[80:83], v5 offset:16384
    v_mfma_f32_16x16x32_bf16 v[156:159], v[84:87], a[8:11], v[156:159]
    s_add_u32 m0, s68, 73728
    s_add_u32 s63, s101, 196608
    buffer_load_dwordx4 v253, s[24:27], s63 offen offset:0 sc1 lds
    v_mfma_f32_16x16x32_bf16 v[176:179], v[84:87], a[12:15], v[176:179]
    ds_read_b128 v[84:87], v5 offset:18432
    v_mfma_f32_16x16x32_bf16 v[160:163], v[88:91], a[8:11], v[160:163]
    v_mfma_f32_16x16x32_bf16 v[180:183], v[88:91], a[12:15], v[180:183]
    ds_read_b128 v[88:91], v5 offset:20480
    v_mfma_f32_16x16x32_bf16 v[164:167], v[92:95], a[8:11], v[164:167]
    buffer_load_dwordx4 a[68:71], v60, s[24:27], s81 offen sc1
    v_mfma_f32_16x16x32_bf16 v[184:187], v[92:95], a[12:15], v[184:187]
    ds_read_b128 v[92:95], v5 offset:22528
    v_mfma_f32_16x16x32_bf16 v[168:171], v[96:99], a[8:11], v[168:171]
    buffer_load_dwordx4 v253, s[24:27], s63 offen offset:1024 sc1 lds
    v_mfma_f32_16x16x32_bf16 v[188:191], v[96:99], a[12:15], v[188:191]
    ds_read_b128 v[96:99], v5 offset:24576
    s_waitcnt vmcnt(27) lgkmcnt(7)
    v_mfma_f32_16x16x32_bf16 v[152:155], v[100:103], a[16:19], v[152:155]
    s_add_u32 s81, s80, 65536
    buffer_load_dwordx4 a[72:75], v59, s[24:27], s81 offen sc1
    v_mfma_f32_16x16x32_bf16 v[172:175], v[100:103], a[20:23], v[172:175]
    ds_read_b128 v[100:103], v5 offset:26624
    v_mfma_f32_16x16x32_bf16 v[156:159], v[104:107], a[16:19], v[156:159]
    s_add_u32 m0, s68, 114688
    s_add_u32 s63, s101, 204800
    buffer_load_dwordx4 v253, s[24:27], s63 offen offset:0 sc1 lds
    v_mfma_f32_16x16x32_bf16 v[176:179], v[104:107], a[20:23], v[176:179]
    ds_read_b128 v[104:107], v5 offset:28672
    v_mfma_f32_16x16x32_bf16 v[160:163], v[108:111], a[16:19], v[160:163]
    v_mfma_f32_16x16x32_bf16 v[180:183], v[108:111], a[20:23], v[180:183]
    ds_read_b128 v[108:111], v5 offset:30720
    v_mfma_f32_16x16x32_bf16 v[164:167], v[64:67], a[16:19], v[164:167]
    buffer_load_dwordx4 a[76:79], v60, s[24:27], s81 offen sc1
    v_mfma_f32_16x16x32_bf16 v[184:187], v[64:67], a[20:23], v[184:187]
    ds_read_b128 v[64:67], v6 offset:24576
    v_mfma_f32_16x16x32_bf16 v[168:171], v[68:71], a[16:19], v[168:171]
    buffer_load_dwordx4 v253, s[24:27], s63 offen offset:1024 sc1 lds
    v_mfma_f32_16x16x32_bf16 v[188:191], v[68:71], a[20:23], v[188:191]
    ds_read_b128 v[68:71], v6 offset:26624
    s_waitcnt vmcnt(21)
    s_barrier
    s_waitcnt lgkmcnt(7)
    v_mfma_f32_16x16x32_bf16 v[152:155], v[72:75], a[24:27], v[152:155]
    s_add_u32 s81, s80, 69632
    buffer_load_dwordx4 a[80:83], v59, s[24:27], s81 offen sc1
    v_mfma_f32_16x16x32_bf16 v[172:175], v[72:75], a[28:31], v[172:175]
    ds_read_b128 v[72:75], v6 offset:28672
    v_mfma_f32_16x16x32_bf16 v[156:159], v[76:79], a[24:27], v[156:159]
    s_add_u32 m0, s68, 147456
    s_add_u32 s63, s101, 212992
    buffer_load_dwordx4 v253, s[24:27], s63 offen offset:0 sc1 lds
    v_mfma_f32_16x16x32_bf16 v[176:179], v[76:79], a[28:31], v[176:179]
    ds_read_b128 v[76:79], v6 offset:30720
    v_mfma_f32_16x16x32_bf16 v[160:163], v[80:83], a[24:27], v[160:163]
    v_mfma_f32_16x16x32_bf16 v[180:183], v[80:83], a[28:31], v[180:183]
    ds_read_b128 v[80:83], v5 offset:32768
    v_mfma_f32_16x16x32_bf16 v[164:167], v[84:87], a[24:27], v[164:167]
    buffer_load_dwordx4 a[84:87], v60, s[24:27], s81 offen sc1
    v_mfma_f32_16x16x32_bf16 v[184:187], v[84:87], a[28:31], v[184:187]
    ds_read_b128 v[84:87], v5 offset:34816
    v_mfma_f32_16x16x32_bf16 v[168:171], v[88:91], a[24:27], v[168:171]
    buffer_load_dwordx4 v253, s[24:27], s63 offen offset:1024 sc1 lds
    v_mfma_f32_16x16x32_bf16 v[188:191], v[88:91], a[28:31], v[188:191]
    ds_read_b128 v[88:91], v5 offset:36864
    s_waitcnt vmcnt(19)
    v_mov_b32 v9, s95
    v_mov_b32 v11, 1
    s_mov_b64 exec, 1
    buffer_store_dword v11, v9, s[72:75], 0 offen offset:768
    buffer_store_dword v11, v9, s[76:79], 0 offen offset:768 sc1
    s_mov_b64 exec, -1
    s_waitcnt lgkmcnt(7)
    v_mfma_f32_16x16x32_bf16 v[152:155], v[92:95], a[32:35], v[152:155]
    s_add_u32 s81, s80, 73728
    buffer_load_dwordx4 a[88:91], v59, s[24:27], s81 offen sc1
    v_mfma_f32_16x16x32_bf16 v[172:175], v[92:95], a[36:39], v[172:175]
    ds_read_b128 v[92:95], v5 offset:38912
    v_mfma_f32_16x16x32_bf16 v[156:159], v[96:99], a[32:35], v[156:159]
    s_add_u32 m0, s68, 0
    s_add_u32 s63, s101, 221184
    buffer_load_dwordx4 v253, s[24:27], s63 offen offset:0 sc1 lds
    v_mfma_f32_16x16x32_bf16 v[176:179], v[96:99], a[36:39], v[176:179]
    ds_read_b128 v[96:99], v5 offset:40960
    v_mfma_f32_16x16x32_bf16 v[160:163], v[100:103], a[32:35], v[160:163]
    v_mfma_f32_16x16x32_bf16 v[180:183], v[100:103], a[36:39], v[180:183]
    ds_read_b128 v[100:103], v5 offset:43008
    v_mfma_f32_16x16x32_bf16 v[164:167], v[104:107], a[32:35], v[164:167]
    buffer_load_dwordx4 a[92:95], v60, s[24:27], s81 offen sc1
    v_mfma_f32_16x16x32_bf16 v[184:187], v[104:107], a[36:39], v[184:187]
    ds_read_b128 v[104:107], v5 offset:45056
    v_mfma_f32_16x16x32_bf16 v[168:171], v[108:111], a[32:35], v[168:171]
    buffer_load_dwordx4 v253, s[24:27], s63 offen offset:1024 sc1 lds
    v_mfma_f32_16x16x32_bf16 v[188:191], v[108:111], a[36:39], v[188:191]
    ds_read_b128 v[108:111], v5 offset:47104
    s_waitcnt lgkmcnt(7)
    v_mfma_f32_16x16x32_bf16 v[152:155], v[64:67], a[40:43], v[152:155]
    s_add_u32 s81, s80, 77824
    buffer_load_dwordx4 a[96:99], v59, s[24:27], s81 offen sc1
    v_mfma_f32_16x16x32_bf16 v[172:175], v[64:67], a[44:47], v[172:175]
    ds_read_b128 v[64:67], v7 offset:8192
    v_mfma_f32_16x16x32_bf16 v[156:159], v[68:71], a[40:43], v[156:159]
    s_add_u32 m0, s68, 8192
    s_add_u32 s63, s101, 229376
    buffer_load_dwordx4 v253, s[24:27], s63 offen offset:0 sc1 lds
    v_mfma_f32_16x16x32_bf16 v[176:179], v[68:71], a[44:47], v[176:179]
    ds_read_b128 v[68:71], v7 offset:10240
    v_mfma_f32_16x16x32_bf16 v[160:163], v[72:75], a[40:43], v[160:163]
    v_mfma_f32_16x16x32_bf16 v[180:183], v[72:75], a[44:47], v[180:183]
    ds_read_b128 v[72:75], v7 offset:12288
    v_mfma_f32_16x16x32_bf16 v[164:167], v[76:79], a[40:43], v[164:167]
    buffer_load_dwordx4 a[100:103], v60, s[24:27], s81 offen sc1
    v_mfma_f32_16x16x32_bf16 v[184:187], v[76:79], a[44:47], v[184:187]
    ds_read_b128 v[76:79], v7 offset:14336
    v_mfma_f32_16x16x32_bf16 v[168:171], v[80:83], a[40:43], v[168:171]
    buffer_load_dwordx4 v253, s[24:27], s63 offen offset:1024 sc1 lds
    v_mfma_f32_16x16x32_bf16 v[188:191], v[80:83], a[44:47], v[188:191]
    ds_read_b128 v[80:83], v5 offset:49152
    s_add_u32 s48, s94, 768
    v_and_b32 v9, 15, v1
    v_lshl_add_u32 v9, v9, 2, s48
    global_load_dword v47, v9, s[22:23] sc1
    s_waitcnt vmcnt(28) lgkmcnt(7)
    v_mfma_f32_16x16x32_bf16 v[152:155], v[84:87], a[48:51], v[152:155]
    v_mfma_f32_16x16x32_bf16 v[172:175], v[84:87], a[52:55], v[172:175]
    ds_read_b128 v[84:87], v5 offset:51200
    v_mfma_f32_16x16x32_bf16 v[156:159], v[88:91], a[48:51], v[156:159]
    s_add_u32 m0, s68, 122880
    s_add_u32 s63, s101, 237568
    buffer_load_dwordx4 v253, s[24:27], s63 offen offset:0 sc1 lds
    v_mfma_f32_16x16x32_bf16 v[176:179], v[88:91], a[52:55], v[176:179]
    ds_read_b128 v[88:91], v5 offset:53248
    v_mfma_f32_16x16x32_bf16 v[160:163], v[92:95], a[48:51], v[160:163]
    v_mfma_f32_16x16x32_bf16 v[180:183], v[92:95], a[52:55], v[180:183]
    ds_read_b128 v[92:95], v5 offset:55296
    v_mfma_f32_16x16x32_bf16 v[164:167], v[96:99], a[48:51], v[164:167]
    buffer_load_dwordx4 v253, s[24:27], s63 offen offset:1024 sc1 lds
    v_mfma_f32_16x16x32_bf16 v[184:187], v[96:99], a[52:55], v[184:187]
    ds_read_b128 v[96:99], v6 offset:32768
    v_mfma_f32_16x16x32_bf16 v[168:171], v[100:103], a[48:51], v[168:171]
    v_mfma_f32_16x16x32_bf16 v[188:191], v[100:103], a[52:55], v[188:191]
    ds_read_b128 v[100:103], v6 offset:34816
    s_waitcnt vmcnt(17)
    s_barrier
    s_waitcnt lgkmcnt(7)
    v_mfma_f32_16x16x32_bf16 v[152:155], v[104:107], a[56:59], v[152:155]
    v_mfma_f32_16x16x32_bf16 v[172:175], v[104:107], a[60:63], v[172:175]
    ds_read_b128 v[104:107], v6 offset:36864
    v_mfma_f32_16x16x32_bf16 v[156:159], v[108:111], a[56:59], v[156:159]
    s_add_u32 m0, s68, 16384
    s_add_u32 s63, s101, 245760
    buffer_load_dwordx4 v253, s[24:27], s63 offen offset:0 sc1 lds
    v_mfma_f32_16x16x32_bf16 v[176:179], v[108:111], a[60:63], v[176:179]
    ds_read_b128 v[108:111], v6 offset:38912
    v_mfma_f32_16x16x32_bf16 v[160:163], v[64:67], a[56:59], v[160:163]
    v_mfma_f32_16x16x32_bf16 v[180:183], v[64:67], a[60:63], v[180:183]
    ds_read_b128 v[64:67], v6 offset:40960
    v_mfma_f32_16x16x32_bf16 v[164:167], v[68:71], a[56:59], v[164:167]
    buffer_load_dwordx4 v253, s[24:27], s63 offen offset:1024 sc1 lds
    v_mfma_f32_16x16x32_bf16 v[184:187], v[68:71], a[60:63], v[184:187]
    ds_read_b128 v[68:71], v6 offset:43008
    v_mfma_f32_16x16x32_bf16 v[168:171], v[72:75], a[56:59], v[168:171]
    v_mfma_f32_16x16x32_bf16 v[188:191], v[72:75], a[60:63], v[188:191]
    ds_read_b128 v[72:75], v6 offset:45056
    s_waitcnt vmcnt(4)
    v_cmp_le_u32 vcc, 1, v47
    s_nop 1
    s_cmp_eq_u64 vcc, -1
    s_nop 1
    s_cbranch_scc1 L_fd_109
    s_mov_b32 s46, 0x200000
    s_nop 0
L_fl_108:
    global_load_dword v10, v9, s[22:23] sc1
    s_waitcnt vmcnt(0)
    v_cmp_le_u32 vcc, 1, v10
    s_nop 1
    s_cmp_eq_u64 vcc, -1
    s_nop 1
    s_cbranch_scc1 L_fd_109
    s_sub_u32 s46, s46, 1
    s_cmp_lg_u32 s46, 0
    s_nop 0
    s_cbranch_scc1 L_fl_108
    s_nop 0
L_fd_109:
    s_waitcnt lgkmcnt(7)
    v_mfma_f32_16x16x32_bf16 v[152:155], v[76:79], a[64:67], v[152:155]
    s_add_u32 s81, s80, 81920
    buffer_load_dwordx4 a[104:107], v59, s[24:27], s81 offen sc1
    v_mfma_f32_16x16x32_bf16 v[172:175], v[76:79], a[68:71], v[172:175]
    ds_read_b128 v[76:79], v6 offset:47104
    v_mfma_f32_16x16x32_bf16 v[156:159], v[80:83], a[64:67], v[156:159]
    s_add_u32 m0, s68, 24576
    s_add_u32 s63, s101, 253952
    buffer_load_dwordx4 v253, s[24:27], s63 offen offset:0 sc1 lds
    v_mfma_f32_16x16x32_bf16 v[176:179], v[80:83], a[68:71], v[176:179]
    ds_read_b128 v[80:83], v5 offset:57344
    v_mfma_f32_16x16x32_bf16 v[160:163], v[84:87], a[64:67], v[160:163]
    v_mfma_f32_16x16x32_bf16 v[180:183], v[84:87], a[68:71], v[180:183]
    ds_read_b128 v[84:87], v5 offset:59392
    v_mfma_f32_16x16x32_bf16 v[164:167], v[88:91], a[64:67], v[164:167]
    buffer_load_dwordx4 a[108:111], v60, s[24:27], s81 offen sc1
    v_mfma_f32_16x16x32_bf16 v[184:187], v[88:91], a[68:71], v[184:187]
    ds_read_b128 v[88:91], v5 offset:61440
    v_mfma_f32_16x16x32_bf16 v[168:171], v[92:95], a[64:67], v[168:171]
    buffer_load_dwordx4 v253, s[24:27], s63 offen offset:1024 sc1 lds
    v_mfma_f32_16x16x32_bf16 v[188:191], v[92:95], a[68:71], v[188:191]
    ds_read_b128 v[92:95], v5 offset:63488
    s_waitcnt lgkmcnt(7)
    v_mfma_f32_16x16x32_bf16 v[152:155], v[96:99], a[72:75], v[152:155]
    s_add_u32 s81, s80, 86016
    buffer_load_dwordx4 a[112:115], v59, s[24:27], s81 offen sc1
    v_mfma_f32_16x16x32_bf16 v[172:175], v[96:99], a[76:79], v[172:175]
    ds_read_b128 v[96:99], v6 offset:0
    v_mfma_f32_16x16x32_bf16 v[156:159], v[100:103], a[72:75], v[156:159]
    s_add_u32 m0, s68, 32768
    s_add_u32 s63, s101, 262144
    buffer_load_dwordx4 v253, s[24:27], s63 offen offset:0 sc1 lds
    v_mfma_f32_16x16x32_bf16 v[176:179], v[100:103], a[76:79], v[176:179]
    ds_read_b128 v[100:103], v6 offset:2048
    v_mfma_f32_16x16x32_bf16 v[160:163], v[104:107], a[72:75], v[160:163]
    v_mfma_f32_16x16x32_bf16 v[180:183], v[104:107], a[76:79], v[180:183]
    ds_read_b128 v[104:107], v6 offset:4096
    v_mfma_f32_16x16x32_bf16 v[164:167], v[108:111], a[72:75], v[164:167]
    buffer_load_dwordx4 a[116:119], v60, s[24:27], s81 offen sc1
    v_mfma_f32_16x16x32_bf16 v[184:187], v[108:111], a[76:79], v[184:187]
    ds_read_b128 v[108:111], v6 offset:6144
    v_mfma_f32_16x16x32_bf16 v[168:171], v[64:67], a[72:75], v[168:171]
    buffer_load_dwordx4 v253, s[24:27], s63 offen offset:1024 sc1 lds
    v_mfma_f32_16x16x32_bf16 v[188:191], v[64:67], a[76:79], v[188:191]
    ds_read_b128 v[64:67], v6 offset:8192
    s_waitcnt lgkmcnt(7)
    v_mfma_f32_16x16x32_bf16 v[152:155], v[68:71], a[80:83], v[152:155]
    s_add_u32 s81, s80, 90112
    buffer_load_dwordx4 a[120:123], v59, s[24:27], s81 offen sc1
    v_mfma_f32_16x16x32_bf16 v[172:175], v[68:71], a[84:87], v[172:175]
    ds_read_b128 v[68:71], v6 offset:10240
    v_mfma_f32_16x16x32_bf16 v[156:159], v[72:75], a[80:83], v[156:159]
    s_add_u32 m0, s68, 81920
    s_add_u32 s63, s101, 270336
    buffer_load_dwordx4 v253, s[24:27], s63 offen offset:0 sc1 lds
    v_mfma_f32_16x16x32_bf16 v[176:179], v[72:75], a[84:87], v[176:179]
    ds_read_b128 v[72:75], v6 offset:12288
    v_mfma_f32_16x16x32_bf16 v[160:163], v[76:79], a[80:83], v[160:163]
    v_mfma_f32_16x16x32_bf16 v[180:183], v[76:79], a[84:87], v[180:183]
    ds_read_b128 v[76:79], v6 offset:14336
    v_mfma_f32_16x16x32_bf16 v[164:167], v[80:83], a[80:83], v[164:167]
    buffer_load_dwordx4 a[124:127], v60, s[24:27], s81 offen sc1
    v_mfma_f32_16x16x32_bf16 v[184:187], v[80:83], a[84:87], v[184:187]
    ds_read_b128 v[80:83], v6 offset:49152
    v_mfma_f32_16x16x32_bf16 v[168:171], v[84:87], a[80:83], v[168:171]
    buffer_load_dwordx4 v253, s[24:27], s63 offen offset:1024 sc1 lds
    v_mfma_f32_16x16x32_bf16 v[188:191], v[84:87], a[84:87], v[188:191]
    ds_read_b128 v[84:87], v6 offset:51200
    s_waitcnt vmcnt(12)
    s_barrier
    s_waitcnt lgkmcnt(7)
    v_mfma_f32_16x16x32_bf16 v[152:155], v[88:91], a[88:91], v[152:155]
    s_add_u32 s81, s80, 94208
    buffer_load_dwordx4 a[128:131], v59, s[24:27], s81 offen sc1
    v_mfma_f32_16x16x32_bf16 v[172:175], v[88:91], a[92:95], v[172:175]
    ds_read_b128 v[88:91], v6 offset:53248
    v_mfma_f32_16x16x32_bf16 v[156:159], v[92:95], a[88:91], v[156:159]
    s_cmp_eq_u32 s62, 1
    s_cbranch_scc0 L_nopg_110
    s_add_u32 m0, s68, 40960
    s_add_u32 s63, s98, 0
    buffer_load_dwordx4 v253, s[24:27], s63 offen offset:0 sc1 lds
L_nopg_110:
    v_mfma_f32_16x16x32_bf16 v[176:179], v[92:95], a[92:95], v[176:179]
    ds_read_b128 v[92:95], v6 offset:55296
    v_mfma_f32_16x16x32_bf16 v[160:163], v[96:99], a[88:91], v[160:163]
    v_mfma_f32_16x16x32_bf16 v[180:183], v[96:99], a[92:95], v[180:183]
    ds_read_b128 v[96:99], v7 offset:16384
    v_mfma_f32_16x16x32_bf16 v[164:167], v[100:103], a[88:91], v[164:167]
    buffer_load_dwordx4 a[132:135], v60, s[24:27], s81 offen sc1
    v_mfma_f32_16x16x32_bf16 v[184:187], v[100:103], a[92:95], v[184:187]
    ds_read_b128 v[100:103], v7 offset:18432
    v_mfma_f32_16x16x32_bf16 v[168:171], v[104:107], a[88:91], v[168:171]
    s_cmp_eq_u32 s62, 1
    s_cbranch_scc0 L_nopg_111
    buffer_load_dwordx4 v253, s[24:27], s63 offen offset:1024 sc1 lds
L_nopg_111:
    v_mfma_f32_16x16x32_bf16 v[188:191], v[104:107], a[92:95], v[188:191]
    ds_read_b128 v[104:107], v7 offset:20480
    s_waitcnt lgkmcnt(7)
    v_mfma_f32_16x16x32_bf16 v[152:155], v[108:111], a[96:99], v[152:155]
    s_add_u32 s81, s80, 98304
    buffer_load_dwordx4 a[136:139], v59, s[24:27], s81 offen sc1
    v_mfma_f32_16x16x32_bf16 v[172:175], v[108:111], a[100:103], v[172:175]
    ds_read_b128 v[108:111], v7 offset:22528
    v_mfma_f32_16x16x32_bf16 v[156:159], v[64:67], a[96:99], v[156:159]
    s_cmp_eq_u32 s62, 1
    s_cbranch_scc0 L_nopg_112
    s_add_u32 m0, s68, 49152
    s_add_u32 s63, s98, 8192
    buffer_load_dwordx4 v253, s[24:27], s63 offen offset:0 sc1 lds
L_nopg_112:
    v_mfma_f32_16x16x32_bf16 v[176:179], v[64:67], a[100:103], v[176:179]
    ds_read_b128 v[64:67], v5 offset:0
    v_mfma_f32_16x16x32_bf16 v[160:163], v[68:71], a[96:99], v[160:163]
    v_mfma_f32_16x16x32_bf16 v[180:183], v[68:71], a[100:103], v[180:183]
    ds_read_b128 v[68:71], v5 offset:2048
    v_mfma_f32_16x16x32_bf16 v[164:167], v[72:75], a[96:99], v[164:167]
    buffer_load_dwordx4 a[140:143], v60, s[24:27], s81 offen sc1
    v_mfma_f32_16x16x32_bf16 v[184:187], v[72:75], a[100:103], v[184:187]
    ds_read_b128 v[72:75], v5 offset:4096
    v_mfma_f32_16x16x32_bf16 v[168:171], v[76:79], a[96:99], v[168:171]
    s_cmp_eq_u32 s62, 1
    s_cbranch_scc0 L_nopg_113
    buffer_load_dwordx4 v253, s[24:27], s63 offen offset:1024 sc1 lds
L_nopg_113:
    v_mfma_f32_16x16x32_bf16 v[188:191], v[76:79], a[100:103], v[188:191]
    ds_read_b128 v[76:79], v5 offset:6144
    s_waitcnt vmcnt(13) lgkmcnt(7)
    v_mfma_f32_16x16x32_bf16 v[152:155], v[80:83], a[104:107], v[152:155]
    s_add_u32 s81, s80, 102400
    buffer_load_dwordx4 a[144:147], v59, s[24:27], s81 offen sc1
    v_mfma_f32_16x16x32_bf16 v[172:175], v[80:83], a[108:111], v[172:175]
    ds_read_b128 v[80:83], v5 offset:8192
    v_mfma_f32_16x16x32_bf16 v[156:159], v[84:87], a[104:107], v[156:159]
    s_cmp_eq_u32 s62, 1
    s_cbranch_scc0 L_nopg_114
    s_add_u32 m0, s68, 90112
    s_add_u32 s63, s98, 16384
    buffer_load_dwordx4 v253, s[24:27], s63 offen offset:0 sc1 lds
L_nopg_114:
    v_mfma_f32_16x16x32_bf16 v[176:179], v[84:87], a[108:111], v[176:179]
    ds_read_b128 v[84:87], v5 offset:10240
    v_mfma_f32_16x16x32_bf16 v[160:163], v[88:91], a[104:107], v[160:163]
    v_mfma_f32_16x16x32_bf16 v[180:183], v[88:91], a[108:111], v[180:183]
    ds_read_b128 v[88:91], v5 offset:12288
    v_mfma_f32_16x16x32_bf16 v[164:167], v[92:95], a[104:107], v[164:167]
    buffer_load_dwordx4 a[148:151], v60, s[24:27], s81 offen sc1
    v_mfma_f32_16x16x32_bf16 v[184:187], v[92:95], a[108:111], v[184:187]
    ds_read_b128 v[92:95], v5 offset:14336
    v_mfma_f32_16x16x32_bf16 v[168:171], v[96:99], a[104:107], v[168:171]
    s_cmp_eq_u32 s62, 1
    s_cbranch_scc0 L_nopg_115
    buffer_load_dwordx4 v253, s[24:27], s63 offen offset:1024 sc1 lds
L_nopg_115:
    v_mfma_f32_16x16x32_bf16 v[188:191], v[96:99], a[108:111], v[188:191]
    ds_read_b128 v[96:99], v6 offset:57344
    s_waitcnt vmcnt(11) lgkmcnt(7)
    v_mfma_f32_16x16x32_bf16 v[152:155], v[100:103], a[112:115], v[152:155]
    s_add_u32 s81, s80, 106496
    buffer_load_dwordx4 a[152:155], v59, s[24:27], s81 offen sc1
    v_mfma_f32_16x16x32_bf16 v[172:175], v[100:103], a[116:119], v[172:175]
    ds_read_b128 v[100:103], v6 offset:59392
    v_mfma_f32_16x16x32_bf16 v[156:159], v[104:107], a[112:115], v[156:159]
    s_cmp_eq_u32 s62, 1
    s_cbranch_scc0 L_nopg_116
    s_add_u32 m0, s68, 98304
    s_add_u32 s63, s98, 24576
    buffer_load_dwordx4 v253, s[24:27], s63 offen offset:0 sc1 lds
L_nopg_116:
    v_mfma_f32_16x16x32_bf16 v[176:179], v[104:107], a[116:119], v[176:179]
    ds_read_b128 v[104:107], v6 offset:61440
    v_mfma_f32_16x16x32_bf16 v[160:163], v[108:111], a[112:115], v[160:163]
    v_mfma_f32_16x16x32_bf16 v[180:183], v[108:111], a[116:119], v[180:183]
    ds_read_b128 v[108:111], v6 offset:63488
    v_mfma_f32_16x16x32_bf16 v[164:167], v[64:67], a[112:115], v[164:167]
    buffer_load_dwordx4 a[156:159], v60, s[24:27], s81 offen sc1
    v_mfma_f32_16x16x32_bf16 v[184:187], v[64:67], a[116:119], v[184:187]
    ds_read_b128 v[64:67], v5 offset:16384
    v_mfma_f32_16x16x32_bf16 v[168:171], v[68:71], a[112:115], v[168:171]
    s_cmp_eq_u32 s62, 1
    s_cbranch_scc0 L_nopg_117
    buffer_load_dwordx4 v253, s[24:27], s63 offen offset:1024 sc1 lds
L_nopg_117:
    v_mfma_f32_16x16x32_bf16 v[188:191], v[68:71], a[116:119], v[188:191]
    ds_read_b128 v[68:71], v5 offset:18432
    s_waitcnt vmcnt(8)
    s_barrier
    s_waitcnt lgkmcnt(7)
    v_mfma_f32_16x16x32_bf16 v[152:155], v[72:75], a[120:123], v[152:155]
    v_mfma_f32_16x16x32_bf16 v[172:175], v[72:75], a[124:127], v[172:175]
    ds_read_b128 v[72:75], v5 offset:20480
    v_mfma_f32_16x16x32_bf16 v[156:159], v[76:79], a[120:123], v[156:159]
    s_cmp_eq_u32 s62, 1
    s_cbranch_scc0 L_nopg_118
    s_add_u32 m0, s68, 57344
    s_add_u32 s63, s98, 32768
    buffer_load_dwordx4 v253, s[24:27], s63 offen offset:0 sc1 lds
L_nopg_118:
    v_mfma_f32_16x16x32_bf16 v[176:179], v[76:79], a[124:127], v[176:179]
    ds_read_b128 v[76:79], v5 offset:22528
    v_mfma_f32_16x16x32_bf16 v[160:163], v[80:83], a[120:123], v[160:163]
    v_mfma_f32_16x16x32_bf16 v[180:183], v[80:83], a[124:127], v[180:183]
    ds_read_b128 v[80:83], v5 offset:24576
    v_mfma_f32_16x16x32_bf16 v[164:167], v[84:87], a[120:123], v[164:167]
    s_cmp_eq_u32 s62, 1
    s_cbranch_scc0 L_nopg_119
    buffer_load_dwordx4 v253, s[24:27], s63 offen offset:1024 sc1 lds
L_nopg_119:
    v_mfma_f32_16x16x32_bf16 v[184:187], v[84:87], a[124:127], v[184:187]
    ds_read_b128 v[84:87], v5 offset:26624
    v_mfma_f32_16x16x32_bf16 v[168:171], v[88:91], a[120:123], v[168:171]
    v_mfma_f32_16x16x32_bf16 v[188:191], v[88:91], a[124:127], v[188:191]
    ds_read_b128 v[88:91], v5 offset:28672
    s_waitcnt vmcnt(6) lgkmcnt(7)
    v_mfma_f32_16x16x32_bf16 v[152:155], v[92:95], a[128:131], v[152:155]
    v_mfma_f32_16x16x32_bf16 v[172:175], v[92:95], a[132:135], v[172:175]
    ds_read_b128 v[92:95], v5 offset:30720
    v_mfma_f32_16x16x32_bf16 v[156:159], v[96:99], a[128:131], v[156:159]
    s_cmp_eq_u32 s62, 1
    s_cbranch_scc0 L_nopg_120
    s_add_u32 m0, s68, 65536
    s_add_u32 s63, s98, 40960
    buffer_load_dwordx4 v253, s[24:27], s63 offen offset:0 sc1 lds
L_nopg_120:
    v_mfma_f32_16x16x32_bf16 v[176:179], v[96:99], a[132:135], v[176:179]
    ds_read_b128 v[96:99], v5 offset:32768
    v_mfma_f32_16x16x32_bf16 v[160:163], v[100:103], a[128:131], v[160:163]
    v_mfma_f32_16x16x32_bf16 v[180:183], v[100:103], a[132:135], v[180:183]
    ds_read_b128 v[100:103], v5 offset:34816
    v_mfma_f32_16x16x32_bf16 v[164:167], v[104:107], a[128:131], v[164:167]
    s_cmp_eq_u32 s62, 1
    s_cbranch_scc0 L_nopg_121
    buffer_load_dwordx4 v253, s[24:27], s63 offen offset:1024 sc1 lds
L_nopg_121:
    v_mfma_f32_16x16x32_bf16 v[184:187], v[104:107], a[132:135], v[184:187]
    ds_read_b128 v[104:107], v5 offset:36864
    v_mfma_f32_16x16x32_bf16 v[168:171], v[108:111], a[128:131], v[168:171]
    v_mfma_f32_16x16x32_bf16 v[188:191], v[108:111], a[132:135], v[188:191]
    ds_read_b128 v[108:111], v5 offset:38912
    s_waitcnt vmcnt(4) lgkmcnt(7)
    v_mfma_f32_16x16x32_bf16 v[152:155], v[64:67], a[136:139], v[152:155]
    v_mfma_f32_16x16x32_bf16 v[172:175], v[64:67], a[140:143], v[172:175]
    ds_read_b128 v[64:67], v6 offset:16384
    v_mfma_f32_16x16x32_bf16 v[156:159], v[68:71], a[136:139], v[156:159]
    v_mfma_f32_16x16x32_bf16 v[176:179], v[68:71], a[140:143], v[176:179]
    ds_read_b128 v[68:71], v6 offset:18432
    v_mfma_f32_16x16x32_bf16 v[160:163], v[72:75], a[136:139], v[160:163]
    v_mfma_f32_16x16x32_bf16 v[180:183], v[72:75], a[140:143], v[180:183]
    ds_read_b128 v[72:75], v6 offset:20480
    v_mfma_f32_16x16x32_bf16 v[164:167], v[76:79], a[136:139], v[164:167]
    v_mfma_f32_16x16x32_bf16 v[184:187], v[76:79], a[140:143], v[184:187]
    v_mfma_f32_16x16x32_bf16 v[168:171], v[80:83], a[136:139], v[168:171]
    v_mfma_f32_16x16x32_bf16 v[188:191], v[80:83], a[140:143], v[188:191]
    s_waitcnt vmcnt(2) lgkmcnt(5)
    v_mfma_f32_16x16x32_bf16 v[152:155], v[84:87], a[144:147], v[152:155]
    s_mul_i32 s48, s42, 5120
    s_xor_b32 s49, s42, 2
    s_mul_i32 s49, s49, 5120
    v_mfma_f32_16x16x32_bf16 v[172:175], v[84:87], a[148:151], v[172:175]
    v_mfma_f32_16x16x32_bf16 v[156:159], v[88:91], a[144:147], v[156:159]
    s_add_u32 s48, s48, 139264
    s_add_u32 s49, s49, 139264
    v_mfma_f32_16x16x32_bf16 v[176:179], v[88:91], a[148:151], v[176:179]
    v_mfma_f32_16x16x32_bf16 v[160:163], v[92:95], a[144:147], v[160:163]
    v_add_u32 v47, s48, v2
    v_mfma_f32_16x16x32_bf16 v[180:183], v[92:95], a[148:151], v[180:183]
    v_mfma_f32_16x16x32_bf16 v[164:167], v[96:99], a[144:147], v[164:167]
    v_add_u32 v48, s49, v2
    v_mfma_f32_16x16x32_bf16 v[184:187], v[96:99], a[148:151], v[184:187]
    v_mfma_f32_16x16x32_bf16 v[168:171], v[100:103], a[144:147], v[168:171]
    v_mfma_f32_16x16x32_bf16 v[188:191], v[100:103], a[148:151], v[188:191]
    s_waitcnt vmcnt(0) lgkmcnt(0)
    v_mfma_f32_16x16x32_bf16 v[172:175], v[104:107], a[156:159], v[172:175]
    v_mfma_f32_16x16x32_bf16 v[176:179], v[108:111], a[156:159], v[176:179]
    v_mfma_f32_16x16x32_bf16 v[180:183], v[64:67], a[156:159], v[180:183]
    v_mfma_f32_16x16x32_bf16 v[184:187], v[68:71], a[156:159], v[184:187]
    v_mfma_f32_16x16x32_bf16 v[188:191], v[72:75], a[156:159], v[188:191]
    v_mfma_f32_16x16x32_bf16 v[152:155], v[104:107], a[152:155], v[152:155]
    s_nop 2
    ds_write_b128 v47, v[172:175] offset:0
    v_mfma_f32_16x16x32_bf16 v[156:159], v[108:111], a[152:155], v[156:159]
    ds_write_b128 v47, v[176:179] offset:1024
    v_mfma_f32_16x16x32_bf16 v[160:163], v[64:67], a[152:155], v[160:163]
    ds_write_b128 v47, v[180:183] offset:2048
    v_mfma_f32_16x16x32_bf16 v[164:167], v[68:71], a[152:155], v[164:167]
    ds_write_b128 v47, v[184:187] offset:3072
    v_mfma_f32_16x16x32_bf16 v[168:171], v[72:75], a[152:155], v[168:171]
    ds_write_b128 v47, v[188:191] offset:4096
    s_waitcnt lgkmcnt(0)
    s_barrier
    ds_read_b128 v[172:175], v48 offset:0
    ds_read_b128 v[176:179], v48 offset:1024
    ds_read_b128 v[180:183], v48 offset:2048
    ds_read_b128 v[184:187], v48 offset:3072
    ds_read_b128 v[188:191], v48 offset:4096
    s_cmp_eq_u32 s62, 1
    s_nop 0
    s_cbranch_scc1 L_more_122
    v_lshrrev_b32 v49, 4, v1
    v_and_b32 v50, 15, v1
    v_and_b32 v51, 1, v49
    v_lshlrev_b32 v51, 1, v51
    v_lshrrev_b32 v52, 1, v49
    v_add_u32 v51, v51, v52
    s_lshl_b32 s53, s97, 5
    s_lshl_b32 s54, s64, 4
    s_add_u32 s53, s53, s54
    v_add_u32 v53, s53, v50
    v_mul_u32_u24 v53, 1280, v53
    v_lshl_add_u32 v54, v49, 3, v53
    v_lshl_add_u32 v53, v51, 4, v53
    s_mul_i32 s50, s43, 160
    s_waitcnt lgkmcnt(4)
    v_pk_add_f32 v[152:153], v[152:153], v[172:173]
    v_pk_add_f32 v[154:155], v[154:155], v[174:175]
    v_cvt_pk_bf16_f32 v16, v152, v153
    v_cvt_pk_bf16_f32 v17, v154, v155
    s_waitcnt lgkmcnt(3)
    v_pk_add_f32 v[156:157], v[156:157], v[176:177]
    v_pk_add_f32 v[158:159], v[158:159], v[178:179]
    v_cvt_pk_bf16_f32 v18, v156, v157
    v_cvt_pk_bf16_f32 v19, v158, v159
    v_mov_b32 v208, v16
    v_mov_b32 v209, v17
    v_mov_b32 v210, v18
    v_mov_b32 v211, v19
    s_nop 0
    v_permlane16_swap_b32 v208, v210
    v_permlane16_swap_b32 v209, v211
    buffer_store_dwordx4 v[208:211], v53, s[32:35], s50 offen offset:0
    s_waitcnt lgkmcnt(2)
    v_pk_add_f32 v[160:161], v[160:161], v[180:181]
    v_pk_add_f32 v[162:163], v[162:163], v[182:183]
    v_cvt_pk_bf16_f32 v20, v160, v161
    v_cvt_pk_bf16_f32 v21, v162, v163
    s_waitcnt lgkmcnt(1)
    v_pk_add_f32 v[164:165], v[164:165], v[184:185]
    v_pk_add_f32 v[166:167], v[166:167], v[186:187]
    v_cvt_pk_bf16_f32 v22, v164, v165
    v_cvt_pk_bf16_f32 v23, v166, v167
    v_mov_b32 v212, v20
    v_mov_b32 v213, v21
    v_mov_b32 v214, v22
    v_mov_b32 v215, v23
    s_nop 0
    v_permlane16_swap_b32 v212, v214
    v_permlane16_swap_b32 v213, v215
    buffer_store_dwordx4 v[212:215], v53, s[32:35], s50 offen offset:64
    s_waitcnt lgkmcnt(0)
    v_pk_add_f32 v[168:169], v[168:169], v[188:189]
    v_pk_add_f32 v[170:171], v[170:171], v[190:191]
    v_cvt_pk_bf16_f32 v24, v168, v169
    v_cvt_pk_bf16_f32 v25, v170, v171
    buffer_store_dwordx2 v[24:25], v54, s[32:35], s50 offen offset:128
    s_endpgm
    s_nop 0
L_more_122:
    v_lshrrev_b32 v49, 4, v1
    v_and_b32 v50, 15, v1
    v_and_b32 v51, 1, v49
    v_lshlrev_b32 v51, 1, v51
    v_lshrrev_b32 v52, 1, v49
    v_add_u32 v51, v51, v52
    s_lshl_b32 s50, s97, 1
    s_add_u32 s50, s50, s64
    s_mul_i32 s50, s50, 20480
    s_add_u32 s50, s50, 33517568
    s_mul_i32 s53, s43, 10
    v_add_u32 v51, s53, v51
    v_lshlrev_b32 v53, 8, v51
    v_lshl_add_u32 v53, v50, 4, v53
    s_add_u32 s53, s53, 8
    v_add_u32 v52, s53, v52
    v_lshlrev_b32 v54, 8, v52
    v_lshl_add_u32 v54, v50, 4, v54
    v_and_b32 v52, 1, v49
    v_lshl_add_u32 v54, v52, 3, v54
    s_lshl_b32 s53, s97, 5
    s_lshl_b32 s54, s64, 4
    s_add_u32 s53, s53, s54
    v_add_u32 v50, s53, v50
    v_lshlrev_b32 v50, 2, v50
    v_lshrrev_b32 v51, 5, v1
    v_lshl_add_u32 v50, v51, 13, v50
    s_lshl_b32 s52, s43, 14
    s_add_u32 s52, s52, 50556928
    v_mov_b32 v55, 0x3f803f80
    s_waitcnt lgkmcnt(4)
    v_pk_add_f32 v[152:153], v[152:153], v[172:173]
    v_pk_add_f32 v[154:155], v[154:155], v[174:175]
    v_cvt_pk_bf16_f32 v16, v152, v153
    v_cvt_pk_bf16_f32 v17, v154, v155
    s_waitcnt lgkmcnt(3)
    v_pk_add_f32 v[156:157], v[156:157], v[176:177]
    v_pk_add_f32 v[158:159], v[158:159], v[178:179]
    v_cvt_pk_bf16_f32 v18, v156, v157
    v_cvt_pk_bf16_f32 v19, v158, v159
    v_mov_b32 v208, v16
    v_mov_b32 v209, v17
    v_mov_b32 v210, v18
    v_mov_b32 v211, v19
    s_nop 0
    v_permlane16_swap_b32 v208, v210
    v_permlane16_swap_b32 v209, v211
    buffer_store_dwordx4 v[208:211], v53, s[24:27], s50 offen offset:0 sc1
    s_waitcnt lgkmcnt(2)
    v_pk_add_f32 v[160:161], v[160:161], v[180:181]
    v_pk_add_f32 v[162:163], v[162:163], v[182:183]
    v_cvt_pk_bf16_f32 v20, v160, v161
    v_cvt_pk_bf16_f32 v21, v162, v163
    s_waitcnt lgkmcnt(1)
    v_pk_add_f32 v[164:165], v[164:165], v[184:185]
    v_pk_add_f32 v[166:167], v[166:167], v[186:187]
    v_cvt_pk_bf16_f32 v22, v164, v165
    v_cvt_pk_bf16_f32 v23, v166, v167
    v_mov_b32 v212, v20
    v_mov_b32 v213, v21
    v_mov_b32 v214, v22
    v_mov_b32 v215, v23
    s_nop 0
    v_permlane16_swap_b32 v212, v214
    v_permlane16_swap_b32 v213, v215
    buffer_store_dwordx4 v[212:215], v53, s[24:27], s50 offen offset:1024 sc1
    s_waitcnt lgkmcnt(0)
    v_pk_add_f32 v[168:169], v[168:169], v[188:189]
    v_pk_add_f32 v[170:171], v[170:171], v[190:191]
    v_cvt_pk_bf16_f32 v24, v168, v169
    v_cvt_pk_bf16_f32 v25, v170, v171
    buffer_store_dwordx2 v[24:25], v54, s[24:27], s50 offen offset:0 sc1
    v_dot2_f32_bf16 v56, v16, v55, 0
    v_dot2_f32_bf16 v57, v16, v16, 0
    v_dot2_f32_bf16 v56, v17, v55, v56
    v_dot2_f32_bf16 v57, v17, v17, v57
    v_dot2_f32_bf16 v56, v18, v55, v56
    v_dot2_f32_bf16 v57, v18, v18, v57
    v_dot2_f32_bf16 v56, v19, v55, v56
    v_dot2_f32_bf16 v57, v19, v19, v57
    v_dot2_f32_bf16 v56, v20, v55, v56
    v_dot2_f32_bf16 v57, v20, v20, v57
    v_dot2_f32_bf16 v56, v21, v55, v56
    v_dot2_f32_bf16 v57, v21, v21, v57
    v_dot2_f32_bf16 v56, v22, v55, v56
    v_dot2_f32_bf16 v57, v22, v22, v57
    v_dot2_f32_bf16 v56, v23, v55, v56
    v_dot2_f32_bf16 v57, v23, v23, v57
    v_dot2_f32_bf16 v56, v24, v55, v56
    v_dot2_f32_bf16 v57, v24, v24, v57
    v_dot2_f32_bf16 v56, v25, v55, v56
    v_dot2_f32_bf16 v57, v25, v25, v57
    s_nop 2
    v_permlane32_swap_b32 v56, v57
    v_add_f32 v56, v56, v57
    v_mov_b32 v57, v56
    s_nop 1
    v_permlane16_swap_b32 v56, v57
    v_add_f32 v56, v56, v57
    s_mov_b32 exec_lo, 0xffff
    s_mov_b32 exec_hi, 0xffff
    buffer_store_dword v56, v50, s[24:27], s52 offen offset:0 sc1
    s_mov_b64 exec, -1
    s_waitcnt vmcnt(10)
    s_barrier
    ds_read_b128 v[64:67], v2 offset:40960
    ds_read_b128 v[68:71], v2 offset:41984
    ds_read_b128 v[72:75], v2 offset:43008
    ds_read_b128 v[76:79], v2 offset:44032
    ds_read_b128 v[80:83], v2 offset:45056
    ds_read_b128 v[84:87], v2 offset:46080
    ds_read_b128 v[88:91], v2 offset:47104
    ds_read_b128 v[92:95], v2 offset:48128
    ds_read_b128 v[96:99], v2 offset:49152
    ds_read_b128 v[100:103], v2 offset:50176
    ds_read_b128 v[104:107], v2 offset:51200
    ds_read_b128 v[108:111], v2 offset:52224
    s_lshl_b32 s50, s96, 1
    s_mul_i32 s50, s50, 20480
    s_add_u32 s50, s50, 33517568
    s_lshl_b32 s48, s96, 5
    v_and_b32 v47, 15, v1
    v_add_u32 v47, s48, v47
    v_lshrrev_b32 v48, 5, v1
    v_lshl_add_u32 v47, v48, 4, v47
    v_lshlrev_b32 v47, 2, v47
    v_bfe_u32 v48, v1, 4, 1
    v_lshl_add_u32 v47, v48, 13, v47
    s_add_u32 m0, s68, 0
    s_add_u32 s63, s98, 49152
    buffer_load_dwordx4 v253, s[24:27], s63 offen offset:0 sc1 lds
    buffer_load_dwordx4 v253, s[24:27], s63 offen offset:1024 sc1 lds
    s_add_u32 m0, s68, 8192
    s_add_u32 s63, s98, 57344
    buffer_load_dwordx4 v253, s[24:27], s63 offen offset:0 sc1 lds
    buffer_load_dwordx4 v253, s[24:27], s63 offen offset:1024 sc1 lds
    s_add_u32 m0, s68, 16384
    s_add_u32 s63, s98, 65536
    buffer_load_dwordx4 v253, s[24:27], s63 offen offset:0 sc1 lds
    buffer_load_dwordx4 v253, s[24:27], s63 offen offset:1024 sc1 lds
    s_waitcnt vmcnt(6)
    v_mov_b32 v9, s91
    v_mov_b32 v11, 1
    s_mov_b64 exec, 1
    buffer_store_dword v11, v9, s[72:75], 0 offen offset:1024
    buffer_store_dword v11, v9, s[76:79], 0 offen offset:1024 sc1
    s_mov_b64 exec, -1
    s_add_u32 m0, s68, 24576
    s_add_u32 s63, s98, 73728
    buffer_load_dwordx4 v253, s[24:27], s63 offen offset:0 sc1 lds
    buffer_load_dwordx4 v253, s[24:27], s63 offen offset:1024 sc1 lds
    s_add_u32 m0, s68, 32768
    s_add_u32 s63, s98, 81920
    buffer_load_dwordx4 v253, s[24:27], s63 offen offset:0 sc1 lds
    buffer_load_dwordx4 v253, s[24:27], s63 offen offset:1024 sc1 lds
    s_add_u32 m0, s68, 73728
    s_add_u32 s63, s98, 90112
    buffer_load_dwordx4 v253, s[24:27], s63 offen offset:0 sc1 lds
    buffer_load_dwordx4 v253, s[24:27], s63 offen offset:1024 sc1 lds
    s_add_u32 s48, s90, 1024
    v_and_b32 v9, 15, v1
    v_lshl_add_u32 v9, v9, 2, s48
    global_load_dword v10, v9, s[22:23] sc1
    s_waitcnt vmcnt(0)
    v_cmp_le_u32 vcc, 1, v10
    s_nop 1
    s_cmp_eq_u64 vcc, -1
    s_nop 1
    s_cbranch_scc1 L_fd_124
    s_mov_b32 s46, 0x200000
    s_nop 0
L_fl_123:
    global_load_dword v10, v9, s[22:23] sc1
    s_waitcnt vmcnt(0)
    v_cmp_le_u32 vcc, 1, v10
    s_nop 1
    s_cmp_eq_u64 vcc, -1
    s_nop 1
    s_cbranch_scc1 L_fd_124
    s_sub_u32 s46, s46, 1
    s_cmp_lg_u32 s46, 0
    s_nop 0
    s_cbranch_scc1 L_fl_123
    s_nop 0
L_fd_124:
    s_add_u32 s51, s50, 0
    buffer_load_dwordx4 a[0:3], v2, s[24:27], s51 offen offset:0 sc1
    s_add_u32 s51, s50, 20480
    buffer_load_dwordx4 a[4:7], v2, s[24:27], s51 offen offset:0 sc1
    s_add_u32 s51, s50, 0
    buffer_load_dwordx4 a[8:11], v2, s[24:27], s51 offen offset:1024 sc1
    s_add_u32 s51, s50, 20480
    buffer_load_dwordx4 a[12:15], v2, s[24:27], s51 offen offset:1024 sc1
    s_add_u32 s51, s50, 0
    buffer_load_dwordx4 a[16:19], v2, s[24:27], s51 offen offset:2048 sc1
    s_add_u32 s51, s50, 20480
    buffer_load_dwordx4 a[20:23], v2, s[24:27], s51 offen offset:2048 sc1
    s_waitcnt vmcnt(4) lgkmcnt(9)
    v_mfma_f32_16x16x32_bf16 v[112:115], v[64:67], a[0:3], 0
    v_mfma_f32_16x16x32_bf16 v[116:119], v[64:67], a[4:7], 0
    ds_read_b128 v[64:67], v2 offset:53248
    v_mfma_f32_16x16x32_bf16 v[120:123], v[68:71], a[0:3], 0
    s_add_u32 s51, s50, 0
    buffer_load_dwordx4 a[24:27], v2, s[24:27], s51 offen offset:3072 sc1
    v_mfma_f32_16x16x32_bf16 v[124:127], v[68:71], a[4:7], 0
    ds_read_b128 v[68:71], v2 offset:54272
    v_mfma_f32_16x16x32_bf16 v[128:131], v[72:75], a[0:3], 0
    v_mfma_f32_16x16x32_bf16 v[132:135], v[72:75], a[4:7], 0
    ds_read_b128 v[72:75], v2 offset:55296
    s_waitcnt lgkmcnt(9)
    v_mfma_f32_16x16x32_bf16 v[136:139], a[0:3], v[76:79], 0
    s_add_u32 s51, s50, 20480
    buffer_load_dwordx4 a[28:31], v2, s[24:27], s51 offen offset:3072 sc1
    v_mfma_f32_16x16x32_bf16 v[140:143], a[4:7], v[76:79], 0
    ds_read_b128 v[76:79], v2 offset:56320
    v_mfma_f32_16x16x32_bf16 v[144:147], a[0:3], v[80:83], 0
    v_mfma_f32_16x16x32_bf16 v[148:151], a[4:7], v[80:83], 0
    ds_read_b128 v[80:83], v3 offset:24576
    v_mfma_f32_16x16x32_bf16 v[152:155], a[0:3], v[84:87], 0
    s_add_u32 s51, s50, 4096
    buffer_load_dwordx4 a[32:35], v2, s[24:27], s51 offen offset:0 sc1
    v_mfma_f32_16x16x32_bf16 v[156:159], a[4:7], v[84:87], 0
    ds_read_b128 v[84:87], v3 offset:25600
    s_waitcnt vmcnt(5) lgkmcnt(9)
    v_mfma_f32_16x16x32_bf16 v[112:115], v[88:91], a[8:11], v[112:115]
    v_mfma_f32_16x16x32_bf16 v[116:119], v[88:91], a[12:15], v[116:119]
    ds_read_b128 v[88:91], v3 offset:26624
    v_mfma_f32_16x16x32_bf16 v[120:123], v[92:95], a[8:11], v[120:123]
    s_add_u32 s51, s50, 24576
    buffer_load_dwordx4 a[36:39], v2, s[24:27], s51 offen offset:0 sc1
    v_mfma_f32_16x16x32_bf16 v[124:127], v[92:95], a[12:15], v[124:127]
    ds_read_b128 v[92:95], v3 offset:27648
    v_mfma_f32_16x16x32_bf16 v[128:131], v[96:99], a[8:11], v[128:131]
    v_mfma_f32_16x16x32_bf16 v[132:135], v[96:99], a[12:15], v[132:135]
    ds_read_b128 v[96:99], v3 offset:28672
    s_waitcnt lgkmcnt(9)
    v_mfma_f32_16x16x32_bf16 v[136:139], a[8:11], v[100:103], v[136:139]
    s_add_u32 s51, s50, 4096
    buffer_load_dwordx4 a[40:43], v2, s[24:27], s51 offen offset:1024 sc1
    v_mfma_f32_16x16x32_bf16 v[140:143], a[12:15], v[100:103], v[140:143]
    ds_read_b128 v[100:103], v3 offset:29696
    v_mfma_f32_16x16x32_bf16 v[144:147], a[8:11], v[104:107], v[144:147]
    v_mfma_f32_16x16x32_bf16 v[148:151], a[12:15], v[104:107], v[148:151]
    ds_read_b128 v[104:107], v3 offset:30720
    v_mfma_f32_16x16x32_bf16 v[152:155], a[8:11], v[108:111], v[152:155]
    s_add_u32 s51, s50, 24576
    buffer_load_dwordx4 a[44:47], v2, s[24:27], s51 offen offset:1024 sc1
    v_mfma_f32_16x16x32_bf16 v[156:159], a[12:15], v[108:111], v[156:159]
    ds_read_b128 v[108:111], v3 offset:31744
    s_barrier
    s_waitcnt vmcnt(6) lgkmcnt(9)
    v_mfma_f32_16x16x32_bf16 v[112:115], v[64:67], a[16:19], v[112:115]
    s_add_u32 s51, s50, 4096
    buffer_load_dwordx4 a[48:51], v2, s[24:27], s51 offen offset:2048 sc1
    v_mfma_f32_16x16x32_bf16 v[116:119], v[64:67], a[20:23], v[116:119]
    ds_read_b128 v[64:67], v3 offset:32768
    v_mfma_f32_16x16x32_bf16 v[120:123], v[68:71], a[16:19], v[120:123]
    s_add_u32 s51, s50, 24576
    buffer_load_dwordx4 a[52:55], v2, s[24:27], s51 offen offset:2048 sc1
    v_mfma_f32_16x16x32_bf16 v[124:127], v[68:71], a[20:23], v[124:127]
    ds_read_b128 v[68:71], v3 offset:33792
    v_mfma_f32_16x16x32_bf16 v[128:131], v[72:75], a[16:19], v[128:131]
    v_mfma_f32_16x16x32_bf16 v[132:135], v[72:75], a[20:23], v[132:135]
    ds_read_b128 v[72:75], v3 offset:34816
    s_waitcnt lgkmcnt(9)
    v_mfma_f32_16x16x32_bf16 v[136:139], a[16:19], v[76:79], v[136:139]
    s_add_u32 s51, s50, 4096
    buffer_load_dwordx4 a[56:59], v2, s[24:27], s51 offen offset:3072 sc1
    v_mfma_f32_16x16x32_bf16 v[140:143], a[20:23], v[76:79], v[140:143]
    ds_read_b128 v[76:79], v3 offset:35840
    v_mfma_f32_16x16x32_bf16 v[144:147], a[16:19], v[80:83], v[144:147]
    s_add_u32 m0, s68, 40960
    s_add_u32 s63, s98, 98304
    buffer_load_dwordx4 v253, s[24:27], s63 offen offset:0 sc1 lds
    v_mfma_f32_16x16x32_bf16 v[148:151], a[20:23], v[80:83], v[148:151]
    ds_read_b128 v[80:83], v3 offset:36864
    v_mfma_f32_16x16x32_bf16 v[152:155], a[16:19], v[84:87], v[152:155]
    buffer_load_dwordx4 v253, s[24:27], s63 offen offset:1024 sc1 lds
    v_mfma_f32_16x16x32_bf16 v[156:159], a[20:23], v[84:87], v[156:159]
    ds_read_b128 v[84:87], v3 offset:37888
    s_waitcnt vmcnt(9) lgkmcnt(9)
    v_mfma_f32_16x16x32_bf16 v[112:115], v[88:91], a[24:27], v[112:115]
    v_mfma_f32_16x16x32_bf16 v[116:119], v[88:91], a[28:31], v[116:119]
    ds_read_b128 v[88:91], v3 offset:38912
    v_mfma_f32_16x16x32_bf16 v[120:123], v[92:95], a[24:27], v[120:123]
    s_add_u32 s51, s50, 24576
    buffer_load_dwordx4 a[60:63], v2, s[24:27], s51 offen offset:3072 sc1
    v_mfma_f32_16x16x32_bf16 v[124:127], v[92:95], a[28:31], v[124:127]
    ds_read_b128 v[92:95], v3 offset:39936
    v_mfma_f32_16x16x32_bf16 v[128:131], v[96:99], a[24:27], v[128:131]
    v_mfma_f32_16x16x32_bf16 v[132:135], v[96:99], a[28:31], v[132:135]
    ds_read_b128 v[96:99], v2 offset:57344
    s_waitcnt lgkmcnt(9)
    v_mfma_f32_16x16x32_bf16 v[136:139], a[24:27], v[100:103], v[136:139]
    s_add_u32 s51, s50, 8192
    buffer_load_dwordx4 a[64:67], v2, s[24:27], s51 offen offset:0 sc1
    v_mfma_f32_16x16x32_bf16 v[140:143], a[28:31], v[100:103], v[140:143]
    ds_read_b128 v[100:103], v2 offset:58368
    v_mfma_f32_16x16x32_bf16 v[144:147], a[24:27], v[104:107], v[144:147]
    v_mfma_f32_16x16x32_bf16 v[148:151], a[28:31], v[104:107], v[148:151]
    ds_read_b128 v[104:107], v2 offset:59392
    v_mfma_f32_16x16x32_bf16 v[152:155], a[24:27], v[108:111], v[152:155]
    s_add_u32 s51, s50, 28672
    buffer_load_dwordx4 a[68:71], v2, s[24:27], s51 offen offset:0 sc1
    v_mfma_f32_16x16x32_bf16 v[156:159], a[28:31], v[108:111], v[156:159]
    ds_read_b128 v[108:111], v2 offset:60416
    s_waitcnt vmcnt(10) lgkmcnt(9)
    v_mfma_f32_16x16x32_bf16 v[112:115], v[64:67], a[32:35], v[112:115]
    v_mfma_f32_16x16x32_bf16 v[116:119], v[64:67], a[36:39], v[116:119]
    ds_read_b128 v[64:67], v2 offset:61440
    v_mfma_f32_16x16x32_bf16 v[120:123], v[68:71], a[32:35], v[120:123]
    s_add_u32 s51, s50, 8192
    buffer_load_dwordx4 a[72:75], v2, s[24:27], s51 offen offset:1024 sc1
    v_mfma_f32_16x16x32_bf16 v[124:127], v[68:71], a[36:39], v[124:127]
    ds_read_b128 v[68:71], v2 offset:62464
    v_mfma_f32_16x16x32_bf16 v[128:131], v[72:75], a[32:35], v[128:131]
    v_mfma_f32_16x16x32_bf16 v[132:135], v[72:75], a[36:39], v[132:135]
    ds_read_b128 v[72:75], v2 offset:63488
    s_waitcnt lgkmcnt(9)
    v_mfma_f32_16x16x32_bf16 v[136:139], a[32:35], v[76:79], v[136:139]
    s_add_u32 s51, s50, 28672
    buffer_load_dwordx4 a[76:79], v2, s[24:27], s51 offen offset:1024 sc1
    v_mfma_f32_16x16x32_bf16 v[140:143], a[36:39], v[76:79], v[140:143]
    ds_read_b128 v[76:79], v2 offset:64512
    v_mfma_f32_16x16x32_bf16 v[144:147], a[32:35], v[80:83], v[144:147]
    v_mfma_f32_16x16x32_bf16 v[148:151], a[36:39], v[80:83], v[148:151]
    ds_read_b128 v[80:83], v3 offset:0
    v_mfma_f32_16x16x32_bf16 v[152:155], a[32:35], v[84:87], v[152:155]
    s_add_u32 s51, s50, 8192
    buffer_load_dwordx4 a[80:83], v2, s[24:27], s51 offen offset:2048 sc1
    v_mfma_f32_16x16x32_bf16 v[156:159], a[36:39], v[84:87], v[156:159]
    ds_read_b128 v[84:87], v3 offset:1024
    s_waitcnt vmcnt(11) lgkmcnt(9)
    v_mfma_f32_16x16x32_bf16 v[112:115], v[88:91], a[40:43], v[112:115]
    v_mfma_f32_16x16x32_bf16 v[116:119], v[88:91], a[44:47], v[116:119]
    ds_read_b128 v[88:91], v3 offset:2048
    v_mfma_f32_16x16x32_bf16 v[120:123], v[92:95], a[40:43], v[120:123]
    s_add_u32 s51, s50, 28672
    buffer_load_dwordx4 a[84:87], v2, s[24:27], s51 offen offset:2048 sc1
    v_mfma_f32_16x16x32_bf16 v[124:127], v[92:95], a[44:47], v[124:127]
    ds_read_b128 v[92:95], v3 offset:3072
    v_mfma_f32_16x16x32_bf16 v[128:131], v[96:99], a[40:43], v[128:131]
    v_mfma_f32_16x16x32_bf16 v[132:135], v[96:99], a[44:47], v[132:135]
    ds_read_b128 v[96:99], v3 offset:4096
    s_waitcnt lgkmcnt(9)
    v_mfma_f32_16x16x32_bf16 v[136:139], a[40:43], v[100:103], v[136:139]
    s_add_u32 s51, s50, 8192
    buffer_load_dwordx4 a[88:91], v2, s[24:27], s51 offen offset:3072 sc1
    v_mfma_f32_16x16x32_bf16 v[140:143], a[44:47], v[100:103], v[140:143]
    ds_read_b128 v[100:103], v3 offset:5120
    v_mfma_f32_16x16x32_bf16 v[144:147], a[40:43], v[104:107], v[144:147]
    v_mfma_f32_16x16x32_bf16 v[148:151], a[44:47], v[104:107], v[148:151]
    ds_read_b128 v[104:107], v3 offset:6144
    v_mfma_f32_16x16x32_bf16 v[152:155], a[40:43], v[108:111], v[152:155]
    s_add_u32 s51, s50, 28672
    buffer_load_dwordx4 a[92:95], v2, s[24:27], s51 offen offset:3072 sc1
    v_mfma_f32_16x16x32_bf16 v[156:159], a[44:47], v[108:111], v[156:159]
    ds_read_b128 v[108:111], v3 offset:7168
    s_barrier
    s_waitcnt vmcnt(12) lgkmcnt(9)
    v_mfma_f32_16x16x32_bf16 v[112:115], v[64:67], a[48:51], v[112:115]
    s_add_u32 s51, s50, 12288
    buffer_load_dwordx4 a[96:99], v2, s[24:27], s51 offen offset:0 sc1
    v_mfma_f32_16x16x32_bf16 v[116:119], v[64:67], a[52:55], v[116:119]
    ds_read_b128 v[64:67], v2 offset:0
    v_mfma_f32_16x16x32_bf16 v[120:123], v[68:71], a[48:51], v[120:123]
    v_mfma_f32_16x16x32_bf16 v[124:127], v[68:71], a[52:55], v[124:127]
    ds_read_b128 v[68:71], v2 offset:1024
    v_mfma_f32_16x16x32_bf16 v[128:131], v[72:75], a[48:51], v[128:131]
    s_add_u32 s51, s50, 32768
    buffer_load_dwordx4 a[100:103], v2, s[24:27], s51 offen offset:0 sc1
    v_mfma_f32_16x16x32_bf16 v[132:135], v[72:75], a[52:55], v[132:135]
    ds_read_b128 v[72:75], v2 offset:2048
    s_waitcnt lgkmcnt(9)
    v_mfma_f32_16x16x32_bf16 v[136:139], a[48:51], v[76:79], v[136:139]
    s_add_u32 m0, s68, 81920
    s_add_u32 s63, s98, 106496
    buffer_load_dwordx4 v253, s[24:27], s63 offen offset:0 sc1 lds
    v_mfma_f32_16x16x32_bf16 v[140:143], a[52:55], v[76:79], v[140:143]
    ds_read_b128 v[76:79], v2 offset:3072
    v_mfma_f32_16x16x32_bf16 v[144:147], a[48:51], v[80:83], v[144:147]
    v_mfma_f32_16x16x32_bf16 v[148:151], a[52:55], v[80:83], v[148:151]
    ds_read_b128 v[80:83], v2 offset:4096
    v_mfma_f32_16x16x32_bf16 v[152:155], a[48:51], v[84:87], v[152:155]
    buffer_load_dwordx4 v253, s[24:27], s63 offen offset:1024 sc1 lds
    v_mfma_f32_16x16x32_bf16 v[156:159], a[52:55], v[84:87], v[156:159]
    ds_read_b128 v[84:87], v2 offset:5120
    s_waitcnt vmcnt(12) lgkmcnt(9)
    v_mfma_f32_16x16x32_bf16 v[112:115], v[88:91], a[56:59], v[112:115]
    v_mfma_f32_16x16x32_bf16 v[116:119], v[88:91], a[60:63], v[116:119]
    ds_read_b128 v[88:91], v2 offset:6144
    v_mfma_f32_16x16x32_bf16 v[120:123], v[92:95], a[56:59], v[120:123]
    s_add_u32 s51, s50, 12288
    buffer_load_dwordx4 a[104:107], v2, s[24:27], s51 offen offset:1024 sc1
    v_mfma_f32_16x16x32_bf16 v[124:127], v[92:95], a[60:63], v[124:127]
    ds_read_b128 v[92:95], v2 offset:7168
    v_mfma_f32_16x16x32_bf16 v[128:131], v[96:99], a[56:59], v[128:131]
    v_mfma_f32_16x16x32_bf16 v[132:135], v[96:99], a[60:63], v[132:135]
    ds_read_b128 v[96:99], v2 offset:8192
    s_waitcnt lgkmcnt(9)
    v_mfma_f32_16x16x32_bf16 v[136:139], a[56:59], v[100:103], v[136:139]
    v_mfma_f32_16x16x32_bf16 v[140:143], a[60:63], v[100:103], v[140:143]
    ds_read_b128 v[100:103], v2 offset:9216
    v_mfma_f32_16x16x32_bf16 v[144:147], a[56:59], v[104:107], v[144:147]
    s_add_u32 s51, s50, 32768
    buffer_load_dwordx4 a[108:111], v2, s[24:27], s51 offen offset:1024 sc1
    v_mfma_f32_16x16x32_bf16 v[148:151], a[60:63], v[104:107], v[148:151]
    ds_read_b128 v[104:107], v2 offset:10240
    v_mfma_f32_16x16x32_bf16 v[152:155], a[56:59], v[108:111], v[152:155]
    v_mfma_f32_16x16x32_bf16 v[156:159], a[60:63], v[108:111], v[156:159]
    ds_read_b128 v[108:111], v2 offset:11264
    s_waitcnt vmcnt(12) lgkmcnt(9)
    v_mfma_f32_16x16x32_bf16 v[112:115], v[64:67], a[64:67], v[112:115]
    v_mfma_f32_16x16x32_bf16 v[116:119], v[64:67], a[68:71], v[116:119]
    ds_read_b128 v[64:67], v2 offset:12288
    v_mfma_f32_16x16x32_bf16 v[120:123], v[68:71], a[64:67], v[120:123]
    s_add_u32 s51, s50, 12288
    buffer_load_dwordx4 a[112:115], v2, s[24:27], s51 offen offset:2048 sc1
    v_mfma_f32_16x16x32_bf16 v[124:127], v[68:71], a[68:71], v[124:127]
    ds_read_b128 v[68:71], v2 offset:13312
    v_mfma_f32_16x16x32_bf16 v[128:131], v[72:75], a[64:67], v[128:131]
    v_mfma_f32_16x16x32_bf16 v[132:135], v[72:75], a[68:71], v[132:135]
    ds_read_b128 v[72:75], v2 offset:14336
    s_waitcnt lgkmcnt(9)
    v_mfma_f32_16x16x32_bf16 v[136:139], a[64:67], v[76:79], v[136:139]
    s_add_u32 s51, s50, 32768
    buffer_load_dwordx4 a[116:119], v2, s[24:27], s51 offen offset:2048 sc1
    v_mfma_f32_16x16x32_bf16 v[140:143], a[68:71], v[76:79], v[140:143]
    ds_read_b128 v[76:79], v2 offset:15360
    v_mfma_f32_16x16x32_bf16 v[144:147], a[64:67], v[80:83], v[144:147]
    v_mfma_f32_16x16x32_bf16 v[148:151], a[68:71], v[80:83], v[148:151]
    ds_read_b128 v[80:83], v2 offset:16384
    v_mfma_f32_16x16x32_bf16 v[152:155], a[64:67], v[84:87], v[152:155]
    s_mov_b32 s49, 50556928
    buffer_load_dword v48, v47, s[24:27], s49 offen sc1
    v_mfma_f32_16x16x32_bf16 v[156:159], a[68:71], v[84:87], v[156:159]
    ds_read_b128 v[84:87], v2 offset:17408
    s_waitcnt vmcnt(13) lgkmcnt(9)
    v_mfma_f32_16x16x32_bf16 v[112:115], v[88:91], a[72:75], v[112:115]
    v_mfma_f32_16x16x32_bf16 v[116:119], v[88:91], a[76:79], v[116:119]
    ds_read_b128 v[88:91], v2 offset:18432
    v_mfma_f32_16x16x32_bf16 v[120:123], v[92:95], a[72:75], v[120:123]
    s_add_u32 s51, s50, 12288
    buffer_load_dwordx4 a[120:123], v2, s[24:27], s51 offen offset:3072 sc1
    v_mfma_f32_16x16x32_bf16 v[124:127], v[92:95], a[76:79], v[124:127]
    ds_read_b128 v[92:95], v2 offset:19456
    v_mfma_f32_16x16x32_bf16 v[128:131], v[96:99], a[72:75], v[128:131]
    v_mfma_f32_16x16x32_bf16 v[132:135], v[96:99], a[76:79], v[132:135]
    ds_read_b128 v[96:99], v2 offset:20480
    s_waitcnt lgkmcnt(9)
    v_mfma_f32_16x16x32_bf16 v[136:139], a[72:75], v[100:103], v[136:139]
    s_add_u32 s51, s50, 32768
    buffer_load_dwordx4 a[124:127], v2, s[24:27], s51 offen offset:3072 sc1
    v_mfma_f32_16x16x32_bf16 v[140:143], a[76:79], v[100:103], v[140:143]
    ds_read_b128 v[100:103], v2 offset:21504
    v_mfma_f32_16x16x32_bf16 v[144:147], a[72:75], v[104:107], v[144:147]
    v_mfma_f32_16x16x32_bf16 v[148:151], a[76:79], v[104:107], v[148:151]
    ds_read_b128 v[104:107], v2 offset:22528
    v_mfma_f32_16x16x32_bf16 v[152:155], a[72:75], v[108:111], v[152:155]
    s_mov_b32 s49, 50573312
    buffer_load_dword v49, v47, s[24:27], s49 offen sc1
    v_mfma_f32_16x16x32_bf16 v[156:159], a[76:79], v[108:111], v[156:159]
    ds_read_b128 v[108:111], v2 offset:23552
    s_barrier
    s_waitcnt vmcnt(14) lgkmcnt(9)
    v_mfma_f32_16x16x32_bf16 v[112:115], v[64:67], a[80:83], v[112:115]
    s_add_u32 s51, s50, 16384
    buffer_load_dwordx4 a[128:131], v2, s[24:27], s51 offen offset:0 sc1
    v_mfma_f32_16x16x32_bf16 v[116:119], v[64:67], a[84:87], v[116:119]
    ds_read_b128 v[64:67], v2 offset:24576
    v_mfma_f32_16x16x32_bf16 v[120:123], v[68:71], a[80:83], v[120:123]
    s_add_u32 s51, s50, 36864
    buffer_load_dwordx4 a[132:135], v2, s[24:27], s51 offen offset:0 sc1
    v_mfma_f32_16x16x32_bf16 v[124:127], v[68:71], a[84:87], v[124:127]
    ds_read_b128 v[68:71], v2 offset:25600
    v_mfma_f32_16x16x32_bf16 v[128:131], v[72:75], a[80:83], v[128:131]
    v_mfma_f32_16x16x32_bf16 v[132:135], v[72:75], a[84:87], v[132:135]
    ds_read_b128 v[72:75], v2 offset:26624
    s_waitcnt lgkmcnt(9)
    v_mfma_f32_16x16x32_bf16 v[136:139], a[80:83], v[76:79], v[136:139]
    s_mov_b32 s49, 50589696
    buffer_load_dword v50, v47, s[24:27], s49 offen sc1
    v_mfma_f32_16x16x32_bf16 v[140:143], a[84:87], v[76:79], v[140:143]
    ds_read_b128 v[76:79], v2 offset:27648
    v_mfma_f32_16x16x32_bf16 v[144:147], a[80:83], v[80:83], v[144:147]
    s_add_u32 m0, s68, 90112
    s_add_u32 s63, s98, 114688
    buffer_load_dwordx4 v253, s[24:27], s63 offen offset:0 sc1 lds
    v_mfma_f32_16x16x32_bf16 v[148:151], a[84:87], v[80:83], v[148:151]
    ds_read_b128 v[80:83], v2 offset:28672
    v_mfma_f32_16x16x32_bf16 v[152:155], a[80:83], v[84:87], v[152:155]
    buffer_load_dwordx4 v253, s[24:27], s63 offen offset:1024 sc1 lds
    v_mfma_f32_16x16x32_bf16 v[156:159], a[84:87], v[84:87], v[156:159]
    ds_read_b128 v[84:87], v2 offset:29696
    s_waitcnt vmcnt(17) lgkmcnt(9)
    v_mfma_f32_16x16x32_bf16 v[112:115], v[88:91], a[88:91], v[112:115]
    v_mfma_f32_16x16x32_bf16 v[116:119], v[88:91], a[92:95], v[116:119]
    ds_read_b128 v[88:91], v2 offset:30720
    v_mfma_f32_16x16x32_bf16 v[120:123], v[92:95], a[88:91], v[120:123]
    s_add_u32 s51, s50, 16384
    buffer_load_dwordx4 a[136:139], v2, s[24:27], s51 offen offset:1024 sc1
    v_mfma_f32_16x16x32_bf16 v[124:127], v[92:95], a[92:95], v[124:127]
    ds_read_b128 v[92:95], v2 offset:31744
    v_mfma_f32_16x16x32_bf16 v[128:131], v[96:99], a[88:91], v[128:131]
    v_mfma_f32_16x16x32_bf16 v[132:135], v[96:99], a[92:95], v[132:135]
    ds_read_b128 v[96:99], v2 offset:32768
    s_waitcnt lgkmcnt(9)
    v_mfma_f32_16x16x32_bf16 v[136:139], a[88:91], v[100:103], v[136:139]
    s_add_u32 s51, s50, 36864
    buffer_load_dwordx4 a[140:143], v2, s[24:27], s51 offen offset:1024 sc1
    v_mfma_f32_16x16x32_bf16 v[140:143], a[92:95], v[100:103], v[140:143]
    ds_read_b128 v[100:103], v2 offset:33792
    v_mfma_f32_16x16x32_bf16 v[144:147], a[88:91], v[104:107], v[144:147]
    v_mfma_f32_16x16x32_bf16 v[148:151], a[92:95], v[104:107], v[148:151]
    ds_read_b128 v[104:107], v2 offset:34816
    v_mfma_f32_16x16x32_bf16 v[152:155], a[88:91], v[108:111], v[152:155]
    s_mov_b32 s49, 50606080
    buffer_load_dword v51, v47, s[24:27], s49 offen sc1
    v_mfma_f32_16x16x32_bf16 v[156:159], a[92:95], v[108:111], v[156:159]
    ds_read_b128 v[108:111], v2 offset:35840
    s_waitcnt vmcnt(18) lgkmcnt(9)
    v_mfma_f32_16x16x32_bf16 v[112:115], v[64:67], a[96:99], v[112:115]
    s_add_u32 s51, s50, 16384
    buffer_load_dwordx4 a[144:147], v2, s[24:27], s51 offen offset:2048 sc1
    v_mfma_f32_16x16x32_bf16 v[116:119], v[64:67], a[100:103], v[116:119]
    ds_read_b128 v[64:67], v2 offset:36864
    v_mfma_f32_16x16x32_bf16 v[120:123], v[68:71], a[96:99], v[120:123]
    s_add_u32 s51, s50, 36864
    buffer_load_dwordx4 a[148:151], v2, s[24:27], s51 offen offset:2048 sc1
    v_mfma_f32_16x16x32_bf16 v[124:127], v[68:71], a[100:103], v[124:127]
    ds_read_b128 v[68:71], v2 offset:37888
    v_mfma_f32_16x16x32_bf16 v[128:131], v[72:75], a[96:99], v[128:131]
    v_mfma_f32_16x16x32_bf16 v[132:135], v[72:75], a[100:103], v[132:135]
    ds_read_b128 v[72:75], v2 offset:38912
    s_waitcnt lgkmcnt(9)
    v_mfma_f32_16x16x32_bf16 v[136:139], a[96:99], v[76:79], v[136:139]
    s_mov_b32 s49, 50622464
    buffer_load_dword v52, v47, s[24:27], s49 offen sc1
    v_mfma_f32_16x16x32_bf16 v[140:143], a[100:103], v[76:79], v[140:143]
    ds_read_b128 v[76:79], v2 offset:39936
    v_mfma_f32_16x16x32_bf16 v[144:147], a[96:99], v[80:83], v[144:147]
    s_add_u32 m0, s68, 98304
    s_add_u32 s63, s98, 122880
    buffer_load_dwordx4 v253, s[24:27], s63 offen offset:0 sc1 lds
    v_mfma_f32_16x16x32_bf16 v[148:151], a[100:103], v[80:83], v[148:151]
    ds_read_b128 v[80:83], v3 offset:8192
    v_mfma_f32_16x16x32_bf16 v[152:155], a[96:99], v[84:87], v[152:155]
    buffer_load_dwordx4 v253, s[24:27], s63 offen offset:1024 sc1 lds
    v_mfma_f32_16x16x32_bf16 v[156:159], a[100:103], v[84:87], v[156:159]
    ds_read_b128 v[84:87], v3 offset:9216
    s_waitcnt vmcnt(19) lgkmcnt(9)
    v_mfma_f32_16x16x32_bf16 v[112:115], v[88:91], a[104:107], v[112:115]
    s_add_u32 s51, s50, 16384
    buffer_load_dwordx4 a[152:155], v2, s[24:27], s51 offen offset:3072 sc1
    v_mfma_f32_16x16x32_bf16 v[116:119], v[88:91], a[108:111], v[116:119]
    ds_read_b128 v[88:91], v3 offset:10240
    v_mfma_f32_16x16x32_bf16 v[120:123], v[92:95], a[104:107], v[120:123]
    s_add_u32 s51, s50, 36864
    buffer_load_dwordx4 a[156:159], v2, s[24:27], s51 offen offset:3072 sc1
    v_mfma_f32_16x16x32_bf16 v[124:127], v[92:95], a[108:111], v[124:127]
    ds_read_b128 v[92:95], v3 offset:11264
    v_mfma_f32_16x16x32_bf16 v[128:131], v[96:99], a[104:107], v[128:131]
    v_mfma_f32_16x16x32_bf16 v[132:135], v[96:99], a[108:111], v[132:135]
    ds_read_b128 v[96:99], v3 offset:12288
    s_waitcnt lgkmcnt(9)
    v_mfma_f32_16x16x32_bf16 v[136:139], a[104:107], v[100:103], v[136:139]
    s_mov_b32 s49, 50638848
    buffer_load_dword v53, v47, s[24:27], s49 offen sc1
    v_mfma_f32_16x16x32_bf16 v[140:143], a[108:111], v[100:103], v[140:143]
    ds_read_b128 v[100:103], v3 offset:13312
    v_mfma_f32_16x16x32_bf16 v[144:147], a[104:107], v[104:107], v[144:147]
    s_add_u32 m0, s68, 106496
    s_add_u32 s63, s98, 131072
    buffer_load_dwordx4 v253, s[24:27], s63 offen offset:0 sc1 lds
    v_mfma_f32_16x16x32_bf16 v[148:151], a[108:111], v[104:107], v[148:151]
    ds_read_b128 v[104:107], v3 offset:14336
    v_mfma_f32_16x16x32_bf16 v[152:155], a[104:107], v[108:111], v[152:155]
    buffer_load_dwordx4 v253, s[24:27], s63 offen offset:1024 sc1 lds
    v_mfma_f32_16x16x32_bf16 v[156:159], a[108:111], v[108:111], v[156:159]
    ds_read_b128 v[108:111], v3 offset:15360
    s_waitcnt vmcnt(13)
    s_barrier
    s_waitcnt lgkmcnt(9)
    v_mfma_f32_16x16x32_bf16 v[112:115], v[64:67], a[112:115], v[112:115]
    v_mfma_f32_16x16x32_bf16 v[116:119], v[64:67], a[116:119], v[116:119]
    ds_read_b128 v[64:67], v2 offset:40960
    v_mfma_f32_16x16x32_bf16 v[120:123], v[68:71], a[112:115], v[120:123]
    s_mov_b32 s49, 50655232
    buffer_load_dword v54, v47, s[24:27], s49 offen sc1
    v_mfma_f32_16x16x32_bf16 v[124:127], v[68:71], a[116:119], v[124:127]
    ds_read_b128 v[68:71], v2 offset:41984
    v_mfma_f32_16x16x32_bf16 v[128:131], v[72:75], a[112:115], v[128:131]
    v_mfma_f32_16x16x32_bf16 v[132:135], v[72:75], a[116:119], v[132:135]
    ds_read_b128 v[72:75], v2 offset:43008
    s_waitcnt lgkmcnt(9)
    v_mfma_f32_16x16x32_bf16 v[136:139], a[112:115], v[76:79], v[136:139]
    s_add_u32 m0, s68, 114688
    s_add_u32 s63, s98, 139264
    buffer_load_dwordx4 v253, s[24:27], s63 offen offset:0 sc1 lds
    v_mfma_f32_16x16x32_bf16 v[140:143], a[116:119], v[76:79], v[140:143]
    ds_read_b128 v[76:79], v2 offset:44032
    v_mfma_f32_16x16x32_bf16 v[144:147], a[112:115], v[80:83], v[144:147]
    v_mfma_f32_16x16x32_bf16 v[148:151], a[116:119], v[80:83], v[148:151]
    ds_read_b128 v[80:83], v2 offset:45056
    v_mfma_f32_16x16x32_bf16 v[152:155], a[112:115], v[84:87], v[152:155]
    buffer_load_dwordx4 v253, s[24:27], s63 offen offset:1024 sc1 lds
    v_mfma_f32_16x16x32_bf16 v[156:159], a[116:119], v[84:87], v[156:159]
    ds_read_b128 v[84:87], v2 offset:46080
    s_waitcnt lgkmcnt(9)
    v_mfma_f32_16x16x32_bf16 v[112:115], v[88:91], a[120:123], v[112:115]
    v_mfma_f32_16x16x32_bf16 v[116:119], v[88:91], a[124:127], v[116:119]
    ds_read_b128 v[88:91], v2 offset:47104
    v_mfma_f32_16x16x32_bf16 v[120:123], v[92:95], a[120:123], v[120:123]
    s_mov_b32 s49, 50671616
    buffer_load_dword v55, v47, s[24:27], s49 offen sc1
    v_mfma_f32_16x16x32_bf16 v[124:127], v[92:95], a[124:127], v[124:127]
    ds_read_b128 v[92:95], v2 offset:48128
    v_mfma_f32_16x16x32_bf16 v[128:131], v[96:99], a[120:123], v[128:131]
    v_mfma_f32_16x16x32_bf16 v[132:135], v[96:99], a[124:127], v[132:135]
    ds_read_b128 v[96:99], v3 offset:16384
    s_waitcnt lgkmcnt(9)
    v_mfma_f32_16x16x32_bf16 v[136:139], a[120:123], v[100:103], v[136:139]
    s_add_u32 m0, s68, 122880
    s_add_u32 s63, s98, 147456
    buffer_load_dwordx4 v253, s[24:27], s63 offen offset:0 sc1 lds
    v_mfma_f32_16x16x32_bf16 v[140:143], a[124:127], v[100:103], v[140:143]
    ds_read_b128 v[100:103], v3 offset:17408
    v_mfma_f32_16x16x32_bf16 v[144:147], a[120:123], v[104:107], v[144:147]
    v_mfma_f32_16x16x32_bf16 v[148:151], a[124:127], v[104:107], v[148:151]
    ds_read_b128 v[104:107], v3 offset:18432
    v_mfma_f32_16x16x32_bf16 v[152:155], a[120:123], v[108:111], v[152:155]
    buffer_load_dwordx4 v253, s[24:27], s63 offen offset:1024 sc1 lds
    v_mfma_f32_16x16x32_bf16 v[156:159], a[124:127], v[108:111], v[156:159]
    ds_read_b128 v[108:111], v3 offset:19456
    s_waitcnt lgkmcnt(9)
    v_mfma_f32_16x16x32_bf16 v[112:115], v[64:67], a[128:131], v[112:115]
    s_mul_i32 s71, s45, 22528
    s_add_u32 s71, s71, 17264640
    s_mov_b32 s62, 2
    s_mul_i32 s83, s42, 5632
    s_add_u32 s82, s71, s83
    s_add_u32 s83, s83, 45056
    v_add_u32 v12, s83, v2
    v_mfma_f32_16x16x32_bf16 v[116:119], v[64:67], a[132:135], v[116:119]
    ds_read_b128 v[64:67], v3 offset:20480
    v_lshrrev_b32 v13, 4, v1
    v_mul_u32_u24 v13, 768, v13
    v_mfma_f32_16x16x32_bf16 v[120:123], v[68:71], a[128:131], v[120:123]
    s_add_u32 m0, s68, 131072
    s_add_u32 s63, s98, 155648
    buffer_load_dwordx4 v253, s[24:27], s63 offen offset:0 sc1 lds
    v_and_b32 v15, 15, v1
    v_lshl_add_u32 v13, v15, 4, v13
    v_mfma_f32_16x16x32_bf16 v[124:127], v[68:71], a[132:135], v[124:127]
    ds_read_b128 v[68:71], v3 offset:21504
    v_add_u32 v14, s83, v13
    v_mov_b32 v60, 0x3f803f80
    v_mfma_f32_16x16x32_bf16 v[128:131], v[72:75], a[128:131], v[128:131]
    v_mfma_f32_16x16x32_bf16 v[132:135], v[72:75], a[132:135], v[132:135]
    ds_read_b128 v[72:75], v3 offset:22528
    s_waitcnt lgkmcnt(9)
    v_mfma_f32_16x16x32_bf16 v[136:139], a[128:131], v[76:79], v[136:139]
    v_mfma_f32_16x16x32_bf16 v[140:143], a[132:135], v[76:79], v[140:143]
    ds_read_b128 v[76:79], v3 offset:23552
    v_mfma_f32_16x16x32_bf16 v[144:147], a[128:131], v[80:83], v[144:147]
    buffer_load_dwordx4 v253, s[24:27], s63 offen offset:1024 sc1 lds
    v_mfma_f32_16x16x32_bf16 v[148:151], a[132:135], v[80:83], v[148:151]
    ds_read_b128 v[80:83], v3 offset:24576
    v_mfma_f32_16x16x32_bf16 v[152:155], a[128:131], v[84:87], v[152:155]
    v_mfma_f32_16x16x32_bf16 v[156:159], a[132:135], v[84:87], v[156:159]
    ds_read_b128 v[84:87], v3 offset:25600
    s_waitcnt vmcnt(19) lgkmcnt(9)
    v_mfma_f32_16x16x32_bf16 v[112:115], v[88:91], a[136:139], v[112:115]
    v_add_f32 v48, v48, v49
    v_add_f32 v48, v48, v50
    v_mfma_f32_16x16x32_bf16 v[116:119], v[88:91], a[140:143], v[116:119]
    ds_read_b128 v[88:91], v3 offset:26624
    s_waitcnt vmcnt(18)
    v_add_f32 v48, v48, v51
    v_mfma_f32_16x16x32_bf16 v[120:123], v[92:95], a[136:139], v[120:123]
    s_waitcnt vmcnt(15)
    v_add_f32 v48, v48, v52
    s_waitcnt vmcnt(10)
    v_add_f32 v48, v48, v53
    v_mfma_f32_16x16x32_bf16 v[124:127], v[92:95], a[140:143], v[124:127]
    ds_read_b128 v[92:95], v3 offset:27648
    s_waitcnt vmcnt(7)
    v_add_f32 v48, v48, v54
    v_mfma_f32_16x16x32_bf16 v[128:131], v[96:99], a[136:139], v[128:131]
    s_waitcnt vmcnt(4)
    v_add_f32 v48, v48, v55
    v_mov_b32 v49, v48
    v_mfma_f32_16x16x32_bf16 v[132:135], v[96:99], a[140:143], v[132:135]
    ds_read_b128 v[96:99], v3 offset:28672
    v_permlane16_swap_b32 v48, v49
    s_waitcnt lgkmcnt(9)
    v_mfma_f32_16x16x32_bf16 v[136:139], a[136:139], v[100:103], v[136:139]
    v_mul_f32 v50, 0.0015625, v48
    v_mul_f32 v55, 0.0015625, v49
    v_fma_f32 v55, -v50, v50, v55
    v_max_f32 v55, 0, v55
    v_add_f32 v55, 1e-05, v55
    v_rsq_f32 v52, v55
    v_mov_b32 v51, v50
    v_mov_b32 v53, v52
    v_mfma_f32_16x16x32_bf16 v[140:143], a[140:143], v[100:103], v[140:143]
    ds_read_b128 v[100:103], v3 offset:29696
    v_permlane32_swap_b32 v50, v51
    v_mfma_f32_16x16x32_bf16 v[144:147], a[136:139], v[104:107], v[144:147]
    v_mfma_f32_16x16x32_bf16 v[148:151], a[140:143], v[104:107], v[148:151]
    ds_read_b128 v[104:107], v3 offset:30720
    v_mfma_f32_16x16x32_bf16 v[152:155], a[136:139], v[108:111], v[152:155]
    v_mfma_f32_16x16x32_bf16 v[156:159], a[140:143], v[108:111], v[156:159]
    ds_read_b128 v[108:111], v3 offset:31744
    s_barrier
    s_waitcnt lgkmcnt(9)
    v_mfma_f32_16x16x32_bf16 v[112:115], v[64:67], a[144:147], v[112:115]
    v_permlane32_swap_b32 v52, v53
    v_lshrrev_b32 v44, 4, v1
    v_lshlrev_b32 v44, 4, v44
    v_mfma_f32_16x16x32_bf16 v[116:119], v[64:67], a[148:151], v[116:119]
    ds_read_b128 v[64:67], v3 offset:32768
    v_cmp_gt_u32 vcc, 32, v1
    v_mfma_f32_16x16x32_bf16 v[120:123], v[68:71], a[144:147], v[120:123]
    v_mov_b32 v26, v52
    v_mul_f32 v40, 0.3225964182229561, v52
    v_cndmask_b32 v42, v26, v40, vcc
    v_mfma_f32_16x16x32_bf16 v[124:127], v[68:71], a[148:151], v[124:127]
    ds_read_b128 v[68:71], v3 offset:33792
    ds_bpermute_b32 v32, v44, v26 offset:0
    v_mfma_f32_16x16x32_bf16 v[128:131], v[72:75], a[144:147], v[128:131]
    ds_bpermute_b32 v33, v44, v26 offset:4
    ds_bpermute_b32 v34, v44, v26 offset:8
    v_mfma_f32_16x16x32_bf16 v[132:135], v[72:75], a[148:151], v[132:135]
    ds_read_b128 v[72:75], v3 offset:34816
    s_waitcnt lgkmcnt(8)
    ds_bpermute_b32 v35, v44, v26 offset:12
    v_mfma_f32_16x16x32_bf16 v[136:139], a[144:147], v[76:79], v[136:139]
    v_cvt_pk_bf16_f32 v45, v50, v50
    v_lshlrev_b32 v45, 16, v45
    v_sub_f32 v46, v50, v45
    v_cvt_pk_bf16_f32 v28, -v45, -v46
    v_cvt_pk_bf16_f32 v29, -v45, 0
    v_mov_b32 v27, v53
    v_mul_f32 v41, 0.3225964182229561, v53
    v_mfma_f32_16x16x32_bf16 v[140:143], a[148:151], v[76:79], v[140:143]
    ds_read_b128 v[76:79], v3 offset:35840
    v_mfma_f32_16x16x32_bf16 v[144:147], a[144:147], v[80:83], v[144:147]
    v_mfma_f32_16x16x32_bf16 v[148:151], a[148:151], v[80:83], v[148:151]
    ds_read_b128 v[80:83], v3 offset:36864
    v_mfma_f32_16x16x32_bf16 v[152:155], a[144:147], v[84:87], v[152:155]
    v_mfma_f32_16x16x32_bf16 v[156:159], a[148:151], v[84:87], v[156:159]
    ds_read_b128 v[84:87], v3 offset:37888
    v_mfma_f32_16x16x32_bf16 v[112:115], v[88:91], a[152:155], v[112:115]
    v_cndmask_b32 v43, v27, v41, vcc
    ds_bpermute_b32 v36, v44, v27 offset:0
    v_mfma_f32_16x16x32_bf16 v[116:119], v[88:91], a[156:159], v[116:119]
    ds_read_b128 v[88:91], v3 offset:38912
    ds_bpermute_b32 v37, v44, v27 offset:4
    v_mfma_f32_16x16x32_bf16 v[120:123], v[92:95], a[152:155], v[120:123]
    s_waitcnt lgkmcnt(8)
    ds_bpermute_b32 v38, v44, v27 offset:8
    ds_bpermute_b32 v39, v44, v27 offset:12
    v_mfma_f32_16x16x32_bf16 v[124:127], v[92:95], a[156:159], v[124:127]
    ds_read_b128 v[92:95], v3 offset:39936
    v_cvt_pk_bf16_f32 v45, v51, v51
    v_lshlrev_b32 v45, 16, v45
    v_sub_f32 v46, v51, v45
    v_cvt_pk_bf16_f32 v30, -v45, -v46
    v_cvt_pk_bf16_f32 v31, -v45, 0
    v_mfma_f32_16x16x32_bf16 v[128:131], v[96:99], a[152:155], v[128:131]
    v_cmp_gt_u32 vcc, 16, v1
    s_nop 1
    v_cndmask_b32 v28, 0, v28, vcc
    v_mfma_f32_16x16x32_bf16 v[132:135], v[96:99], a[156:159], v[132:135]
    ds_read_b128 v[96:99], v3 offset:40960
    v_cndmask_b32 v29, 0, v29, vcc
    v_mfma_f32_16x16x32_bf16 v[136:139], a[152:155], v[100:103], v[136:139]
    v_cndmask_b32 v30, 0, v30, vcc
    v_cndmask_b32 v31, 0, v31, vcc
    v_mfma_f32_16x16x32_bf16 v[140:143], a[156:159], v[100:103], v[140:143]
    ds_read_b128 v[100:103], v3 offset:41984
    v_mfma_f32_16x16x32_bf16 v[144:147], a[152:155], v[104:107], v[144:147]
    v_mfma_f32_16x16x32_bf16 v[148:151], a[156:159], v[104:107], v[148:151]
    ds_read_b128 v[104:107], v3 offset:43008
    v_mfma_f32_16x16x32_bf16 v[152:155], a[152:155], v[108:111], v[152:155]
    v_mfma_f32_16x16x32_bf16 v[156:159], a[156:159], v[108:111], v[156:159]
    ds_read_b128 v[108:111], v3 offset:44032
    v_mfma_f32_16x16x16bf16_1k v[112:115], a[216:217], v[28:29], v[112:115]
    v_mfma_f32_16x16x16bf16_1k v[116:119], a[216:217], v[30:31], v[116:119]
    v_mfma_f32_16x16x16bf16_1k v[120:123], a[218:219], v[28:29], v[120:123]
    v_mfma_f32_16x16x16bf16_1k v[124:127], a[218:219], v[30:31], v[124:127]
    v_mfma_f32_16x16x16bf16_1k v[128:131], a[220:221], v[28:29], v[128:131]
    v_mfma_f32_16x16x16bf16_1k v[132:135], a[220:221], v[30:31], v[132:135]
    v_mfma_f32_16x16x16bf16_1k v[136:139], v[28:29], a[222:223], v[136:139]
    v_mfma_f32_16x16x16bf16_1k v[140:143], v[30:31], a[222:223], v[140:143]
    v_mfma_f32_16x16x16bf16_1k v[144:147], v[28:29], a[224:225], v[144:147]
    v_mfma_f32_16x16x16bf16_1k v[148:151], v[30:31], a[224:225], v[148:151]
    v_mfma_f32_16x16x16bf16_1k v[152:155], v[28:29], a[226:227], v[152:155]
    v_mfma_f32_16x16x16bf16_1k v[156:159], v[30:31], a[226:227], v[156:159]
    v_mfma_f32_16x16x16bf16_1k v[160:163], a[228:229], v[28:29], 0
    v_mfma_f32_16x16x16bf16_1k v[164:167], a[228:229], v[30:31], 0
    v_mfma_f32_16x16x16bf16_1k v[168:171], a[230:231], v[28:29], 0
    v_mfma_f32_16x16x16bf16_1k v[172:175], a[230:231], v[30:31], 0
    s_nop 2
    v_mfma_f32_16x16x32_bf16 v[160:163], v[64:67], a[0:3], v[160:163]
    v_mul_f32 v112, v112, v26
    v_mul_f32 v113, v113, v26
    v_mul_f32 v114, v114, v26
    v_mfma_f32_16x16x32_bf16 v[164:167], v[64:67], a[4:7], v[164:167]
    s_waitcnt lgkmcnt(8)
    ds_read_b128 v[64:67], v3 offset:45056
    v_mul_f32 v115, v115, v26
    v_cvt_pk_bf16_f32 v208, v112, v113
    v_mfma_f32_16x16x32_bf16 v[168:171], v[68:71], a[0:3], v[168:171]
    v_cvt_pk_bf16_f32 v209, v114, v115
    v_mul_f32 v116, v116, v27
    v_mul_f32 v117, v117, v27
    v_mfma_f32_16x16x32_bf16 v[172:175], v[68:71], a[4:7], v[172:175]
    ds_read_b128 v[68:71], v3 offset:46080
    v_mul_f32 v118, v118, v27
    v_mfma_f32_16x16x32_bf16 v[160:163], v[72:75], a[8:11], v[160:163]
    v_mul_f32 v119, v119, v27
    v_cvt_pk_bf16_f32 v210, v116, v117
    v_cvt_pk_bf16_f32 v211, v118, v119
    v_mfma_f32_16x16x32_bf16 v[164:167], v[72:75], a[12:15], v[164:167]
    ds_read_b128 v[72:75], v3 offset:47104
    s_nop 0
    v_permlane16_swap_b32 v208, v210
    v_mfma_f32_16x16x32_bf16 v[168:171], v[76:79], a[8:11], v[168:171]
    v_permlane16_swap_b32 v209, v211
    buffer_store_dwordx4 v[208:211], v2, s[24:27], s82 offen offset:0 sc1
    ds_write_b128 v12, v[208:211] offset:0
    v_mfma_f32_16x16x32_bf16 v[172:175], v[76:79], a[12:15], v[172:175]
    ds_read_b128 v[76:79], v3 offset:48128
    v_mul_f32 v120, v120, v26
    v_mfma_f32_16x16x32_bf16 v[160:163], v[80:83], a[16:19], v[160:163]
    v_mul_f32 v121, v121, v26
    v_mul_f32 v122, v122, v26
    v_mul_f32 v123, v123, v26
    v_mfma_f32_16x16x32_bf16 v[164:167], v[80:83], a[20:23], v[164:167]
    ds_read_b128 v[80:83], v3 offset:49152
    v_cvt_pk_bf16_f32 v212, v120, v121
    v_cvt_pk_bf16_f32 v213, v122, v123
    v_mfma_f32_16x16x32_bf16 v[168:171], v[84:87], a[16:19], v[168:171]
    v_mul_f32 v124, v124, v27
    v_mul_f32 v125, v125, v27
    v_mul_f32 v126, v126, v27
    v_mfma_f32_16x16x32_bf16 v[172:175], v[84:87], a[20:23], v[172:175]
    ds_read_b128 v[84:87], v3 offset:50176
    v_mul_f32 v127, v127, v27
    s_waitcnt lgkmcnt(11)
    v_mfma_f32_16x16x32_bf16 v[160:163], v[88:91], a[24:27], v[160:163]
    v_cvt_pk_bf16_f32 v214, v124, v125
    v_cvt_pk_bf16_f32 v215, v126, v127
    s_nop 0
    v_mfma_f32_16x16x32_bf16 v[164:167], v[88:91], a[28:31], v[164:167]
    ds_read_b128 v[88:91], v3 offset:51200
    v_permlane16_swap_b32 v212, v214
    v_permlane16_swap_b32 v213, v215
    v_mfma_f32_16x16x32_bf16 v[168:171], v[92:95], a[24:27], v[168:171]
    buffer_store_dwordx4 v[212:215], v2, s[24:27], s82 offen offset:1024 sc1
    ds_write_b128 v12, v[212:215] offset:1024
    v_mul_f32 v128, v128, v42
    v_mfma_f32_16x16x32_bf16 v[172:175], v[92:95], a[28:31], v[172:175]
    ds_read_b128 v[92:95], v3 offset:52224
    v_mul_f32 v129, v129, v42
    s_waitcnt vmcnt(2)
    s_barrier
    s_waitcnt lgkmcnt(12)
    v_mfma_f32_16x16x32_bf16 v[160:163], v[96:99], a[32:35], v[160:163]
    v_mul_f32 v130, v130, v42
    v_mul_f32 v131, v131, v42
    v_cvt_pk_bf16_f32 v216, v128, v129
    v_mfma_f32_16x16x32_bf16 v[164:167], v[96:99], a[36:39], v[164:167]
    ds_read_b128 v[96:99], v3 offset:53248
    v_cvt_pk_bf16_f32 v217, v130, v131
    v_mul_f32 v132, v132, v43
    v_mfma_f32_16x16x32_bf16 v[168:171], v[100:103], a[32:35], v[168:171]
    v_mul_f32 v133, v133, v43
    v_mul_f32 v134, v134, v43
    v_mul_f32 v135, v135, v43
    v_mfma_f32_16x16x32_bf16 v[172:175], v[100:103], a[36:39], v[172:175]
    ds_read_b128 v[100:103], v3 offset:54272
    v_cvt_pk_bf16_f32 v218, v132, v133
    s_waitcnt lgkmcnt(12)
    v_mfma_f32_16x16x32_bf16 v[160:163], v[104:107], a[40:43], v[160:163]
    v_cvt_pk_bf16_f32 v219, v134, v135
    s_nop 0
    v_permlane16_swap_b32 v216, v218
    v_mfma_f32_16x16x32_bf16 v[164:167], v[104:107], a[44:47], v[164:167]
    ds_read_b128 v[104:107], v3 offset:55296
    v_permlane16_swap_b32 v217, v219
    s_mov_b32 exec_lo, 0
    buffer_store_dwordx4 v[216:219], v2, s[24:27], s82 offen offset:1536 sc1
    ds_write_b128 v12, v[216:219] offset:1536
    s_mov_b32 exec_lo, -1
    v_mfma_f32_16x16x32_bf16 v[168:171], v[108:111], a[40:43], v[168:171]
    v_cmp_gt_u32 vcc, 32, v1
    s_nop 1
    v_cndmask_b32 v248, 0, v216, vcc
    v_cndmask_b32 v249, 0, v217, vcc
    v_mfma_f32_16x16x32_bf16 v[172:175], v[108:111], a[44:47], v[172:175]
    ds_read_b128 v[108:111], v3 offset:56320
    v_cndmask_b32 v250, 0, v218, vcc
    s_waitcnt lgkmcnt(13)
    v_mfma_f32_16x16x32_bf16 v[160:163], v[64:67], a[48:51], v[160:163]
    v_cndmask_b32 v251, 0, v219, vcc
    v_mul_f32 v136, v136, v32
    v_mul_f32 v137, v137, v33
    v_mfma_f32_16x16x32_bf16 v[164:167], v[64:67], a[52:55], v[164:167]
    ds_read_b128 v[64:67], v3 offset:57344
    v_mul_f32 v138, v138, v34
    v_mul_f32 v139, v139, v35
    v_mfma_f32_16x16x32_bf16 v[168:171], v[68:71], a[48:51], v[168:171]
    v_cvt_pk_bf16_f32 v220, v136, v137
    v_cvt_pk_bf16_f32 v221, v138, v139
    v_mul_f32 v140, v140, v36
    v_mfma_f32_16x16x32_bf16 v[172:175], v[68:71], a[52:55], v[172:175]
    ds_read_b128 v[68:71], v3 offset:58368
    v_mul_f32 v141, v141, v37
    s_waitcnt lgkmcnt(12)
    v_mfma_f32_16x16x32_bf16 v[160:163], v[72:75], a[56:59], v[160:163]
    v_mul_f32 v142, v142, v38
    v_mul_f32 v143, v143, v39
    v_cvt_pk_bf16_f32 v222, v140, v141
    v_mfma_f32_16x16x32_bf16 v[164:167], v[72:75], a[60:63], v[164:167]
    ds_read_b128 v[72:75], v3 offset:59392
    v_cvt_pk_bf16_f32 v223, v142, v143
    s_nop 0
    v_mfma_f32_16x16x32_bf16 v[168:171], v[76:79], a[56:59], v[168:171]
    v_permlane32_swap_b32 v220, v222
    v_permlane32_swap_b32 v221, v223
    buffer_store_dwordx4 v[220:223], v13, s[24:27], s82 offen offset:2560 sc1
    v_mfma_f32_16x16x32_bf16 v[172:175], v[76:79], a[60:63], v[172:175]
    ds_read_b128 v[76:79], v3 offset:60416
    ds_write_b128 v14, v[220:223] offset:2560
    s_waitcnt lgkmcnt(13)
    v_mfma_f32_16x16x32_bf16 v[160:163], v[80:83], a[64:67], v[160:163]
    v_mul_f32 v144, v144, v32
    v_mul_f32 v145, v145, v33
    v_mul_f32 v146, v146, v34
    v_mfma_f32_16x16x32_bf16 v[164:167], v[80:83], a[68:71], v[164:167]
    ds_read_b128 v[80:83], v3 offset:61440
    v_mul_f32 v147, v147, v35
    v_cvt_pk_bf16_f32 v224, v144, v145
    v_mfma_f32_16x16x32_bf16 v[168:171], v[84:87], a[64:67], v[168:171]
    v_cvt_pk_bf16_f32 v225, v146, v147
    v_mul_f32 v148, v148, v36
    v_mul_f32 v149, v149, v37
    v_mfma_f32_16x16x32_bf16 v[172:175], v[84:87], a[68:71], v[172:175]
    ds_read_b128 v[84:87], v3 offset:62464
    v_mul_f32 v150, v150, v38
    s_waitcnt lgkmcnt(12)
    v_mfma_f32_16x16x32_bf16 v[160:163], v[88:91], a[72:75], v[160:163]
    v_mul_f32 v151, v151, v39
    v_cvt_pk_bf16_f32 v226, v148, v149
    v_cvt_pk_bf16_f32 v227, v150, v151
    v_mfma_f32_16x16x32_bf16 v[164:167], v[88:91], a[76:79], v[164:167]
    ds_read_b128 v[88:91], v3 offset:63488
    s_nop 0
    v_permlane32_swap_b32 v224, v226
    v_mfma_f32_16x16x32_bf16 v[168:171], v[92:95], a[72:75], v[168:171]
    v_permlane32_swap_b32 v225, v227
    buffer_store_dwordx4 v[224:227], v13, s[24:27], s82 offen offset:2816 sc1
    ds_write_b128 v14, v[224:227] offset:2816
    v_mfma_f32_16x16x32_bf16 v[172:175], v[92:95], a[76:79], v[172:175]
    ds_read_b128 v[92:95], v3 offset:64512
    v_mul_f32 v152, v152, v32
    s_waitcnt lgkmcnt(13)
    v_mfma_f32_16x16x32_bf16 v[160:163], v[96:99], a[80:83], v[160:163]
    v_mul_f32 v153, v153, v33
    v_mul_f32 v154, v154, v34
    v_mul_f32 v155, v155, v35
    v_mfma_f32_16x16x32_bf16 v[164:167], v[96:99], a[84:87], v[164:167]
    ds_read_b128 v[96:99], v4 offset:0
    v_cvt_pk_bf16_f32 v228, v152, v153
    v_cvt_pk_bf16_f32 v229, v154, v155
    v_mfma_f32_16x16x32_bf16 v[168:171], v[100:103], a[80:83], v[168:171]
    v_mul_f32 v156, v156, v36
    v_mul_f32 v157, v157, v37
    v_mul_f32 v158, v158, v38
    v_mfma_f32_16x16x32_bf16 v[172:175], v[100:103], a[84:87], v[172:175]
    ds_read_b128 v[100:103], v4 offset:1024
    v_mul_f32 v159, v159, v39
    s_waitcnt lgkmcnt(12)
    v_mfma_f32_16x16x32_bf16 v[160:163], v[104:107], a[88:91], v[160:163]
    v_cvt_pk_bf16_f32 v230, v156, v157
    v_cvt_pk_bf16_f32 v231, v158, v159
    s_nop 0
    v_mfma_f32_16x16x32_bf16 v[164:167], v[104:107], a[92:95], v[164:167]
    ds_read_b128 v[104:107], v4 offset:2048
    v_permlane32_swap_b32 v228, v230
    v_permlane32_swap_b32 v229, v231
    v_mfma_f32_16x16x32_bf16 v[168:171], v[108:111], a[88:91], v[168:171]
    v_cmp_eq_u32 vcc, 8, v15
    s_nop 1
    v_cndmask_b32 v228, v228, v60, vcc
    v_cndmask_b32 v229, v229, v60, vcc
    v_mfma_f32_16x16x32_bf16 v[172:175], v[108:111], a[92:95], v[172:175]
    ds_read_b128 v[108:111], v4 offset:3072
    v_cndmask_b32 v230, v230, v60, vcc
    s_waitcnt lgkmcnt(12)
    v_mfma_f32_16x16x32_bf16 v[160:163], v[64:67], a[96:99], v[160:163]
    v_cndmask_b32 v231, v231, v60, vcc
    buffer_store_dwordx4 v[228:231], v13, s[24:27], s82 offen offset:3072 sc1
    ds_write_b128 v14, v[228:231] offset:3072
    v_mfma_f32_16x16x32_bf16 v[164:167], v[64:67], a[100:103], v[164:167]
    ds_read_b128 v[64:67], v4 offset:4096
    v_and_b32 v44, 31, v1
    v_lshrrev_b32 v45, 5, v1
    v_mfma_f32_16x16x32_bf16 v[168:171], v[68:71], a[96:99], v[168:171]
    v_lshlrev_b32 v46, 2, v45
    v_sub_u32 v46, v44, v46
    v_mov_b32 v47, 0xf149f2ca
    v_mfma_f32_16x16x32_bf16 v[172:175], v[68:71], a[100:103], v[172:175]
    ds_read_b128 v[68:71], v4 offset:5120
    s_mul_i32 s48, s42, 5632
    v_add_u32 v32, s48, v2
    v_lshl_add_u32 v33, v44, 4, s48
    s_waitcnt lgkmcnt(13)
    v_mfma_f32_16x16x32_bf16 v[160:163], v[72:75], a[104:107], v[160:163]
    v_cmp_gt_u32 vcc, 20, v44
    v_mul_u32_u24 v48, 48, v45
    v_add_u32 v49, 0, v44
    v_mfma_f32_16x16x32_bf16 v[164:167], v[72:75], a[108:111], v[164:167]
    ds_read_b128 v[72:75], v4 offset:6144
    v_cndmask_b32 v49, 40, v49, vcc
    v_add_u32 v49, v49, v48
    v_mfma_f32_16x16x32_bf16 v[168:171], v[76:79], a[104:107], v[168:171]
    s_mul_i32 s48, s42, 5632
    v_lshl_add_u32 v34, v49, 4, s48
    v_add_u32 v49, 20, v44
    v_cndmask_b32 v49, 40, v49, vcc
    v_mfma_f32_16x16x32_bf16 v[172:175], v[76:79], a[108:111], v[172:175]
    ds_read_b128 v[76:79], v4 offset:7168
    v_add_u32 v49, v49, v48
    s_waitcnt lgkmcnt(12)
    v_mfma_f32_16x16x32_bf16 v[160:163], v[80:83], a[112:115], v[160:163]
    s_mul_i32 s48, s42, 5632
    v_lshl_add_u32 v35, v49, 4, s48
    v_cmp_le_i32 vcc, 0, v46
    s_nop 1
    v_cndmask_b32 v208, v47, 0, vcc
    v_mfma_f32_16x16x32_bf16 v[164:167], v[80:83], a[116:119], v[164:167]
    v_cndmask_b32 v224, 0, v47, vcc
    v_cmp_le_i32 vcc, 1, v46
    v_mfma_f32_16x16x32_bf16 v[168:171], v[84:87], a[112:115], v[168:171]
    s_nop 0
    v_cndmask_b32 v209, v47, 0, vcc
    v_cndmask_b32 v225, 0, v47, vcc
    v_cmp_le_i32 vcc, 2, v46
    v_mfma_f32_16x16x32_bf16 v[172:175], v[84:87], a[116:119], v[172:175]
    s_nop 0
    v_cndmask_b32 v210, v47, 0, vcc
    s_waitcnt lgkmcnt(9)
    v_mfma_f32_16x16x32_bf16 v[160:163], v[88:91], a[120:123], v[160:163]
    v_cndmask_b32 v226, 0, v47, vcc
    v_cmp_le_i32 vcc, 3, v46
    s_nop 1
    v_cndmask_b32 v211, v47, 0, vcc
    v_mfma_f32_16x16x32_bf16 v[164:167], v[88:91], a[124:127], v[164:167]
    v_cndmask_b32 v227, 0, v47, vcc
    v_cmp_le_i32 vcc, 8, v46
    v_mfma_f32_16x16x32_bf16 v[168:171], v[92:95], a[120:123], v[168:171]
    s_nop 0
    v_cndmask_b32 v212, v47, 0, vcc
    v_cndmask_b32 v228, 0, v47, vcc
    v_cmp_le_i32 vcc, 9, v46
    v_mfma_f32_16x16x32_bf16 v[172:175], v[92:95], a[124:127], v[172:175]
    s_waitcnt lgkmcnt(7)
    v_mfma_f32_16x16x32_bf16 v[160:163], v[96:99], a[128:131], v[160:163]
    v_cndmask_b32 v213, v47, 0, vcc
    v_cndmask_b32 v229, 0, v47, vcc
    v_cmp_le_i32 vcc, 10, v46
    v_mfma_f32_16x16x32_bf16 v[164:167], v[96:99], a[132:135], v[164:167]
    s_nop 0
    v_cndmask_b32 v214, v47, 0, vcc
    v_cndmask_b32 v230, 0, v47, vcc
    v_mfma_f32_16x16x32_bf16 v[168:171], v[100:103], a[128:131], v[168:171]
    v_cmp_le_i32 vcc, 11, v46
    s_nop 1
    v_cndmask_b32 v215, v47, 0, vcc
    v_cndmask_b32 v231, 0, v47, vcc
    v_mfma_f32_16x16x32_bf16 v[172:175], v[100:103], a[132:135], v[172:175]
    s_waitcnt lgkmcnt(5)
    v_mfma_f32_16x16x32_bf16 v[160:163], v[104:107], a[136:139], v[160:163]
    v_cmp_le_i32 vcc, 16, v46
    s_nop 1
    v_cndmask_b32 v216, v47, 0, vcc
    v_cndmask_b32 v232, 0, v47, vcc
    v_mfma_f32_16x16x32_bf16 v[164:167], v[104:107], a[140:143], v[164:167]
    v_cmp_le_i32 vcc, 17, v46
    s_nop 1
    v_cndmask_b32 v217, v47, 0, vcc
    v_mfma_f32_16x16x32_bf16 v[168:171], v[108:111], a[136:139], v[168:171]
    v_cndmask_b32 v233, 0, v47, vcc
    v_cmp_le_i32 vcc, 18, v46
    s_nop 1
    v_cndmask_b32 v218, v47, 0, vcc
    v_mfma_f32_16x16x32_bf16 v[172:175], v[108:111], a[140:143], v[172:175]
    s_waitcnt lgkmcnt(2)
    v_mfma_f32_16x16x32_bf16 v[160:163], v[64:67], a[144:147], v[160:163]
    v_cndmask_b32 v234, 0, v47, vcc
    v_cmp_le_i32 vcc, 19, v46
    s_nop 1
    v_cndmask_b32 v219, v47, 0, vcc
    v_mfma_f32_16x16x32_bf16 v[164:167], v[64:67], a[148:151], v[164:167]
    v_cndmask_b32 v235, 0, v47, vcc
    v_cmp_le_i32 vcc, 24, v46
    v_mfma_f32_16x16x32_bf16 v[168:171], v[68:71], a[144:147], v[168:171]
    s_nop 0
    v_cndmask_b32 v220, v47, 0, vcc
    v_cndmask_b32 v236, 0, v47, vcc
    v_cmp_le_i32 vcc, 25, v46
    v_mfma_f32_16x16x32_bf16 v[172:175], v[68:71], a[148:151], v[172:175]
    s_waitcnt lgkmcnt(0)
    v_mfma_f32_16x16x32_bf16 v[160:163], v[72:75], a[152:155], v[160:163]
    v_cndmask_b32 v221, v47, 0, vcc
    v_cndmask_b32 v237, 0, v47, vcc
    v_cmp_le_i32 vcc, 26, v46
    v_mfma_f32_16x16x32_bf16 v[164:167], v[72:75], a[156:159], v[164:167]
    s_nop 0
    v_cndmask_b32 v222, v47, 0, vcc
    v_cndmask_b32 v238, 0, v47, vcc
    v_mfma_f32_16x16x32_bf16 v[168:171], v[76:79], a[152:155], v[168:171]
    v_cmp_le_i32 vcc, 27, v46
    s_nop 1
    v_cndmask_b32 v223, v47, 0, vcc
    v_cndmask_b32 v239, 0, v47, vcc
    v_mfma_f32_16x16x32_bf16 v[172:175], v[76:79], a[156:159], v[172:175]
    v_pk_mul_f32 v[160:161], v[160:161], v[40:41] op_sel:[0,0] op_sel_hi:[1,0]
    v_pk_mul_f32 v[162:163], v[162:163], v[40:41] op_sel:[0,0] op_sel_hi:[1,0]
    v_cvt_pk_bf16_f32 v240, v160, v161
    v_cvt_pk_bf16_f32 v241, v162, v163
    v_pk_mul_f32 v[164:165], v[164:165], v[40:41] op_sel:[0,1] op_sel_hi:[1,1]
    v_pk_mul_f32 v[166:167], v[166:167], v[40:41] op_sel:[0,1] op_sel_hi:[1,1]
    v_cvt_pk_bf16_f32 v242, v164, v165
    v_cvt_pk_bf16_f32 v243, v166, v167
    s_nop 0
    v_permlane16_swap_b32 v240, v242
    v_permlane16_swap_b32 v241, v243
    v_pk_mul_f32 v[168:169], v[168:169], v[40:41] op_sel:[0,0] op_sel_hi:[1,0]
    v_pk_mul_f32 v[170:171], v[170:171], v[40:41] op_sel:[0,0] op_sel_hi:[1,0]
    v_cvt_pk_bf16_f32 v244, v168, v169
    v_cvt_pk_bf16_f32 v245, v170, v171
    v_pk_mul_f32 v[172:173], v[172:173], v[40:41] op_sel:[0,1] op_sel_hi:[1,1]
    v_pk_mul_f32 v[174:175], v[174:175], v[40:41] op_sel:[0,1] op_sel_hi:[1,1]
    v_cvt_pk_bf16_f32 v246, v172, v173
    v_cvt_pk_bf16_f32 v247, v174, v175
    s_nop 0
    v_permlane16_swap_b32 v244, v246
    v_permlane16_swap_b32 v245, v247
    s_waitcnt vmcnt(0)
    s_barrier
    s_cmp_lg_u32 s42, 0
    s_nop 0
    s_cbranch_scc1 L_w0_125
    s_add_u32 s48, s45, 16
    s_lshl_b32 s48, s48, 7
    s_add_u32 s48, s48, 4
    v_mul_u32_u24 v9, 133120, v1
    v_add_u32 v9, s48, v9
    v_mov_b32 v11, s62
    s_sub_u32 s48, 15, s40
    s_min_u32 s48, s48, 2
    s_bfm_b64 exec, s48, 0
    s_nop 0
    s_cbranch_execz L_nosig_126
    global_store_dword v9, v11, s[22:23] sc1
    s_nop 0
L_nosig_126:
    s_mov_b64 exec, -1
    s_nop 0
L_w0_125:
    s_add_u32 s95, s95, 2048
    s_add_u32 s94, s94, 2048
    s_add_u32 s90, s90, 2048
    s_add_u32 s91, s91, 2048
    s_mov_b32 s98, 0x7f000000
    s_nop 0
    s_branch L_layer
L_pack_5:
    s_mov_b32 s48, 6144
    s_cmp_eq_u32 s42, 3
    s_cselect_b32 s48, 2048, s48
    s_mul_i32 s48, s48, 0
    s_add_u32 s48, s48, s89
    buffer_store_dwordx4 v[96:99], v2, s[24:27], s48 offen offset:0 sc1
    buffer_store_dwordx4 v[100:103], v2, s[24:27], s48 offen offset:1024 sc1
    s_nop 1
    s_branch L_packed_6
L_pack_7:
    s_mov_b32 s48, 6144
    s_cmp_eq_u32 s42, 3
    s_cselect_b32 s48, 2048, s48
    s_mul_i32 s48, s48, 1
    s_add_u32 s48, s48, s89
    buffer_store_dwordx4 v[104:107], v2, s[24:27], s48 offen offset:0 sc1
    buffer_store_dwordx4 v[108:111], v2, s[24:27], s48 offen offset:1024 sc1
    s_nop 1
    s_branch L_packed_8
L_pack_9:
    s_mov_b32 s48, 6144
    s_cmp_eq_u32 s42, 3
    s_cselect_b32 s48, 2048, s48
    s_mul_i32 s48, s48, 2
    s_add_u32 s48, s48, s89
    buffer_store_dwordx4 v[96:99], v2, s[24:27], s48 offen offset:0 sc1
    buffer_store_dwordx4 v[100:103], v2, s[24:27], s48 offen offset:1024 sc1
    s_nop 1
    s_branch L_packed_10
L_pack_11:
    s_mov_b32 s48, 6144
    s_cmp_eq_u32 s42, 3
    s_cselect_b32 s48, 2048, s48
    s_mul_i32 s48, s48, 3
    s_add_u32 s48, s48, s89
    buffer_store_dwordx4 v[104:107], v2, s[24:27], s48 offen offset:0 sc1
    buffer_store_dwordx4 v[108:111], v2, s[24:27], s48 offen offset:1024 sc1
    s_nop 1
    s_branch L_packed_12
L_pack_13:
    s_mov_b32 s48, 6144
    s_cmp_eq_u32 s42, 3
    s_cselect_b32 s48, 2048, s48
    s_mul_i32 s48, s48, 4
    s_add_u32 s48, s48, s89
    buffer_store_dwordx4 v[96:99], v2, s[24:27], s48 offen offset:0 sc1
    buffer_store_dwordx4 v[100:103], v2, s[24:27], s48 offen offset:1024 sc1
    s_nop 1
    s_branch L_packed_14
L_pack_15:
    s_mov_b32 s48, 6144
    s_cmp_eq_u32 s42, 3
    s_cselect_b32 s48, 2048, s48
    s_mul_i32 s48, s48, 5
    s_add_u32 s48, s48, s89
    buffer_store_dwordx4 v[104:107], v2, s[24:27], s48 offen offset:0 sc1
    buffer_store_dwordx4 v[108:111], v2, s[24:27], s48 offen offset:1024 sc1
    s_nop 1
    s_branch L_packed_16
L_pack_17:
    s_mov_b32 s48, 6144
    s_cmp_eq_u32 s42, 3
    s_cselect_b32 s48, 2048, s48
    s_mul_i32 s48, s48, 6
    s_add_u32 s48, s48, s89
    buffer_store_dwordx4 v[96:99], v2, s[24:27], s48 offen offset:0 sc1
    buffer_store_dwordx4 v[100:103], v2, s[24:27], s48 offen offset:1024 sc1
    s_nop 1
    s_branch L_packed_18
L_pack_19:
    s_mov_b32 s48, 6144
    s_cmp_eq_u32 s42, 3
    s_cselect_b32 s48, 2048, s48
    s_mul_i32 s48, s48, 7
    s_add_u32 s48, s48, s89
    buffer_store_dwordx4 v[104:107], v2, s[24:27], s48 offen offset:0 sc1
    buffer_store_dwordx4 v[108:111], v2, s[24:27], s48 offen offset:1024 sc1
    s_nop 1
    s_branch L_packed_20
L_pack_22:
    s_mov_b32 s48, 6144
    s_cmp_eq_u32 s42, 3
    s_cselect_b32 s48, 2048, s48
    s_mul_i32 s48, s48, 8
    s_add_u32 s48, s48, s89
    buffer_store_dwordx4 v[96:99], v2, s[24:27], s48 offen offset:0 sc1
    buffer_store_dwordx4 v[100:103], v2, s[24:27], s48 offen offset:1024 sc1
    s_nop 1
    s_branch L_packed_23
L_pack_24:
    s_mov_b32 s48, 6144
    s_cmp_eq_u32 s42, 3
    s_cselect_b32 s48, 2048, s48
    s_mul_i32 s48, s48, 9
    s_add_u32 s48, s48, s89
    buffer_store_dwordx4 v[104:107], v2, s[24:27], s48 offen offset:0 sc1
    buffer_store_dwordx4 v[108:111], v2, s[24:27], s48 offen offset:1024 sc1
    s_nop 1
    s_branch L_packed_25
L_pack_26:
    s_mov_b32 s48, 6144
    s_cmp_eq_u32 s42, 3
    s_cselect_b32 s48, 2048, s48
    s_mul_i32 s48, s48, 10
    s_add_u32 s48, s48, s89
    buffer_store_dwordx4 v[96:99], v2, s[24:27], s48 offen offset:0 sc1
    buffer_store_dwordx4 v[100:103], v2, s[24:27], s48 offen offset:1024 sc1
    s_nop 1
    s_branch L_packed_27
L_pack_28:
    s_mov_b32 s48, 6144
    s_cmp_eq_u32 s42, 3
    s_cselect_b32 s48, 2048, s48
    s_mul_i32 s48, s48, 11
    s_add_u32 s48, s48, s89
    buffer_store_dwordx4 v[104:107], v2, s[24:27], s48 offen offset:0 sc1
    buffer_store_dwordx4 v[108:111], v2, s[24:27], s48 offen offset:1024 sc1
    s_nop 1
    s_branch L_packed_29
L_pack_30:
    s_mov_b32 s48, 6144
    s_cmp_eq_u32 s42, 3
    s_cselect_b32 s48, 2048, s48
    s_mul_i32 s48, s48, 12
    s_add_u32 s48, s48, s89
    buffer_store_dwordx4 v[96:99], v2, s[24:27], s48 offen offset:0 sc1
    buffer_store_dwordx4 v[100:103], v2, s[24:27], s48 offen offset:1024 sc1
    s_nop 1
    s_branch L_packed_31
L_dup_32:
    s_sub_u32 s48, s45, 40
    s_and_b32 s48, s48, 7
    s_mul_i32 s48, s48, 5
    v_and_b32 v44, 31, v1
    v_lshlrev_b32 v44, 4, v44
    v_lshrrev_b32 v45, 5, v1
    v_lshl_add_u32 v44, v45, 10, v44
    s_add_u32 s49, s48, 0
    s_lshr_b32 s50, s49, 1
    s_lshl_b32 s50, s50, 12
    s_and_b32 s49, s49, 1
    s_lshl_b32 s49, s49, 9
    s_add_u32 s50, s50, s49
    s_add_u32 s50, s50, s81
    buffer_store_dwordx4 v[208:211], v44, s[24:27], s50 offen sc1
    s_add_u32 s49, s48, 1
    s_lshr_b32 s50, s49, 1
    s_lshl_b32 s50, s50, 12
    s_and_b32 s49, s49, 1
    s_lshl_b32 s49, s49, 9
    s_add_u32 s50, s50, s49
    s_add_u32 s50, s50, s81
    buffer_store_dwordx4 v[212:215], v44, s[24:27], s50 offen sc1
    s_add_u32 s49, s48, 2
    s_lshr_b32 s50, s49, 1
    s_lshl_b32 s50, s50, 12
    s_and_b32 s49, s49, 1
    s_lshl_b32 s49, s49, 9
    s_add_u32 s50, s50, s49
    s_add_u32 s50, s50, s81
    buffer_store_dwordx4 v[216:219], v44, s[24:27], s50 offen sc1
    s_add_u32 s49, s48, 3
    s_lshr_b32 s50, s49, 1
    s_lshl_b32 s50, s50, 12
    s_and_b32 s49, s49, 1
    s_lshl_b32 s49, s49, 9
    s_add_u32 s50, s50, s49
    s_add_u32 s50, s50, s81
    buffer_store_dwordx4 v[220:223], v44, s[24:27], s50 offen sc1
    s_add_u32 s49, s48, 4
    s_lshr_b32 s50, s49, 1
    s_lshl_b32 s50, s50, 12
    s_and_b32 s49, s49, 1
    s_lshl_b32 s49, s49, 9
    s_add_u32 s50, s50, s49
    s_add_u32 s50, s50, s81
    buffer_store_dwordx4 v[224:227], v44, s[24:27], s50 offen sc1
    s_nop 1
    s_branch L_dupd_33
L_pack_34:
    s_mov_b32 s48, 6144
    s_cmp_eq_u32 s42, 3
    s_cselect_b32 s48, 2048, s48
    s_mul_i32 s48, s48, 13
    s_add_u32 s48, s48, s89
    buffer_store_dwordx4 v[104:107], v2, s[24:27], s48 offen offset:0 sc1
    buffer_store_dwordx4 v[108:111], v2, s[24:27], s48 offen offset:1024 sc1
    s_nop 1
    s_branch L_packed_35
L_pack_39:
    s_mov_b32 s48, 6144
    s_cmp_eq_u32 s42, 3
    s_cselect_b32 s48, 2048, s48
    s_mul_i32 s48, s48, 14
    s_add_u32 s48, s48, s89
    buffer_store_dwordx4 v[96:99], v2, s[24:27], s48 offen offset:0 sc1
    buffer_store_dwordx4 v[100:103], v2, s[24:27], s48 offen offset:1024 sc1
    s_nop 1
    s_branch L_packed_40
L_pack_42:
    s_mov_b32 s48, 6144
    s_cmp_eq_u32 s42, 3
    s_cselect_b32 s48, 2048, s48
    s_mul_i32 s48, s48, 15
    s_add_u32 s48, s48, s89
    buffer_store_dwordx4 v[104:107], v2, s[24:27], s48 offen offset:0 sc1
    buffer_store_dwordx4 v[108:111], v2, s[24:27], s48 offen offset:1024 sc1
    s_nop 1
    s_branch L_packed_43
L_pack_44:
    s_mov_b32 s48, 6144
    s_cmp_eq_u32 s42, 3
    s_cselect_b32 s48, 2048, s48
    s_mul_i32 s48, s48, 16
    s_add_u32 s48, s48, s89
    buffer_store_dwordx4 v[96:99], v2, s[24:27], s48 offen offset:0 sc1
    buffer_store_dwordx4 v[100:103], v2, s[24:27], s48 offen offset:1024 sc1
    s_nop 1
    s_branch L_packed_45
L_pack_48:
    s_mov_b32 s48, 6144
    s_cmp_eq_u32 s42, 3
    s_cselect_b32 s48, 2048, s48
    s_mul_i32 s48, s48, 17
    s_add_u32 s48, s48, s89
    buffer_store_dwordx4 v[104:107], v2, s[24:27], s48 offen offset:0 sc1
    buffer_store_dwordx4 v[108:111], v2, s[24:27], s48 offen offset:1024 sc1
    s_nop 1
    s_branch L_packed_49
L_pack_50:
    s_mov_b32 s48, 6144
    s_cmp_eq_u32 s42, 3
    s_cselect_b32 s48, 2048, s48
    s_mul_i32 s48, s48, 18
    s_add_u32 s48, s48, s89
    buffer_store_dwordx4 v[96:99], v2, s[24:27], s48 offen offset:0 sc1
    buffer_store_dwordx4 v[100:103], v2, s[24:27], s48 offen offset:1024 sc1
    s_nop 1
    s_branch L_packed_51
L_pack_52:
    s_mov_b32 s48, 6144
    s_cmp_eq_u32 s42, 3
    s_cselect_b32 s48, 2048, s48
    s_mul_i32 s48, s48, 19
    s_add_u32 s48, s48, s89
    buffer_store_dwordx4 v[104:107], v2, s[24:27], s48 offen offset:0 sc1
    buffer_store_dwordx4 v[108:111], v2, s[24:27], s48 offen offset:1024 sc1
    s_nop 1
    s_branch L_packed_53
    s_nop 0
L_exit:
    s_endpgm
.section .rodata,"a"
.p2align 6
.amdhsa_kernel interleave_layers__sliding_block__glu_gated_reglu__prompt_kernel
  .amdhsa_next_free_vgpr 512
  .amdhsa_next_free_sgpr 102
  .amdhsa_accum_offset 256
  .amdhsa_group_segment_fixed_size 0
  .amdhsa_kernarg_size 80
  .amdhsa_user_sgpr_count 2
  .amdhsa_user_sgpr_kernarg_segment_ptr 1
  .amdhsa_system_sgpr_workgroup_id_x 1
.end_amdhsa_kernel
```
